```python
import torch

def _softmax(x, axis=-1):
    return torch.softmax(x, dim=axis)
def _gelu(x):
    return torch.nn.functional.gelu(x, approximate="tanh")
def _silu(x):
    return torch.nn.functional.silu(x)
def _sigmoid(x):
    return torch.sigmoid(x)
def _layernorm(x, axis=-1, eps=1e-5):
    m = x.mean(dim=axis, keepdim=True)
    v = x.var(dim=axis, keepdim=True, unbiased=False)
    return (x - m) / torch.sqrt(v + eps)
def _scatter_add(tgt, idx, src, axis=0):
    return tgt.clone().index_add_(axis, idx, src)
def _segment_sum(src, seg, n):
    out = torch.zeros((n,) + src.shape[1:], dtype=src.dtype)
    return out.index_add_(0, seg, src)
def _pad(x, pw):
    flat = tuple(v for pair in reversed(pw) for v in pair)
    return torch.nn.functional.pad(x, flat)

kernel_name = 'sequential_preLN__linear_kernel_hedgehog__dense_activation_silu__prompt'

def setup_inputs():

    _w = (lambda a: (lambda t: t.to(torch.bfloat16) if t.is_floating_point() else t)(torch.as_tensor(a)))
    def _A_setup():
        B, S, D, H = 1, 2048, 448, 16
        Dh = D // H
        return {
            "x": _w((lambda *s: torch.randn(*s, dtype=torch.bfloat16) * 0.05)(B, S, D)),
            "wqkv": _w((lambda *s: torch.randn(*s, dtype=torch.bfloat16) * 0.2)(D, 3 * D)),
            "w_phi": _w((lambda *s: torch.randn(*s, dtype=torch.bfloat16) * 0.2)(H, Dh, Dh) * (Dh ** -0.5)),
            "wo": _w((lambda *s: torch.randn(*s, dtype=torch.bfloat16) * 0.05)(D, D)),
        }
    _A_in = _A_setup()

    def _B_setup():
        B, S, D, F = 1, 2048, 448, 1792
        return {
            "x": _w((lambda *s: torch.randn(*s, dtype=torch.bfloat16) * 0.05)(B, S, D)),
            "w1": _w((lambda *s: torch.randn(*s, dtype=torch.bfloat16) * 3.2)(D, F) * (D ** -0.5)),
            "w2": _w((lambda *s: torch.randn(*s, dtype=torch.bfloat16) * 0.1)(F, D) * (F ** -0.5)),
        }
    _B_in = _B_setup()

    return {
        "A_x": _A_in["x"],
        "A_wqkv": _A_in["wqkv"],
        "A_w_phi": _A_in["w_phi"],
        "A_wo": _A_in["wo"],
        "B_x": _B_in["x"],
        "B_w1": _B_in["w1"],
        "B_w2": _B_in["w2"],
    }

def reference(A_x, A_wqkv, A_w_phi, A_wo, B_x, B_w1, B_w2):
    def _A_ref(x, wqkv, w_phi, wo):
        B, S, D = x.shape
        H = 16; Dh = D // H
        qkv = (lambda x, *d: x.permute(*d))((x @ wqkv).reshape(B, S, 3, H, Dh), 2, 0, 3, 1, 4)
        q, k, v = qkv[0], qkv[1], qkv[2]
        pq = torch.einsum("bhsd,hdf->bhsf", q, w_phi)
        pk = torch.einsum("bhsd,hdf->bhsf", k, w_phi)
        phi_q = torch.concatenate([_softmax(pq, axis=-1), _softmax(-pq, axis=-1)], axis=-1)
        phi_k = torch.concatenate([_softmax(pk, axis=-1), _softmax(-pk, axis=-1)], axis=-1)
        kv = torch.einsum("bhsf,bhsd->bhfd", phi_k, v)
        z  = torch.einsum("bhsf->bhf", phi_k)
        num = torch.einsum("bhqf,bhfd->bhqd", phi_q, kv)
        den = torch.einsum("bhqf,bhf->bhq", phi_q, z)[..., None] + 1e-6
        o = num / den
        return (lambda x, *d: x.permute(*d))(o, 0, 2, 1, 3).reshape(B, S, D) @ wo

    def _B_ref(x, w1, w2):
        h = torch.einsum("bsd,df->bsf", x, w1)
        h = _silu(h)
        out = torch.einsum("bsf,fd->bsd", h, w2)
        return out

    x = A_x
    h = x + _A_ref(_layernorm(x, axis=-1), A_wqkv, A_w_phi, A_wo)
    h2 = h + _B_ref(_layernorm(h, axis=-1), B_w1, B_w2)
    return h2
```

```asm
; @launch grid=(256,1,1) block=(512,1,1) lds=163840
.amdgcn_target "amdgcn-amd-amdhsa--gfx950"
.text
.p2align 8
.globl sequential_preLN__linear_kernel_hedgehog__dense_activation_silu__prompt_kernel
.type sequential_preLN__linear_kernel_hedgehog__dense_activation_silu__prompt_kernel,@function
sequential_preLN__linear_kernel_hedgehog__dense_activation_silu__prompt_kernel:
  s_load_dwordx16 s[64:79], s[0:1], 0
  s_load_dwordx2 s[80:81], s[0:1], 72
  s_getpc_b64 s[94:95]
  s_cmp_ge_u32 s2, 256
  s_cbranch_scc1 END_1
  s_and_b32 s3, s2, 7
  s_lshr_b32 s55, s2, 3
  v_lshrrev_b32 v7, 6, v0
  v_and_b32 v1, 63, v0
  s_and_b32 s44, s55, 1
  s_lshl1_add_u32 s44, s3, s44
  v_readfirstlane_b32 s46, v7
  s_add_u32 s47, s3, s55
  s_mul_i32 s49, s47, 37
  s_lshr_b32 s49, s49, 8
  s_mul_i32 s49, s49, 7
  s_sub_u32 s47, s47, s49
  s_cmp_lg_u32 s46, 5
  s_cbranch_scc1 NC_2
  s_mul_i32 s49, s55, 1408
  v_lshlrev_b32 v3, 7, v1
  v_add_u32 v3, s49, v3
  s_mov_b64 exec, 0x7ff
  global_load_dword v72, v3, s[94:95]
  s_mov_b64 exec, -1
NC_2:
  v_lshrrev_b32 v3, 3, v1
  v_mul_u32_u24 v3, 896, v3
  v_lshrrev_b32 v4, 4, v1
  v_and_b32 v28, 7, v1
  v_xor_b32 v28, v28, v4
  v_xor_b32 v29, 4, v28
  v_lshl_add_u32 v28, v28, 4, v3
  v_lshl_add_u32 v29, v29, 4, v3
  v_add_u32 v29, 6144, v29
  v_add_u32 v30, 12288, v28
  v_add_u32 v31, 12288, v29
  s_mul_i32 s89, s44, 114688
  s_mov_b32 s4, 0x10db9642
  s_mov_b32 s5, 0xfeca8753
  s_lshr_b32 s49, s55, 1
  s_lshl_b32 s49, s49, 2
  s_lshr_b64 s[4:5], s[4:5], s49
  s_and_b32 s45, s4, 15
  v_lshlrev_b32 v7, 2, v7
  v_add_u32 v7, 163328, v7
  v_mov_b32 v3, 0
  ds_write2st64_b32 v7, v3, v3 offset0:0 offset1:1
  ds_write2_b32 v7, v3, v3 offset0:16 offset1:24
  v_lshrrev_b32 v40, 2, v1
  v_mul_u32_u24 v40, 2688, v40
  v_and_b32 v4, 3, v1
  v_lshl_add_u32 v40, v4, 4, v40
  s_mul_i32 s49, s45, 56
  s_and_b32 s49, s49, 0xfffffff0
  v_add_u32 v40, s49, v40
  v_add_u32 v41, 41984, v40
  v_add_u32 v42, 83968, v40
  v_add_u32 v43, 125952, v40
  v_mov_b32 v2, 163328
  s_mov_b32 s90, 0x400000
  s_mov_b32 s48, 0
  s_mul_i32 s50, s46, 28672
  s_lshl_b32 s49, s47, 7
  s_add_u32 s49, s49, s89
  s_add_u32 s49, s49, s50
  s_lshl_b32 m0, s46, 12
  s_mov_b32 s14, 0x1c0000
  s_mov_b32 s15, 0x20000
  s_mov_b32 s18, 0x126000
  s_mov_b32 s19, 0x20000
  s_waitcnt lgkmcnt(0)
  s_mov_b64 s[12:13], s[64:65]
  s_mov_b64 s[16:17], s[66:67]
  s_mov_b32 s0, 0
  s_cmp_eq_u32 s46, 4
  s_cbranch_scc1 EW_6
  s_cmp_gt_u32 s46, 4
  s_cbranch_scc1 E7_8
  buffer_load_dwordx4 v28, s[12:15], s49 offen offset:0 lds
  buffer_load_dwordx4 v29, s[12:15], s49 offen offset:1024 lds
  buffer_load_dwordx4 v30, s[12:15], s49 offen offset:2048 lds
  buffer_load_dwordx4 v31, s[12:15], s49 offen offset:3072 lds
E7_8:
  s_cmp_lg_u32 s46, 7
  s_cbranch_scc1 EC_7
  s_setprio 2
  s_mov_b32 s100, 0
  s_mov_b32 m0, 16384
  s_mov_b32 s52, s47
  s_add_u32 s52, s52, 1
  s_cmp_eq_u32 s52, 7
  s_cselect_b32 s52, 0, s52
XL_9:
  s_lshl_b32 s49, s52, 7
  s_add_u32 s49, s49, s89
  s_waitcnt vmcnt(16)
  s_max_i32 s50, s100, 0
  v_mov_b32 v3, s50
  ds_write_b32 v7, v3
  buffer_load_dwordx4 v28, s[12:15], s49 offen offset:0 lds
  buffer_load_dwordx4 v29, s[12:15], s49 offen offset:1024 lds
  buffer_load_dwordx4 v30, s[12:15], s49 offen offset:2048 lds
  buffer_load_dwordx4 v31, s[12:15], s49 offen offset:3072 lds
  s_add_u32 m0, m0, 4096
  s_add_u32 s49, s49, 28672
  s_waitcnt vmcnt(16)
  buffer_load_dwordx4 v28, s[12:15], s49 offen offset:0 lds
  buffer_load_dwordx4 v29, s[12:15], s49 offen offset:1024 lds
  buffer_load_dwordx4 v30, s[12:15], s49 offen offset:2048 lds
  buffer_load_dwordx4 v31, s[12:15], s49 offen offset:3072 lds
  s_add_u32 m0, m0, 4096
  s_add_u32 s49, s49, 28672
  s_waitcnt vmcnt(16)
  buffer_load_dwordx4 v28, s[12:15], s49 offen offset:0 lds
  buffer_load_dwordx4 v29, s[12:15], s49 offen offset:1024 lds
  buffer_load_dwordx4 v30, s[12:15], s49 offen offset:2048 lds
  buffer_load_dwordx4 v31, s[12:15], s49 offen offset:3072 lds
  s_add_u32 m0, m0, 4096
  s_add_u32 s49, s49, 28672
  s_waitcnt vmcnt(16)
  buffer_load_dwordx4 v28, s[12:15], s49 offen offset:0 lds
  buffer_load_dwordx4 v29, s[12:15], s49 offen offset:1024 lds
  buffer_load_dwordx4 v30, s[12:15], s49 offen offset:2048 lds
  buffer_load_dwordx4 v31, s[12:15], s49 offen offset:3072 lds
  s_add_u32 m0, m0, 4096
  s_cmp_lg_u32 s100, 0
  s_cbranch_scc1 NB_10
  s_barrier
NB_10:
  s_add_u32 s52, s52, 1
  s_cmp_eq_u32 s52, 7
  s_cselect_b32 s52, 0, s52
  s_add_u32 s100, s100, 1
  s_cmp_lt_i32 s100, 6
  s_cbranch_scc1 XL_9
  s_waitcnt vmcnt(16)
  v_mov_b32 v3, 6
  ds_write_b32 v7, v3
  s_waitcnt vmcnt(0)
  v_mov_b32 v3, 7
  ds_write_b32 v7, v3
  s_branch H1_4
EW_6:
  s_setprio 2
  s_mov_b32 s52, s47
  s_mov_b32 s100, -2
  s_mov_b32 m0, 114688
WL_11:
  s_mul_i32 s49, s52, 172032
  s_add_u32 s49, s49, 896
  s_max_i32 s50, s100, 0
  s_waitcnt vmcnt(8)
  v_mov_b32 v3, s50
  ds_write_b32 v7, v3
  buffer_load_dwordx4 v40, s[16:19], s49 offen offset:0 lds
  buffer_load_dwordx4 v41, s[16:19], s49 offen offset:1024 lds
  buffer_load_dwordx4 v42, s[16:19], s49 offen offset:2048 lds
  buffer_load_dwordx4 v43, s[16:19], s49 offen offset:3072 lds
  s_add_u32 m0, m0, 4096
  s_cmp_lg_u32 s100, 0
  s_cbranch_scc1 NB_12
  s_barrier
NB_12:
  s_add_u32 s52, s52, 1
  s_cmp_eq_u32 s52, 7
  s_cselect_b32 s52, 0, s52
  s_add_u32 s100, s100, 1
  s_cmp_lt_i32 s100, 5
  s_cbranch_scc1 WL_11
  s_waitcnt vmcnt(8)
  v_mov_b32 v3, 5
  ds_write_b32 v7, v3
  s_waitcnt vmcnt(4)
  v_mov_b32 v3, 6
  ds_write_b32 v7, v3
  s_waitcnt vmcnt(0)
  v_mov_b32 v3, 7
  ds_write_b32 v7, v3
  s_branch H0_3
REFRESH_7:
  ds_read_b32 v32, v2 offset:28
  s_waitcnt lgkmcnt(0)
  v_readfirstlane_b32 s0, v32
  s_sub_u32 s90, s90, 1
  s_cselect_b32 s0, -1, s0
  s_setpc_b64 s[94:95]
REFRESH_4:
  ds_read_b32 v32, v2 offset:16
  s_waitcnt lgkmcnt(0)
  v_readfirstlane_b32 s48, v32
  s_sub_u32 s90, s90, 1
  s_cselect_b32 s48, -1, s48
  s_setpc_b64 s[94:95]
EC_7:
  s_barrier
  s_cmp_ge_u32 s46, 5
  s_cbranch_scc1 H23_5
  s_setprio 1
  s_add_u32 s82, s80, 16818176
  s_addc_u32 s83, s81, 0
  s_load_dword s53, s[82:83], 0
  s_mov_b32 s20, s68
  s_and_b32 s21, s69, 0xffff
  s_mov_b32 s22, 0x6200
  s_mov_b32 s23, 0x20000
  s_mul_i32 s96, s55, 37
  s_lshr_b32 s96, s96, 8
  s_mul_i32 s97, s96, 7
  s_sub_u32 s97, s55, s97
  s_lshr_b32 s98, s96, 1
  s_mul_i32 s99, s98, 14
  s_sub_u32 s99, s55, s99
  s_lshl2_add_u32 s96, s3, s96
  s_lshl1_add_u32 s98, s3, s98
  v_lshlrev_b32 v5, 4, v1
  s_mov_b32 s54, 0
  s_mov_b32 s51, 0x3f803f80
  s_mov_b32 s28, s70
  s_and_b32 s29, s71, 0xffff
  s_mov_b32 s30, 0x62000
  s_mov_b32 s31, 0x20000
  s_mov_b32 s32, s74
  s_and_b32 s33, s75, 0xffff
  s_mov_b32 s34, 0x188000
  s_mov_b32 s35, 0x20000
  s_mov_b32 s36, s76
  s_and_b32 s37, s77, 0xffff
  s_mov_b32 s38, 0x188000
  s_mov_b32 s39, 0x20000
  s_mov_b32 s40, s78
  s_and_b32 s41, s79, 0xffff
  s_mov_b32 s42, 0x1c0000
  s_mov_b32 s43, 0x20000
  s_mov_b32 s24, s80
  s_and_b32 s25, s81, 0xffff
  s_mov_b32 s26, 0x1200000
  s_mov_b32 s27, 0x20000
  s_lshl_b32 s91, s46, 12
  v_and_b32 v3, 31, v1
  v_lshlrev_b32 v8, 7, v3
  v_add_u32 v8, s91, v8
  v_bfe_u32 v3, v1, 1, 3
  v_lshrrev_b32 v4, 5, v1
  v_xor_b32 v3, v3, v4
  v_xor_b32 v12, 0, v3
  v_lshl_add_u32 v12, v12, 4, v8
  v_xor_b32 v13, 2, v3
  v_lshl_add_u32 v13, v13, 4, v8
  v_xor_b32 v14, 4, v3
  v_lshl_add_u32 v14, v14, 4, v8
  v_xor_b32 v15, 6, v3
  v_lshl_add_u32 v15, v15, 4, v8
  v_lshrrev_b32 v4, 5, v1
  v_bfe_u32 v3, v1, 2, 2
  v_lshl_add_u32 v3, v4, 3, v3
  v_lshlrev_b32 v3, 6, v3
  v_bfe_u32 v8, v1, 4, 1
  v_lshl_add_u32 v3, v8, 5, v3
  v_and_b32 v8, 3, v1
  v_lshl_add_u32 v3, v8, 3, v3
  v_add_u32 v16, 114688, v3
  v_add_u32 v17, 0, v3
  v_add_u32 v18, 32768, v3
  v_lshlrev_b32 v36, 3, v1
  v_add_u32 v36, 159744, v36
  v_mov_b32 v20, 0
  v_mov_b32 v21, 0
  v_mov_b32 v22, 0
  v_mov_b32 v23, 0
  v_mov_b32 v138, 0
  v_mov_b32 v139, 0
  v_mov_b32 v142, 0
  v_mov_b32 v143, 0
  s_mov_b32 s4, 0
  s_mov_b32 s5, -1
  s_bitcmp1_b32 s45, 0
  s_cselect_b32 s6, 0xf, 0xf0000000
  s_mov_b32 s7, s6
  s_cselect_b32 s8, -1, 0
  s_mov_b32 s9, 0
  s_mov_b32 s10, 0
  s_cselect_b32 s11, 0, -1
  s_cselect_b64 s[92:93], -1, 0
  v_bfe_u32 v3, v1, 2, 2
  v_lshrrev_b32 v4, 5, v1
  v_lshl_add_u32 v3, v4, 2, v3
  v_mul_u32_u24 v3, 56, v3
  v_and_b32 v4, 3, v1
  v_bfe_u32 v8, v1, 4, 1
  v_lshl_add_u32 v4, v8, 2, v4
  v_min_u32 v4, 6, v4
  v_lshl_add_u32 v3, v4, 3, v3
  s_and_b32 s49, s45, 1
  s_mul_i32 s49, s49, 224
  s_sub_u32 s49, 161280, s49
  v_add_u32 v27, s49, v3
  s_waitcnt lgkmcnt(0)
  s_mul_i32 s53, s53, 0x19660d
  s_add_u32 s53, s53, 0x3c6ef35f
  v_mov_b32 v6, s53
  s_and_b32 s100, s46, 1
  s_lshr_b32 s101, s46, 1
  s_lshl_b32 s49, s96, 1
  s_add_u32 s100, s100, s49
  v_and_b32 v39, 31, v1
  v_mul_u32_u24 v39, 896, v39
  v_lshrrev_b32 v4, 5, v1
  v_lshl_add_u32 v39, v4, 4, v39
  s_mul_i32 s49, s100, 28672
  s_lshl_b32 s50, s97, 7
  s_add_u32 s49, s49, s50
  s_lshl_b32 s50, s101, 6
  s_add_u32 s49, s49, s50
  v_add_u32 v39, s49, v39
  buffer_load_dwordx4 v[48:51], v39, s[12:15], 0 offen offset:0
  buffer_load_dwordx4 v[52:55], v39, s[12:15], 0 offen offset:32
  v_add_u32 v28, 0x10000, v12
  v_add_u32 v29, 0x10000, v13
  v_add_u32 v30, 0x10000, v14
  v_add_u32 v31, 0x10000, v15
  v_and_b32 v26, 31, v1
  s_lshl_b32 s49, s46, 8
  s_add_u32 s49, s49, 156672
  v_lshl_add_u32 v26, v26, 3, s49
  s_waitcnt vmcnt(2)
  ds_read_b128 v[144:147], v12 offset:0
  ds_read_b128 v[148:151], v13 offset:0
  ds_read_b128 v[152:155], v14 offset:0
  ds_read_b128 v[156:159], v15 offset:0
  s_getpc_b64 s[94:95]
  s_cmp_ge_u32 s48, 1
  s_cbranch_scc0 REFRESH_4
  ds_read_b64_tr_b16 v[56:57], v16 offset:0
  ds_read_b64_tr_b16 v[58:59], v16 offset:256
  ds_read_b64_tr_b16 v[60:61], v16 offset:1024
  ds_read_b64_tr_b16 v[62:63], v16 offset:1280
  ds_read_b64_tr_b16 v[64:65], v16 offset:2048
  ds_read_b64_tr_b16 v[66:67], v16 offset:2304
  ds_read_b64_tr_b16 v[68:69], v16 offset:3072
  ds_read_b64_tr_b16 v[70:71], v16 offset:3328
  ds_read_b128 v[8:11], v2 offset:16
  s_waitcnt lgkmcnt(9)
  v_dot2c_f32_bf16 v20, s51, v144
  v_dot2c_f32_bf16 v22, v144, v144
  v_dot2c_f32_bf16 v21, s51, v145
  v_dot2c_f32_bf16 v23, v145, v145
  v_dot2c_f32_bf16 v20, s51, v146
  v_dot2c_f32_bf16 v22, v146, v146
  v_dot2c_f32_bf16 v21, s51, v147
  v_dot2c_f32_bf16 v23, v147, v147
  v_dot2c_f32_bf16 v20, s51, v148
  v_dot2c_f32_bf16 v22, v148, v148
  v_dot2c_f32_bf16 v21, s51, v149
  v_dot2c_f32_bf16 v23, v149, v149
  v_dot2c_f32_bf16 v20, s51, v150
  v_dot2c_f32_bf16 v22, v150, v150
  v_dot2c_f32_bf16 v21, s51, v151
  v_dot2c_f32_bf16 v23, v151, v151
  v_dot2c_f32_bf16 v20, s51, v152
  v_dot2c_f32_bf16 v22, v152, v152
  v_dot2c_f32_bf16 v21, s51, v153
  v_dot2c_f32_bf16 v23, v153, v153
  v_dot2c_f32_bf16 v20, s51, v154
  v_dot2c_f32_bf16 v22, v154, v154
  v_dot2c_f32_bf16 v21, s51, v155
  v_dot2c_f32_bf16 v23, v155, v155
  v_dot2c_f32_bf16 v20, s51, v156
  v_dot2c_f32_bf16 v22, v156, v156
  v_dot2c_f32_bf16 v21, s51, v157
  v_dot2c_f32_bf16 v23, v157, v157
  v_dot2c_f32_bf16 v20, s51, v158
  v_dot2c_f32_bf16 v22, v158, v158
  v_dot2c_f32_bf16 v21, s51, v159
  v_dot2c_f32_bf16 v23, v159, v159
  s_waitcnt lgkmcnt(0)
  v_readfirstlane_b32 s48, v8
  v_readfirstlane_b32 s0, v11
  s_getpc_b64 s[94:95]
  s_cmp_ge_u32 s0, 2
  s_cbranch_scc0 REFRESH_7
  ds_read_b128 v[160:163], v12 offset:16384
  ds_read_b128 v[164:167], v13 offset:16384
  ds_read_b128 v[168:171], v14 offset:16384
  ds_read_b128 v[172:175], v15 offset:16384
  v_mov_b32 v3, 1
  ds_write_b32 v7, v3
  s_getpc_b64 s[94:95]
  s_cmp_ge_u32 s48, 2
  s_cbranch_scc0 REFRESH_4
  v_mfma_f32_32x32x16_bf16 v[88:103], v[56:59], v[144:147], 0
  ds_read_b64_tr_b16 v[72:73], v16 offset:4096
  ds_read_b64_tr_b16 v[74:75], v16 offset:4352
  v_mfma_f32_32x32x16_bf16 v[88:103], v[60:63], v[148:151], v[88:103]
  ds_read_b64_tr_b16 v[76:77], v16 offset:5120
  ds_read_b64_tr_b16 v[78:79], v16 offset:5376
  v_mfma_f32_32x32x16_bf16 v[88:103], v[64:67], v[152:155], v[88:103]
  ds_read_b64_tr_b16 v[80:81], v16 offset:6144
  ds_read_b64_tr_b16 v[82:83], v16 offset:6400
  v_mfma_f32_32x32x16_bf16 v[88:103], v[68:71], v[156:159], v[88:103]
  ds_read_b64_tr_b16 v[84:85], v16 offset:7168
  ds_read_b64_tr_b16 v[86:87], v16 offset:7424
  ds_read_b128 v[8:11], v2 offset:16
  s_waitcnt lgkmcnt(10)
  v_dot2c_f32_bf16 v20, s51, v160
  v_dot2c_f32_bf16 v22, v160, v160
  v_dot2c_f32_bf16 v21, s51, v161
  v_dot2c_f32_bf16 v23, v161, v161
  v_dot2c_f32_bf16 v20, s51, v162
  v_dot2c_f32_bf16 v22, v162, v162
  v_dot2c_f32_bf16 v21, s51, v163
  v_dot2c_f32_bf16 v23, v163, v163
  v_dot2c_f32_bf16 v20, s51, v164
  v_dot2c_f32_bf16 v22, v164, v164
  v_dot2c_f32_bf16 v21, s51, v165
  v_dot2c_f32_bf16 v23, v165, v165
  v_dot2c_f32_bf16 v20, s51, v166
  v_dot2c_f32_bf16 v22, v166, v166
  v_dot2c_f32_bf16 v21, s51, v167
  v_dot2c_f32_bf16 v23, v167, v167
  v_dot2c_f32_bf16 v20, s51, v168
  v_dot2c_f32_bf16 v22, v168, v168
  v_dot2c_f32_bf16 v21, s51, v169
  v_dot2c_f32_bf16 v23, v169, v169
  v_dot2c_f32_bf16 v20, s51, v170
  v_dot2c_f32_bf16 v22, v170, v170
  v_dot2c_f32_bf16 v21, s51, v171
  v_dot2c_f32_bf16 v23, v171, v171
  v_dot2c_f32_bf16 v20, s51, v172
  v_dot2c_f32_bf16 v22, v172, v172
  v_dot2c_f32_bf16 v21, s51, v173
  v_dot2c_f32_bf16 v23, v173, v173
  v_dot2c_f32_bf16 v20, s51, v174
  v_dot2c_f32_bf16 v22, v174, v174
  v_dot2c_f32_bf16 v21, s51, v175
  v_dot2c_f32_bf16 v23, v175, v175
  s_waitcnt lgkmcnt(0)
  v_readfirstlane_b32 s48, v8
  v_readfirstlane_b32 s0, v11
  s_getpc_b64 s[94:95]
  s_cmp_ge_u32 s0, 3
  s_cbranch_scc0 REFRESH_7
  ds_read_b128 v[176:179], v12 offset:32768
  ds_read_b128 v[180:183], v13 offset:32768
  ds_read_b128 v[184:187], v14 offset:32768
  ds_read_b128 v[188:191], v15 offset:32768
  s_getpc_b64 s[94:95]
  s_cmp_ge_u32 s48, 3
  s_cbranch_scc0 REFRESH_4
  v_mfma_f32_32x32x16_bf16 v[88:103], v[72:75], v[160:163], v[88:103]
  ds_read_b64_tr_b16 v[56:57], v16 offset:8192
  ds_read_b64_tr_b16 v[58:59], v16 offset:8448
  v_mfma_f32_32x32x16_bf16 v[88:103], v[76:79], v[164:167], v[88:103]
  ds_read_b64_tr_b16 v[60:61], v16 offset:9216
  ds_read_b64_tr_b16 v[62:63], v16 offset:9472
  v_mfma_f32_32x32x16_bf16 v[88:103], v[80:83], v[168:171], v[88:103]
  ds_read_b64_tr_b16 v[64:65], v16 offset:10240
  ds_read_b64_tr_b16 v[66:67], v16 offset:10496
  v_mfma_f32_32x32x16_bf16 v[88:103], v[84:87], v[172:175], v[88:103]
  ds_read_b64_tr_b16 v[68:69], v16 offset:11264
  ds_read_b64_tr_b16 v[70:71], v16 offset:11520
  ds_read_b128 v[8:11], v2 offset:16
  s_waitcnt lgkmcnt(9)
  v_dot2c_f32_bf16 v20, s51, v176
  v_dot2c_f32_bf16 v22, v176, v176
  v_dot2c_f32_bf16 v21, s51, v177
  v_dot2c_f32_bf16 v23, v177, v177
  v_dot2c_f32_bf16 v20, s51, v178
  v_dot2c_f32_bf16 v22, v178, v178
  v_dot2c_f32_bf16 v21, s51, v179
  v_dot2c_f32_bf16 v23, v179, v179
  v_dot2c_f32_bf16 v20, s51, v180
  v_dot2c_f32_bf16 v22, v180, v180
  v_dot2c_f32_bf16 v21, s51, v181
  v_dot2c_f32_bf16 v23, v181, v181
  v_dot2c_f32_bf16 v20, s51, v182
  v_dot2c_f32_bf16 v22, v182, v182
  v_dot2c_f32_bf16 v21, s51, v183
  v_dot2c_f32_bf16 v23, v183, v183
  v_dot2c_f32_bf16 v20, s51, v184
  v_dot2c_f32_bf16 v22, v184, v184
  v_dot2c_f32_bf16 v21, s51, v185
  v_dot2c_f32_bf16 v23, v185, v185
  v_dot2c_f32_bf16 v20, s51, v186
  v_dot2c_f32_bf16 v22, v186, v186
  v_dot2c_f32_bf16 v21, s51, v187
  v_dot2c_f32_bf16 v23, v187, v187
  v_dot2c_f32_bf16 v20, s51, v188
  v_dot2c_f32_bf16 v22, v188, v188
  v_dot2c_f32_bf16 v21, s51, v189
  v_dot2c_f32_bf16 v23, v189, v189
  v_dot2c_f32_bf16 v20, s51, v190
  v_dot2c_f32_bf16 v22, v190, v190
  v_dot2c_f32_bf16 v21, s51, v191
  v_dot2c_f32_bf16 v23, v191, v191
  s_waitcnt lgkmcnt(0)
  v_readfirstlane_b32 s48, v8
  v_readfirstlane_b32 s0, v11
  s_getpc_b64 s[94:95]
  s_cmp_ge_u32 s0, 4
  s_cbranch_scc0 REFRESH_7
  ds_read_b128 v[192:195], v12 offset:49152
  ds_read_b128 v[196:199], v13 offset:49152
  ds_read_b128 v[200:203], v14 offset:49152
  ds_read_b128 v[204:207], v15 offset:49152
  v_mov_b32 v3, 2
  ds_write_b32 v7, v3
  s_getpc_b64 s[94:95]
  s_cmp_ge_u32 s48, 4
  s_cbranch_scc0 REFRESH_4
  v_mfma_f32_32x32x16_bf16 v[88:103], v[56:59], v[176:179], v[88:103]
  ds_read_b64_tr_b16 v[72:73], v16 offset:12288
  ds_read_b64_tr_b16 v[74:75], v16 offset:12544
  v_mfma_f32_32x32x16_bf16 v[88:103], v[60:63], v[180:183], v[88:103]
  ds_read_b64_tr_b16 v[76:77], v16 offset:13312
  ds_read_b64_tr_b16 v[78:79], v16 offset:13568
  v_mfma_f32_32x32x16_bf16 v[88:103], v[64:67], v[184:187], v[88:103]
  ds_read_b64_tr_b16 v[80:81], v16 offset:14336
  ds_read_b64_tr_b16 v[82:83], v16 offset:14592
  v_mfma_f32_32x32x16_bf16 v[88:103], v[68:71], v[188:191], v[88:103]
  ds_read_b64_tr_b16 v[84:85], v16 offset:15360
  ds_read_b64_tr_b16 v[86:87], v16 offset:15616
  ds_read_b128 v[8:11], v2 offset:16
  s_waitcnt lgkmcnt(10)
  v_dot2c_f32_bf16 v20, s51, v192
  v_dot2c_f32_bf16 v22, v192, v192
  v_dot2c_f32_bf16 v21, s51, v193
  v_dot2c_f32_bf16 v23, v193, v193
  v_dot2c_f32_bf16 v20, s51, v194
  v_dot2c_f32_bf16 v22, v194, v194
  v_dot2c_f32_bf16 v21, s51, v195
  v_dot2c_f32_bf16 v23, v195, v195
  v_dot2c_f32_bf16 v20, s51, v196
  v_dot2c_f32_bf16 v22, v196, v196
  v_dot2c_f32_bf16 v21, s51, v197
  v_dot2c_f32_bf16 v23, v197, v197
  v_dot2c_f32_bf16 v20, s51, v198
  v_dot2c_f32_bf16 v22, v198, v198
  v_dot2c_f32_bf16 v21, s51, v199
  v_dot2c_f32_bf16 v23, v199, v199
  v_dot2c_f32_bf16 v20, s51, v200
  v_dot2c_f32_bf16 v22, v200, v200
  v_dot2c_f32_bf16 v21, s51, v201
  v_dot2c_f32_bf16 v23, v201, v201
  v_dot2c_f32_bf16 v20, s51, v202
  v_dot2c_f32_bf16 v22, v202, v202
  v_dot2c_f32_bf16 v21, s51, v203
  v_dot2c_f32_bf16 v23, v203, v203
  v_dot2c_f32_bf16 v20, s51, v204
  v_dot2c_f32_bf16 v22, v204, v204
  v_dot2c_f32_bf16 v21, s51, v205
  v_dot2c_f32_bf16 v23, v205, v205
  v_dot2c_f32_bf16 v20, s51, v206
  v_dot2c_f32_bf16 v22, v206, v206
  v_dot2c_f32_bf16 v21, s51, v207
  v_dot2c_f32_bf16 v23, v207, v207
  s_waitcnt lgkmcnt(0)
  v_readfirstlane_b32 s48, v8
  v_readfirstlane_b32 s0, v11
  s_getpc_b64 s[94:95]
  s_cmp_ge_u32 s0, 5
  s_cbranch_scc0 REFRESH_7
  ds_read_b128 v[208:211], v28 offset:0
  ds_read_b128 v[212:215], v29 offset:0
  ds_read_b128 v[216:219], v30 offset:0
  ds_read_b128 v[220:223], v31 offset:0
  s_getpc_b64 s[94:95]
  s_cmp_ge_u32 s48, 5
  s_cbranch_scc0 REFRESH_4
  v_mfma_f32_32x32x16_bf16 v[88:103], v[72:75], v[192:195], v[88:103]
  ds_read_b64_tr_b16 v[56:57], v16 offset:16384
  ds_read_b64_tr_b16 v[58:59], v16 offset:16640
  v_mfma_f32_32x32x16_bf16 v[88:103], v[76:79], v[196:199], v[88:103]
  ds_read_b64_tr_b16 v[60:61], v16 offset:17408
  ds_read_b64_tr_b16 v[62:63], v16 offset:17664
  v_mfma_f32_32x32x16_bf16 v[88:103], v[80:83], v[200:203], v[88:103]
  ds_read_b64_tr_b16 v[64:65], v16 offset:18432
  ds_read_b64_tr_b16 v[66:67], v16 offset:18688
  v_mfma_f32_32x32x16_bf16 v[88:103], v[84:87], v[204:207], v[88:103]
  ds_read_b64_tr_b16 v[68:69], v16 offset:19456
  ds_read_b64_tr_b16 v[70:71], v16 offset:19712
  ds_read_b128 v[8:11], v2 offset:16
  s_waitcnt lgkmcnt(9)
  v_dot2c_f32_bf16 v20, s51, v208
  v_dot2c_f32_bf16 v22, v208, v208
  v_dot2c_f32_bf16 v21, s51, v209
  v_dot2c_f32_bf16 v23, v209, v209
  v_dot2c_f32_bf16 v20, s51, v210
  v_dot2c_f32_bf16 v22, v210, v210
  v_dot2c_f32_bf16 v21, s51, v211
  v_dot2c_f32_bf16 v23, v211, v211
  v_dot2c_f32_bf16 v20, s51, v212
  v_dot2c_f32_bf16 v22, v212, v212
  v_dot2c_f32_bf16 v21, s51, v213
  v_dot2c_f32_bf16 v23, v213, v213
  v_dot2c_f32_bf16 v20, s51, v214
  v_dot2c_f32_bf16 v22, v214, v214
  v_dot2c_f32_bf16 v21, s51, v215
  v_dot2c_f32_bf16 v23, v215, v215
  v_dot2c_f32_bf16 v20, s51, v216
  v_dot2c_f32_bf16 v22, v216, v216
  v_dot2c_f32_bf16 v21, s51, v217
  v_dot2c_f32_bf16 v23, v217, v217
  v_dot2c_f32_bf16 v20, s51, v218
  v_dot2c_f32_bf16 v22, v218, v218
  v_dot2c_f32_bf16 v21, s51, v219
  v_dot2c_f32_bf16 v23, v219, v219
  v_dot2c_f32_bf16 v20, s51, v220
  v_dot2c_f32_bf16 v22, v220, v220
  v_dot2c_f32_bf16 v21, s51, v221
  v_dot2c_f32_bf16 v23, v221, v221
  v_dot2c_f32_bf16 v20, s51, v222
  v_dot2c_f32_bf16 v22, v222, v222
  v_dot2c_f32_bf16 v21, s51, v223
  v_dot2c_f32_bf16 v23, v223, v223
  s_waitcnt lgkmcnt(0)
  v_readfirstlane_b32 s48, v8
  v_readfirstlane_b32 s0, v11
  s_getpc_b64 s[94:95]
  s_cmp_ge_u32 s0, 6
  s_cbranch_scc0 REFRESH_7
  ds_read_b128 v[224:227], v28 offset:16384
  ds_read_b128 v[228:231], v29 offset:16384
  ds_read_b128 v[232:235], v30 offset:16384
  ds_read_b128 v[236:239], v31 offset:16384
  s_getpc_b64 s[94:95]
  s_cmp_ge_u32 s48, 6
  s_cbranch_scc0 REFRESH_4
  v_mfma_f32_32x32x16_bf16 v[88:103], v[56:59], v[208:211], v[88:103]
  ds_read_b64_tr_b16 v[72:73], v16 offset:20480
  ds_read_b64_tr_b16 v[74:75], v16 offset:20736
  v_mfma_f32_32x32x16_bf16 v[88:103], v[60:63], v[212:215], v[88:103]
  ds_read_b64_tr_b16 v[76:77], v16 offset:21504
  ds_read_b64_tr_b16 v[78:79], v16 offset:21760
  v_mfma_f32_32x32x16_bf16 v[88:103], v[64:67], v[216:219], v[88:103]
  ds_read_b64_tr_b16 v[80:81], v16 offset:22528
  ds_read_b64_tr_b16 v[82:83], v16 offset:22784
  v_mfma_f32_32x32x16_bf16 v[88:103], v[68:71], v[220:223], v[88:103]
  ds_read_b64_tr_b16 v[84:85], v16 offset:23552
  ds_read_b64_tr_b16 v[86:87], v16 offset:23808
  ds_read_b128 v[8:11], v2 offset:16
  s_waitcnt lgkmcnt(9)
  v_dot2c_f32_bf16 v20, s51, v224
  v_dot2c_f32_bf16 v22, v224, v224
  v_dot2c_f32_bf16 v21, s51, v225
  v_dot2c_f32_bf16 v23, v225, v225
  v_dot2c_f32_bf16 v20, s51, v226
  v_dot2c_f32_bf16 v22, v226, v226
  v_dot2c_f32_bf16 v21, s51, v227
  v_dot2c_f32_bf16 v23, v227, v227
  v_dot2c_f32_bf16 v20, s51, v228
  v_dot2c_f32_bf16 v22, v228, v228
  v_dot2c_f32_bf16 v21, s51, v229
  v_dot2c_f32_bf16 v23, v229, v229
  v_dot2c_f32_bf16 v20, s51, v230
  v_dot2c_f32_bf16 v22, v230, v230
  v_dot2c_f32_bf16 v21, s51, v231
  v_dot2c_f32_bf16 v23, v231, v231
  v_dot2c_f32_bf16 v20, s51, v232
  v_dot2c_f32_bf16 v22, v232, v232
  v_dot2c_f32_bf16 v21, s51, v233
  v_dot2c_f32_bf16 v23, v233, v233
  v_dot2c_f32_bf16 v20, s51, v234
  v_dot2c_f32_bf16 v22, v234, v234
  v_dot2c_f32_bf16 v21, s51, v235
  v_dot2c_f32_bf16 v23, v235, v235
  v_dot2c_f32_bf16 v20, s51, v236
  v_dot2c_f32_bf16 v22, v236, v236
  v_dot2c_f32_bf16 v21, s51, v237
  v_dot2c_f32_bf16 v23, v237, v237
  v_dot2c_f32_bf16 v20, s51, v238
  v_dot2c_f32_bf16 v22, v238, v238
  v_dot2c_f32_bf16 v21, s51, v239
  v_dot2c_f32_bf16 v23, v239, v239
  s_waitcnt lgkmcnt(0)
  v_readfirstlane_b32 s48, v8
  v_readfirstlane_b32 s0, v11
  s_getpc_b64 s[94:95]
  s_cmp_ge_u32 s0, 7
  s_cbranch_scc0 REFRESH_7
  ds_read_b128 v[240:243], v28 offset:32768
  ds_read_b128 v[244:247], v29 offset:32768
  ds_read_b128 v[248:251], v30 offset:32768
  ds_read_b128 v[252:255], v31 offset:32768
  s_getpc_b64 s[94:95]
  s_cmp_ge_u32 s48, 7
  s_cbranch_scc0 REFRESH_4
  v_mfma_f32_32x32x16_bf16 v[88:103], v[72:75], v[224:227], v[88:103]
  ds_read_b64_tr_b16 v[56:57], v16 offset:24576
  ds_read_b64_tr_b16 v[58:59], v16 offset:24832
  v_mfma_f32_32x32x16_bf16 v[88:103], v[76:79], v[228:231], v[88:103]
  ds_read_b64_tr_b16 v[60:61], v16 offset:25600
  ds_read_b64_tr_b16 v[62:63], v16 offset:25856
  v_mfma_f32_32x32x16_bf16 v[88:103], v[80:83], v[232:235], v[88:103]
  ds_read_b64_tr_b16 v[64:65], v16 offset:26624
  ds_read_b64_tr_b16 v[66:67], v16 offset:26880
  v_mfma_f32_32x32x16_bf16 v[88:103], v[84:87], v[236:239], v[88:103]
  ds_read_b64_tr_b16 v[68:69], v16 offset:27648
  ds_read_b64_tr_b16 v[70:71], v16 offset:27904
  s_waitcnt lgkmcnt(8)
  v_dot2c_f32_bf16 v20, s51, v240
  v_dot2c_f32_bf16 v22, v240, v240
  v_dot2c_f32_bf16 v21, s51, v241
  v_dot2c_f32_bf16 v23, v241, v241
  v_dot2c_f32_bf16 v20, s51, v242
  v_dot2c_f32_bf16 v22, v242, v242
  v_dot2c_f32_bf16 v21, s51, v243
  v_dot2c_f32_bf16 v23, v243, v243
  v_dot2c_f32_bf16 v20, s51, v244
  v_dot2c_f32_bf16 v22, v244, v244
  v_dot2c_f32_bf16 v21, s51, v245
  v_dot2c_f32_bf16 v23, v245, v245
  v_dot2c_f32_bf16 v20, s51, v246
  v_dot2c_f32_bf16 v22, v246, v246
  v_dot2c_f32_bf16 v21, s51, v247
  v_dot2c_f32_bf16 v23, v247, v247
  v_dot2c_f32_bf16 v20, s51, v248
  v_dot2c_f32_bf16 v22, v248, v248
  v_dot2c_f32_bf16 v21, s51, v249
  v_dot2c_f32_bf16 v23, v249, v249
  v_dot2c_f32_bf16 v20, s51, v250
  v_dot2c_f32_bf16 v22, v250, v250
  v_dot2c_f32_bf16 v21, s51, v251
  v_dot2c_f32_bf16 v23, v251, v251
  v_dot2c_f32_bf16 v20, s51, v252
  v_dot2c_f32_bf16 v22, v252, v252
  v_dot2c_f32_bf16 v21, s51, v253
  v_dot2c_f32_bf16 v23, v253, v253
  v_dot2c_f32_bf16 v20, s51, v254
  v_dot2c_f32_bf16 v22, v254, v254
  v_dot2c_f32_bf16 v21, s51, v255
  v_dot2c_f32_bf16 v23, v255, v255
  v_mov_b32 v3, 3
  ds_write_b32 v7, v3
  ds_read_b32 v38, v2 offset:20
  ds_read_b64 v[140:141], v36 offset:0
  ds_read_b64_tr_b16 v[40:41], v27 offset:0
  ds_read_b64_tr_b16 v[42:43], v27 offset:448
  ds_read_b64_tr_b16 v[44:45], v27 offset:896
  ds_read_b64_tr_b16 v[46:47], v27 offset:1344
  s_waitcnt lgkmcnt(13)
  v_mfma_f32_32x32x16_bf16 v[88:103], v[56:59], v[240:243], v[88:103]
  v_add_f32 v20, v20, v21
  v_add_f32 v22, v22, v23
  s_nop 1
  v_permlane32_swap_b32 v20, v22
  v_add_f32 v3, v20, v22
  v_mul_f32 v3, 0x3b124925, v3
  s_waitcnt lgkmcnt(11)
  v_mfma_f32_32x32x16_bf16 v[88:103], v[60:63], v[244:247], v[88:103]
  v_mov_b32 v4, v3
  s_nop 1
  v_permlane32_swap_b32 v3, v4
  v_fma_f32 v4, -v3, v3, v4
  v_max_f32 v4, 0, v4
  s_waitcnt lgkmcnt(9)
  v_mfma_f32_32x32x16_bf16 v[88:103], v[64:67], v[248:251], v[88:103]
  v_add_f32 v4, 0x3727c5ac, v4
  v_rsq_f32 v25, v4
  v_sub_f32 v24, 0, v3
  v_cvt_pk_bf16_f32 v137, v24, 0
  s_waitcnt lgkmcnt(7)
  v_mfma_f32_32x32x16_bf16 v[88:103], v[68:71], v[252:255], v[88:103]
  v_lshlrev_b32 v3, 16, v137
  v_sub_f32 v3, v24, v3
  v_cvt_pk_bf16_f32 v136, v24, v3
  v_mul_f32 v26, 0x3fb8aa3b, v25
  s_waitcnt lgkmcnt(0)
  v_readfirstlane_b32 s49, v38
  s_cmp_ge_u32 s49, 1
  s_cbranch_scc1 LT_157
W_159:
  ds_read_b32 v32, v2 offset:20
  ds_read_b64 v[140:141], v36 offset:0
  ds_read_b64_tr_b16 v[40:41], v27 offset:0
  ds_read_b64_tr_b16 v[42:43], v27 offset:448
  ds_read_b64_tr_b16 v[44:45], v27 offset:896
  ds_read_b64_tr_b16 v[46:47], v27 offset:1344
  s_waitcnt lgkmcnt(0)
  v_readfirstlane_b32 s49, v32
  s_sub_u32 s90, s90, 1
  s_cbranch_scc1 WD_158
  s_cmp_ge_u32 s49, 1
  s_cbranch_scc0 W_159
WD_158:
LT_157:
  v_add_u32 v28, s91, v5
  v_add_u32 v28, 65536, v28
  v_mfma_f32_32x32x16_bf16 v[88:103], v[140:143], v[136:139], v[88:103]
  v_and_b32 v3, 31, v1
  s_lshl_b32 s49, s46, 7
  s_add_u32 s49, s49, 155648
  v_lshl_add_u32 v3, v3, 2, s49
  ds_write_b32 v3, v25
  v_lshrrev_b32 v27, 5, v1
  v_lshl_add_u32 v27, v27, 4, s49
  v_cndmask_b32 v40, v40, 0, s[8:9]
  v_cndmask_b32 v46, v46, 0, s[10:11]
  v_cndmask_b32 v41, v41, 0, s[8:9]
  v_cndmask_b32 v47, v47, 0, s[10:11]
  s_nop 0
  v_cvt_pk_bf16_f32 v120, v88, v89
  v_cvt_pk_bf16_f32 v121, v90, v91
  v_cvt_pk_bf16_f32 v122, v92, v93
  v_cvt_pk_bf16_f32 v123, v94, v95
  v_cvt_pk_bf16_f32 v124, v96, v97
  v_cvt_pk_bf16_f32 v125, v98, v99
  v_cvt_pk_bf16_f32 v126, v100, v101
  v_cvt_pk_bf16_f32 v127, v102, v103
  v_mfma_f32_32x32x16_bf16 v[88:103], v[40:43], v[120:123], 0
  s_nop 0
  v_mfma_f32_32x32x16_bf16 v[88:103], v[44:47], v[124:127], v[88:103]
  s_nop 11
  v_cndmask_b32 v100, v100, v102, s[4:5]
  v_cndmask_b32 v101, v101, v103, s[4:5]
  v_max3_f32 v8, v88, v89, v90
  v_min3_f32 v9, v88, v89, v90
  v_max3_f32 v8, v8, v91, v92
  v_min3_f32 v9, v9, v91, v92
  v_max3_f32 v8, v8, v93, v94
  v_min3_f32 v9, v9, v93, v94
  v_max3_f32 v8, v8, v95, v96
  v_min3_f32 v9, v9, v95, v96
  v_max3_f32 v8, v8, v97, v98
  v_min3_f32 v9, v9, v97, v98
  v_max3_f32 v8, v8, v99, v100
  v_min3_f32 v9, v9, v99, v100
  v_max_f32 v8, v8, v101
  v_min_f32 v9, v9, v101
  v_sub_f32 v9, 0, v9
  s_nop 1
  v_permlane32_swap_b32 v8, v9
  v_max_f32 v8, v8, v9
  v_mul_f32 v8, v8, v26
  v_mov_b32 v9, v8
  s_nop 1
  v_permlane32_swap_b32 v8, v9
  v_pk_fma_f32 v[120:121], v[88:89], v[26:27], v[8:9] op_sel:[0,0,1] op_sel_hi:[1,0,1] neg_lo:[1,0,1] neg_hi:[1,0,1]
  v_pk_fma_f32 v[88:89], v[88:89], v[26:27], v[8:9] op_sel_hi:[1,0,0] neg_lo:[0,0,1] neg_hi:[0,0,1]
  v_pk_fma_f32 v[122:123], v[90:91], v[26:27], v[8:9] op_sel:[0,0,1] op_sel_hi:[1,0,1] neg_lo:[1,0,1] neg_hi:[1,0,1]
  v_pk_fma_f32 v[90:91], v[90:91], v[26:27], v[8:9] op_sel_hi:[1,0,0] neg_lo:[0,0,1] neg_hi:[0,0,1]
  v_pk_fma_f32 v[124:125], v[92:93], v[26:27], v[8:9] op_sel:[0,0,1] op_sel_hi:[1,0,1] neg_lo:[1,0,1] neg_hi:[1,0,1]
  v_pk_fma_f32 v[92:93], v[92:93], v[26:27], v[8:9] op_sel_hi:[1,0,0] neg_lo:[0,0,1] neg_hi:[0,0,1]
  v_pk_fma_f32 v[126:127], v[94:95], v[26:27], v[8:9] op_sel:[0,0,1] op_sel_hi:[1,0,1] neg_lo:[1,0,1] neg_hi:[1,0,1]
  v_pk_fma_f32 v[94:95], v[94:95], v[26:27], v[8:9] op_sel_hi:[1,0,0] neg_lo:[0,0,1] neg_hi:[0,0,1]
  v_pk_fma_f32 v[128:129], v[96:97], v[26:27], v[8:9] op_sel:[0,0,1] op_sel_hi:[1,0,1] neg_lo:[1,0,1] neg_hi:[1,0,1]
  v_pk_fma_f32 v[96:97], v[96:97], v[26:27], v[8:9] op_sel_hi:[1,0,0] neg_lo:[0,0,1] neg_hi:[0,0,1]
  v_pk_fma_f32 v[130:131], v[98:99], v[26:27], v[8:9] op_sel:[0,0,1] op_sel_hi:[1,0,1] neg_lo:[1,0,1] neg_hi:[1,0,1]
  v_pk_fma_f32 v[98:99], v[98:99], v[26:27], v[8:9] op_sel_hi:[1,0,0] neg_lo:[0,0,1] neg_hi:[0,0,1]
  v_pk_fma_f32 v[132:133], v[100:101], v[26:27], v[8:9] op_sel:[0,0,1] op_sel_hi:[1,0,1] neg_lo:[1,0,1] neg_hi:[1,0,1]
  v_pk_fma_f32 v[100:101], v[100:101], v[26:27], v[8:9] op_sel_hi:[1,0,0] neg_lo:[0,0,1] neg_hi:[0,0,1]
  v_exp_f32 v120, v120
  v_exp_f32 v88, v88
  v_exp_f32 v121, v121
  v_exp_f32 v89, v89
  v_exp_f32 v122, v122
  v_exp_f32 v90, v90
  v_exp_f32 v123, v123
  v_exp_f32 v91, v91
  v_exp_f32 v124, v124
  v_exp_f32 v92, v92
  v_exp_f32 v125, v125
  v_exp_f32 v93, v93
  v_exp_f32 v126, v126
  v_exp_f32 v94, v94
  v_exp_f32 v127, v127
  v_exp_f32 v95, v95
  v_exp_f32 v128, v128
  v_exp_f32 v96, v96
  v_exp_f32 v129, v129
  v_exp_f32 v97, v97
  v_exp_f32 v130, v130
  v_exp_f32 v98, v98
  v_exp_f32 v131, v131
  v_exp_f32 v99, v99
  v_exp_f32 v132, v132
  v_exp_f32 v100, v100
  v_exp_f32 v133, v133
  v_exp_f32 v101, v101
  v_pk_add_f32 v[102:103], v[88:89], v[90:91]
  v_pk_add_f32 v[134:135], v[120:121], v[122:123]
  v_pk_add_f32 v[102:103], v[102:103], v[92:93]
  v_pk_add_f32 v[134:135], v[134:135], v[124:125]
  v_pk_add_f32 v[102:103], v[102:103], v[94:95]
  v_pk_add_f32 v[134:135], v[134:135], v[126:127]
  v_pk_add_f32 v[102:103], v[102:103], v[96:97]
  v_pk_add_f32 v[134:135], v[134:135], v[128:129]
  v_pk_add_f32 v[102:103], v[102:103], v[98:99]
  v_pk_add_f32 v[134:135], v[134:135], v[130:131]
  v_pk_add_f32 v[102:103], v[102:103], v[100:101]
  v_pk_add_f32 v[134:135], v[134:135], v[132:133]
  v_add_f32 v10, v102, v103
  v_add_f32 v8, v134, v135
  s_nop 1
  v_permlane32_swap_b32 v10, v8
  v_add_f32 v10, v10, v8
  v_rcp_f32 v10, v10
  s_nop 0
  v_mov_b32 v8, v10
  s_nop 1
  v_permlane32_swap_b32 v10, v8
  s_getpc_b64 s[94:95]
  s_cmp_ge_u32 s48, 8
  s_cbranch_scc0 REFRESH_4
  ds_read_b64_tr_b16 v[56:57], v17 offset:0
  ds_read_b64_tr_b16 v[58:59], v17 offset:256
  ds_read_b64_tr_b16 v[60:61], v17 offset:1024
  ds_read_b64_tr_b16 v[62:63], v17 offset:1280
  ds_read_b64_tr_b16 v[64:65], v17 offset:2048
  ds_read_b64_tr_b16 v[66:67], v17 offset:2304
  ds_read_b64_tr_b16 v[68:69], v17 offset:3072
  ds_read_b64_tr_b16 v[70:71], v17 offset:3328
  v_pk_mul_f32 v[88:89], v[88:89], v[10:11] op_sel_hi:[1,0]
  v_pk_mul_f32 v[120:121], v[120:121], v[8:9] op_sel_hi:[1,0]
  v_pk_mul_f32 v[90:91], v[90:91], v[10:11] op_sel_hi:[1,0]
  v_pk_mul_f32 v[122:123], v[122:123], v[8:9] op_sel_hi:[1,0]
  v_pk_mul_f32 v[92:93], v[92:93], v[10:11] op_sel_hi:[1,0]
  v_pk_mul_f32 v[124:125], v[124:125], v[8:9] op_sel_hi:[1,0]
  v_pk_mul_f32 v[94:95], v[94:95], v[10:11] op_sel_hi:[1,0]
  v_pk_mul_f32 v[126:127], v[126:127], v[8:9] op_sel_hi:[1,0]
  v_pk_mul_f32 v[96:97], v[96:97], v[10:11] op_sel_hi:[1,0]
  v_pk_mul_f32 v[128:129], v[128:129], v[8:9] op_sel_hi:[1,0]
  v_pk_mul_f32 v[98:99], v[98:99], v[10:11] op_sel_hi:[1,0]
  v_pk_mul_f32 v[130:131], v[130:131], v[8:9] op_sel_hi:[1,0]
  v_pk_mul_f32 v[100:101], v[100:101], v[10:11] op_sel_hi:[1,0]
  v_pk_mul_f32 v[132:133], v[132:133], v[8:9] op_sel_hi:[1,0]
  v_cvt_pk_bf16_f32 v88, v88, v89
  v_cvt_pk_bf16_f32 v120, v120, v121
  v_cvt_pk_bf16_f32 v89, v90, v91
  v_cvt_pk_bf16_f32 v121, v122, v123
  v_cvt_pk_bf16_f32 v90, v92, v93
  v_cvt_pk_bf16_f32 v122, v124, v125
  v_cvt_pk_bf16_f32 v91, v94, 0
  v_cvt_pk_bf16_f32 v123, v126, 0
  v_cvt_pk_bf16_f32 v92, v95, v96
  v_cvt_pk_bf16_f32 v124, v127, v128
  v_cvt_pk_bf16_f32 v93, v97, v98
  v_cvt_pk_bf16_f32 v125, v129, v130
  v_cvt_pk_bf16_f32 v94, v99, v100
  v_cvt_pk_bf16_f32 v126, v131, v132
  v_cvt_pk_bf16_f32 v95, v101, 0
  v_cvt_pk_bf16_f32 v127, v133, 0
  ds_write_b128 v28, v[88:91] offset:0
  ds_write_b128 v28, v[92:95] offset:1024
  ds_write_b128 v28, v[120:123] offset:2048
  ds_write_b128 v28, v[124:127] offset:3072
  v_mov_b32 v3, 4
  ds_write_b32 v7, v3
  ds_read_b128 v[88:91], v27 offset:0
  ds_read_b128 v[92:95], v27 offset:32
  ds_read_b128 v[96:99], v27 offset:64
  ds_read_b128 v[100:103], v27 offset:96
  s_waitcnt lgkmcnt(15)
  v_mfma_f32_32x32x16_bf16 v[104:119], v[144:147], v[56:59], 0
  s_getpc_b64 s[94:95]
  s_cmp_ge_u32 s48, 9
  s_cbranch_scc0 REFRESH_4
  ds_read_b32 v37, v2 offset:16
  ds_read_b64_tr_b16 v[72:73], v17 offset:4096
  ds_read_b64_tr_b16 v[74:75], v17 offset:4352
  s_waitcnt lgkmcnt(15)
  v_mfma_f32_32x32x16_bf16 v[104:119], v[148:151], v[60:63], v[104:119]
  ds_read_b64_tr_b16 v[76:77], v17 offset:5120
  ds_read_b64_tr_b16 v[78:79], v17 offset:5376
  s_waitcnt lgkmcnt(15)
  v_mfma_f32_32x32x16_bf16 v[104:119], v[152:155], v[64:67], v[104:119]
  ds_read_b64_tr_b16 v[80:81], v17 offset:6144
  ds_read_b64_tr_b16 v[82:83], v17 offset:6400
  s_waitcnt lgkmcnt(15)
  v_mfma_f32_32x32x16_bf16 v[104:119], v[156:159], v[68:71], v[104:119]
  ds_read_b64_tr_b16 v[84:85], v17 offset:7168
  ds_read_b64_tr_b16 v[86:87], v17 offset:7424
  s_waitcnt lgkmcnt(6)
  v_readfirstlane_b32 s48, v37
  v_mfma_f32_32x32x16_bf16 v[104:119], v[160:163], v[72:75], v[104:119]
  s_getpc_b64 s[94:95]
  s_cmp_ge_u32 s48, 10
  s_cbranch_scc0 REFRESH_4
  ds_read_b32 v37, v2 offset:16
  ds_read_b64_tr_b16 v[56:57], v17 offset:8192
  ds_read_b64_tr_b16 v[58:59], v17 offset:8448
  s_waitcnt lgkmcnt(7)
  v_mfma_f32_32x32x16_bf16 v[104:119], v[164:167], v[76:79], v[104:119]
  ds_read_b64_tr_b16 v[60:61], v17 offset:9216
  ds_read_b64_tr_b16 v[62:63], v17 offset:9472
  s_waitcnt lgkmcnt(7)
  v_mfma_f32_32x32x16_bf16 v[104:119], v[168:171], v[80:83], v[104:119]
  ds_read_b64_tr_b16 v[64:65], v17 offset:10240
  ds_read_b64_tr_b16 v[66:67], v17 offset:10496
  s_waitcnt lgkmcnt(7)
  v_mfma_f32_32x32x16_bf16 v[104:119], v[172:175], v[84:87], v[104:119]
  ds_read_b64_tr_b16 v[68:69], v17 offset:11264
  ds_read_b64_tr_b16 v[70:71], v17 offset:11520
  s_waitcnt lgkmcnt(6)
  v_readfirstlane_b32 s48, v37
  v_mfma_f32_32x32x16_bf16 v[104:119], v[176:179], v[56:59], v[104:119]
  s_getpc_b64 s[94:95]
  s_cmp_ge_u32 s48, 11
  s_cbranch_scc0 REFRESH_4
  ds_read_b32 v37, v2 offset:16
  ds_read_b64_tr_b16 v[72:73], v17 offset:12288
  ds_read_b64_tr_b16 v[74:75], v17 offset:12544
  s_waitcnt lgkmcnt(7)
  v_mfma_f32_32x32x16_bf16 v[104:119], v[180:183], v[60:63], v[104:119]
  ds_read_b64_tr_b16 v[76:77], v17 offset:13312
  ds_read_b64_tr_b16 v[78:79], v17 offset:13568
  s_waitcnt lgkmcnt(7)
  v_mfma_f32_32x32x16_bf16 v[104:119], v[184:187], v[64:67], v[104:119]
  ds_read_b64_tr_b16 v[80:81], v17 offset:14336
  ds_read_b64_tr_b16 v[82:83], v17 offset:14592
  s_waitcnt lgkmcnt(7)
  v_mfma_f32_32x32x16_bf16 v[104:119], v[188:191], v[68:71], v[104:119]
  ds_read_b64_tr_b16 v[84:85], v17 offset:15360
  ds_read_b64_tr_b16 v[86:87], v17 offset:15616
  s_waitcnt lgkmcnt(6)
  v_readfirstlane_b32 s48, v37
  v_mfma_f32_32x32x16_bf16 v[104:119], v[192:195], v[72:75], v[104:119]
  s_getpc_b64 s[94:95]
  s_cmp_ge_u32 s48, 12
  s_cbranch_scc0 REFRESH_4
  ds_read_b32 v37, v2 offset:16
  ds_read_b64_tr_b16 v[56:57], v17 offset:16384
  ds_read_b64_tr_b16 v[58:59], v17 offset:16640
  s_waitcnt lgkmcnt(7)
  v_mfma_f32_32x32x16_bf16 v[104:119], v[196:199], v[76:79], v[104:119]
  ds_read_b64_tr_b16 v[60:61], v17 offset:17408
  ds_read_b64_tr_b16 v[62:63], v17 offset:17664
  s_waitcnt lgkmcnt(7)
  v_mfma_f32_32x32x16_bf16 v[104:119], v[200:203], v[80:83], v[104:119]
  ds_read_b64_tr_b16 v[64:65], v17 offset:18432
  ds_read_b64_tr_b16 v[66:67], v17 offset:18688
  s_waitcnt lgkmcnt(7)
  v_mfma_f32_32x32x16_bf16 v[104:119], v[204:207], v[84:87], v[104:119]
  ds_read_b64_tr_b16 v[68:69], v17 offset:19456
  ds_read_b64_tr_b16 v[70:71], v17 offset:19712
  s_waitcnt lgkmcnt(6)
  v_readfirstlane_b32 s48, v37
  v_mfma_f32_32x32x16_bf16 v[104:119], v[208:211], v[56:59], v[104:119]
  s_getpc_b64 s[94:95]
  s_cmp_ge_u32 s48, 13
  s_cbranch_scc0 REFRESH_4
  ds_read_b32 v37, v2 offset:16
  ds_read_b64_tr_b16 v[72:73], v17 offset:20480
  ds_read_b64_tr_b16 v[74:75], v17 offset:20736
  s_waitcnt lgkmcnt(7)
  v_mfma_f32_32x32x16_bf16 v[104:119], v[212:215], v[60:63], v[104:119]
  ds_read_b64_tr_b16 v[76:77], v17 offset:21504
  ds_read_b64_tr_b16 v[78:79], v17 offset:21760
  s_waitcnt lgkmcnt(7)
  v_mfma_f32_32x32x16_bf16 v[104:119], v[216:219], v[64:67], v[104:119]
  ds_read_b64_tr_b16 v[80:81], v17 offset:22528
  ds_read_b64_tr_b16 v[82:83], v17 offset:22784
  s_waitcnt lgkmcnt(7)
  v_mfma_f32_32x32x16_bf16 v[104:119], v[220:223], v[68:71], v[104:119]
  ds_read_b64_tr_b16 v[84:85], v17 offset:23552
  ds_read_b64_tr_b16 v[86:87], v17 offset:23808
  s_waitcnt lgkmcnt(6)
  v_readfirstlane_b32 s48, v37
  v_mfma_f32_32x32x16_bf16 v[104:119], v[224:227], v[72:75], v[104:119]
  s_getpc_b64 s[94:95]
  s_cmp_ge_u32 s48, 14
  s_cbranch_scc0 REFRESH_4
  ds_read_b64_tr_b16 v[56:57], v17 offset:24576
  ds_read_b64_tr_b16 v[58:59], v17 offset:24832
  s_waitcnt lgkmcnt(6)
  v_mfma_f32_32x32x16_bf16 v[104:119], v[228:231], v[76:79], v[104:119]
  ds_read_b64_tr_b16 v[60:61], v17 offset:25600
  ds_read_b64_tr_b16 v[62:63], v17 offset:25856
  s_waitcnt lgkmcnt(6)
  v_mfma_f32_32x32x16_bf16 v[104:119], v[232:235], v[80:83], v[104:119]
  ds_read_b64_tr_b16 v[64:65], v17 offset:26624
  ds_read_b64_tr_b16 v[66:67], v17 offset:26880
  s_waitcnt lgkmcnt(6)
  v_mfma_f32_32x32x16_bf16 v[104:119], v[236:239], v[84:87], v[104:119]
  ds_read_b64_tr_b16 v[68:69], v17 offset:27648
  ds_read_b64_tr_b16 v[70:71], v17 offset:27904
  ds_read_b32 v38, v2 offset:28
  ds_read_b64 v[140:141], v36 offset:512
  s_waitcnt lgkmcnt(8)
  v_mfma_f32_32x32x16_bf16 v[104:119], v[240:243], v[56:59], v[104:119]
  s_waitcnt lgkmcnt(6)
  v_mfma_f32_32x32x16_bf16 v[104:119], v[244:247], v[60:63], v[104:119]
  s_waitcnt lgkmcnt(4)
  v_mfma_f32_32x32x16_bf16 v[104:119], v[248:251], v[64:67], v[104:119]
  s_waitcnt lgkmcnt(2)
  v_mfma_f32_32x32x16_bf16 v[104:119], v[252:255], v[68:71], v[104:119]
  s_waitcnt lgkmcnt(0)
  v_readfirstlane_b32 s49, v38
  s_cmp_ge_u32 s49, 8
  s_cbranch_scc1 LT_160
W_162:
  ds_read_b32 v32, v2 offset:28
  ds_read_b64 v[140:141], v36 offset:512
  s_waitcnt lgkmcnt(0)
  v_readfirstlane_b32 s49, v32
  s_sub_u32 s90, s90, 1
  s_cbranch_scc1 WD_161
  s_cmp_ge_u32 s49, 8
  s_cbranch_scc0 W_162
WD_161:
LT_160:
  v_mfma_f32_32x32x16_bf16 v[104:119], v[136:139], v[140:143], v[104:119]
  v_mov_b32 v4, 0x3f803f80
  s_nop 10
  v_pk_mul_f32 v[104:105], v[104:105], v[88:89]
  v_pk_mul_f32 v[106:107], v[106:107], v[90:91]
  v_pk_mul_f32 v[108:109], v[108:109], v[92:93]
  v_pk_mul_f32 v[110:111], v[110:111], v[94:95]
  v_pk_mul_f32 v[112:113], v[112:113], v[96:97]
  v_pk_mul_f32 v[114:115], v[114:115], v[98:99]
  v_pk_mul_f32 v[116:117], v[116:117], v[100:101]
  v_pk_mul_f32 v[118:119], v[118:119], v[102:103]
  v_cvt_pk_bf16_f32 v120, v104, v105
  v_cvt_pk_bf16_f32 v121, v106, v107
  v_cvt_pk_bf16_f32 v122, v108, v109
  v_cvt_pk_bf16_f32 v123, v110, v111
  v_cvt_pk_bf16_f32 v124, v112, v113
  v_cvt_pk_bf16_f32 v125, v114, v115
  v_cvt_pk_bf16_f32 v126, v116, v117
  v_cvt_pk_bf16_f32 v127, v118, v119
  v_cndmask_b32 v120, v120, v4, s[6:7]
  v_cndmask_b32 v121, v121, v4, s[6:7]
  v_cndmask_b32 v122, v122, v4, s[6:7]
  v_cndmask_b32 v123, v123, v4, s[6:7]
  v_cndmask_b32 v124, v124, v4, s[6:7]
  v_cndmask_b32 v125, v125, v4, s[6:7]
  v_cndmask_b32 v126, v126, v4, s[6:7]
  v_cndmask_b32 v127, v127, v4, s[6:7]
  ds_write_b128 v28, v[120:123] offset:16384
  ds_write_b128 v28, v[124:127] offset:17408
  v_mov_b32 v3, 5
  ds_write_b32 v7, v3
  s_getpc_b64 s[94:95]
  s_cmp_ge_u32 s48, 15
  s_cbranch_scc0 REFRESH_4
  ds_read_b64_tr_b16 v[56:57], v18 offset:0
  ds_read_b64_tr_b16 v[58:59], v18 offset:256
  ds_read_b64_tr_b16 v[60:61], v18 offset:1024
  ds_read_b64_tr_b16 v[62:63], v18 offset:1280
  ds_read_b64_tr_b16 v[64:65], v18 offset:2048
  ds_read_b64_tr_b16 v[66:67], v18 offset:2304
  ds_read_b64_tr_b16 v[68:69], v18 offset:3072
  ds_read_b64_tr_b16 v[70:71], v18 offset:3328
  s_waitcnt lgkmcnt(6)
  v_mfma_f32_32x32x16_bf16 v[88:103], v[56:59], v[144:147], 0
  s_getpc_b64 s[94:95]
  s_cmp_ge_u32 s48, 16
  s_cbranch_scc0 REFRESH_4
  ds_read_b32 v37, v2 offset:16
  ds_read_b64_tr_b16 v[72:73], v18 offset:4096
  ds_read_b64_tr_b16 v[74:75], v18 offset:4352
  s_waitcnt lgkmcnt(7)
  v_mfma_f32_32x32x16_bf16 v[88:103], v[60:63], v[148:151], v[88:103]
  ds_read_b64_tr_b16 v[76:77], v18 offset:5120
  ds_read_b64_tr_b16 v[78:79], v18 offset:5376
  s_waitcnt lgkmcnt(7)
  v_mfma_f32_32x32x16_bf16 v[88:103], v[64:67], v[152:155], v[88:103]
  ds_read_b64_tr_b16 v[80:81], v18 offset:6144
  ds_read_b64_tr_b16 v[82:83], v18 offset:6400
  s_waitcnt lgkmcnt(7)
  v_mfma_f32_32x32x16_bf16 v[88:103], v[68:71], v[156:159], v[88:103]
  ds_read_b64_tr_b16 v[84:85], v18 offset:7168
  ds_read_b64_tr_b16 v[86:87], v18 offset:7424
  s_waitcnt lgkmcnt(6)
  v_readfirstlane_b32 s48, v37
  v_mfma_f32_32x32x16_bf16 v[88:103], v[72:75], v[160:163], v[88:103]
  s_getpc_b64 s[94:95]
  s_cmp_ge_u32 s48, 17
  s_cbranch_scc0 REFRESH_4
  ds_read_b32 v37, v2 offset:16
  ds_read_b64_tr_b16 v[56:57], v18 offset:8192
  ds_read_b64_tr_b16 v[58:59], v18 offset:8448
  s_waitcnt lgkmcnt(7)
  v_mfma_f32_32x32x16_bf16 v[88:103], v[76:79], v[164:167], v[88:103]
  ds_read_b64_tr_b16 v[60:61], v18 offset:9216
  ds_read_b64_tr_b16 v[62:63], v18 offset:9472
  s_waitcnt lgkmcnt(7)
  v_mfma_f32_32x32x16_bf16 v[88:103], v[80:83], v[168:171], v[88:103]
  ds_read_b64_tr_b16 v[64:65], v18 offset:10240
  ds_read_b64_tr_b16 v[66:67], v18 offset:10496
  s_waitcnt lgkmcnt(7)
  v_mfma_f32_32x32x16_bf16 v[88:103], v[84:87], v[172:175], v[88:103]
  ds_read_b64_tr_b16 v[68:69], v18 offset:11264
  ds_read_b64_tr_b16 v[70:71], v18 offset:11520
  s_waitcnt lgkmcnt(6)
  v_readfirstlane_b32 s48, v37
  v_mfma_f32_32x32x16_bf16 v[88:103], v[56:59], v[176:179], v[88:103]
  s_getpc_b64 s[94:95]
  s_cmp_ge_u32 s48, 18
  s_cbranch_scc0 REFRESH_4
  ds_read_b32 v37, v2 offset:16
  ds_read_b64_tr_b16 v[72:73], v18 offset:12288
  ds_read_b64_tr_b16 v[74:75], v18 offset:12544
  s_waitcnt lgkmcnt(7)
  v_mfma_f32_32x32x16_bf16 v[88:103], v[60:63], v[180:183], v[88:103]
  ds_read_b64_tr_b16 v[76:77], v18 offset:13312
  ds_read_b64_tr_b16 v[78:79], v18 offset:13568
  s_waitcnt lgkmcnt(7)
  v_mfma_f32_32x32x16_bf16 v[88:103], v[64:67], v[184:187], v[88:103]
  ds_read_b64_tr_b16 v[80:81], v18 offset:14336
  ds_read_b64_tr_b16 v[82:83], v18 offset:14592
  s_waitcnt lgkmcnt(7)
  v_mfma_f32_32x32x16_bf16 v[88:103], v[68:71], v[188:191], v[88:103]
  ds_read_b64_tr_b16 v[84:85], v18 offset:15360
  ds_read_b64_tr_b16 v[86:87], v18 offset:15616
  s_waitcnt lgkmcnt(6)
  v_readfirstlane_b32 s48, v37
  v_mfma_f32_32x32x16_bf16 v[88:103], v[72:75], v[192:195], v[88:103]
  s_getpc_b64 s[94:95]
  s_cmp_ge_u32 s48, 19
  s_cbranch_scc0 REFRESH_4
  ds_read_b32 v37, v2 offset:16
  ds_read_b64_tr_b16 v[56:57], v18 offset:16384
  ds_read_b64_tr_b16 v[58:59], v18 offset:16640
  s_waitcnt lgkmcnt(7)
  v_mfma_f32_32x32x16_bf16 v[88:103], v[76:79], v[196:199], v[88:103]
  ds_read_b64_tr_b16 v[60:61], v18 offset:17408
  ds_read_b64_tr_b16 v[62:63], v18 offset:17664
  s_waitcnt lgkmcnt(7)
  v_mfma_f32_32x32x16_bf16 v[88:103], v[80:83], v[200:203], v[88:103]
  ds_read_b64_tr_b16 v[64:65], v18 offset:18432
  ds_read_b64_tr_b16 v[66:67], v18 offset:18688
  s_waitcnt lgkmcnt(7)
  v_mfma_f32_32x32x16_bf16 v[88:103], v[84:87], v[204:207], v[88:103]
  ds_read_b64_tr_b16 v[68:69], v18 offset:19456
  ds_read_b64_tr_b16 v[70:71], v18 offset:19712
  s_waitcnt lgkmcnt(6)
  v_readfirstlane_b32 s48, v37
  v_mfma_f32_32x32x16_bf16 v[88:103], v[56:59], v[208:211], v[88:103]
  s_getpc_b64 s[94:95]
  s_cmp_ge_u32 s48, 20
  s_cbranch_scc0 REFRESH_4
  ds_read_b32 v37, v2 offset:16
  ds_read_b64_tr_b16 v[72:73], v18 offset:20480
  ds_read_b64_tr_b16 v[74:75], v18 offset:20736
  s_waitcnt lgkmcnt(7)
  v_mfma_f32_32x32x16_bf16 v[88:103], v[60:63], v[212:215], v[88:103]
  ds_read_b64_tr_b16 v[76:77], v18 offset:21504
  ds_read_b64_tr_b16 v[78:79], v18 offset:21760
  s_waitcnt lgkmcnt(7)
  v_mfma_f32_32x32x16_bf16 v[88:103], v[64:67], v[216:219], v[88:103]
  ds_read_b64_tr_b16 v[80:81], v18 offset:22528
  ds_read_b64_tr_b16 v[82:83], v18 offset:22784
  s_waitcnt lgkmcnt(7)
  v_mfma_f32_32x32x16_bf16 v[88:103], v[68:71], v[220:223], v[88:103]
  ds_read_b64_tr_b16 v[84:85], v18 offset:23552
  ds_read_b64_tr_b16 v[86:87], v18 offset:23808
  s_waitcnt lgkmcnt(6)
  v_readfirstlane_b32 s48, v37
  v_mfma_f32_32x32x16_bf16 v[88:103], v[72:75], v[224:227], v[88:103]
  s_getpc_b64 s[94:95]
  s_cmp_ge_u32 s48, 21
  s_cbranch_scc0 REFRESH_4
  ds_read_b64_tr_b16 v[56:57], v18 offset:24576
  ds_read_b64_tr_b16 v[58:59], v18 offset:24832
  s_waitcnt lgkmcnt(6)
  v_mfma_f32_32x32x16_bf16 v[88:103], v[76:79], v[228:231], v[88:103]
  ds_read_b64_tr_b16 v[60:61], v18 offset:25600
  ds_read_b64_tr_b16 v[62:63], v18 offset:25856
  s_waitcnt lgkmcnt(6)
  v_mfma_f32_32x32x16_bf16 v[88:103], v[80:83], v[232:235], v[88:103]
  ds_read_b64_tr_b16 v[64:65], v18 offset:26624
  ds_read_b64_tr_b16 v[66:67], v18 offset:26880
  s_waitcnt lgkmcnt(6)
  v_mfma_f32_32x32x16_bf16 v[88:103], v[84:87], v[236:239], v[88:103]
  ds_read_b64_tr_b16 v[68:69], v18 offset:27648
  ds_read_b64_tr_b16 v[70:71], v18 offset:27904
  v_mov_b32 v3, 7
  ds_write_b32 v7, v3
  ds_read_b32 v38, v2 offset:28
  ds_read_b64 v[140:141], v36 offset:1024
  s_waitcnt lgkmcnt(9)
  v_mfma_f32_32x32x16_bf16 v[88:103], v[56:59], v[240:243], v[88:103]
  s_waitcnt lgkmcnt(7)
  v_mfma_f32_32x32x16_bf16 v[88:103], v[60:63], v[244:247], v[88:103]
  s_waitcnt lgkmcnt(5)
  v_mfma_f32_32x32x16_bf16 v[88:103], v[64:67], v[248:251], v[88:103]
  s_waitcnt lgkmcnt(3)
  v_mfma_f32_32x32x16_bf16 v[88:103], v[68:71], v[252:255], v[88:103]
  s_waitcnt lgkmcnt(0)
  v_readfirstlane_b32 s49, v38
  s_cmp_ge_u32 s49, 9
  s_cbranch_scc1 LT_163
W_165:
  ds_read_b32 v32, v2 offset:28
  ds_read_b64 v[140:141], v36 offset:1024
  s_waitcnt lgkmcnt(0)
  v_readfirstlane_b32 s49, v32
  s_sub_u32 s90, s90, 1
  s_cbranch_scc1 WD_164
  s_cmp_ge_u32 s49, 9
  s_cbranch_scc0 W_165
WD_164:
LT_163:
  v_mfma_f32_32x32x16_bf16 v[88:103], v[140:143], v[136:139], v[88:103]
  s_nop 11
  v_cvt_pk_bf16_f32 v120, v88, v89
  v_cvt_pk_bf16_f32 v121, v90, v91
  v_cvt_pk_bf16_f32 v122, v92, v93
  v_cvt_pk_bf16_f32 v123, v94, v95
  v_cvt_pk_bf16_f32 v124, v96, v97
  v_cvt_pk_bf16_f32 v125, v98, v99
  v_cvt_pk_bf16_f32 v126, v100, v101
  v_cvt_pk_bf16_f32 v127, v102, v103
  v_mfma_f32_32x32x16_bf16 v[88:103], v[40:43], v[120:123], 0
  s_nop 0
  v_mfma_f32_32x32x16_bf16 v[88:103], v[44:47], v[124:127], v[88:103]
  s_nop 11
  v_cndmask_b32 v100, v100, v102, s[4:5]
  v_cndmask_b32 v101, v101, v103, s[4:5]
  v_max3_f32 v8, v88, v89, v90
  v_min3_f32 v9, v88, v89, v90
  v_max3_f32 v8, v8, v91, v92
  v_min3_f32 v9, v9, v91, v92
  v_max3_f32 v8, v8, v93, v94
  v_min3_f32 v9, v9, v93, v94
  v_max3_f32 v8, v8, v95, v96
  v_min3_f32 v9, v9, v95, v96
  v_max3_f32 v8, v8, v97, v98
  v_min3_f32 v9, v9, v97, v98
  v_max3_f32 v8, v8, v99, v100
  v_min3_f32 v9, v9, v99, v100
  v_max_f32 v8, v8, v101
  v_min_f32 v9, v9, v101
  v_sub_f32 v9, 0, v9
  s_nop 1
  v_permlane32_swap_b32 v8, v9
  v_max_f32 v8, v8, v9
  v_mul_f32 v8, v8, v26
  v_mov_b32 v9, v8
  s_nop 1
  v_permlane32_swap_b32 v8, v9
  v_pk_fma_f32 v[120:121], v[88:89], v[26:27], v[8:9] op_sel:[0,0,1] op_sel_hi:[1,0,1] neg_lo:[1,0,1] neg_hi:[1,0,1]
  v_pk_fma_f32 v[88:89], v[88:89], v[26:27], v[8:9] op_sel_hi:[1,0,0] neg_lo:[0,0,1] neg_hi:[0,0,1]
  v_pk_fma_f32 v[122:123], v[90:91], v[26:27], v[8:9] op_sel:[0,0,1] op_sel_hi:[1,0,1] neg_lo:[1,0,1] neg_hi:[1,0,1]
  v_pk_fma_f32 v[90:91], v[90:91], v[26:27], v[8:9] op_sel_hi:[1,0,0] neg_lo:[0,0,1] neg_hi:[0,0,1]
  v_pk_fma_f32 v[124:125], v[92:93], v[26:27], v[8:9] op_sel:[0,0,1] op_sel_hi:[1,0,1] neg_lo:[1,0,1] neg_hi:[1,0,1]
  v_pk_fma_f32 v[92:93], v[92:93], v[26:27], v[8:9] op_sel_hi:[1,0,0] neg_lo:[0,0,1] neg_hi:[0,0,1]
  v_pk_fma_f32 v[126:127], v[94:95], v[26:27], v[8:9] op_sel:[0,0,1] op_sel_hi:[1,0,1] neg_lo:[1,0,1] neg_hi:[1,0,1]
  v_pk_fma_f32 v[94:95], v[94:95], v[26:27], v[8:9] op_sel_hi:[1,0,0] neg_lo:[0,0,1] neg_hi:[0,0,1]
  v_pk_fma_f32 v[128:129], v[96:97], v[26:27], v[8:9] op_sel:[0,0,1] op_sel_hi:[1,0,1] neg_lo:[1,0,1] neg_hi:[1,0,1]
  v_pk_fma_f32 v[96:97], v[96:97], v[26:27], v[8:9] op_sel_hi:[1,0,0] neg_lo:[0,0,1] neg_hi:[0,0,1]
  v_pk_fma_f32 v[130:131], v[98:99], v[26:27], v[8:9] op_sel:[0,0,1] op_sel_hi:[1,0,1] neg_lo:[1,0,1] neg_hi:[1,0,1]
  v_pk_fma_f32 v[98:99], v[98:99], v[26:27], v[8:9] op_sel_hi:[1,0,0] neg_lo:[0,0,1] neg_hi:[0,0,1]
  v_pk_fma_f32 v[132:133], v[100:101], v[26:27], v[8:9] op_sel:[0,0,1] op_sel_hi:[1,0,1] neg_lo:[1,0,1] neg_hi:[1,0,1]
  v_pk_fma_f32 v[100:101], v[100:101], v[26:27], v[8:9] op_sel_hi:[1,0,0] neg_lo:[0,0,1] neg_hi:[0,0,1]
  v_exp_f32 v120, v120
  v_exp_f32 v88, v88
  v_exp_f32 v121, v121
  v_exp_f32 v89, v89
  v_exp_f32 v122, v122
  v_exp_f32 v90, v90
  v_exp_f32 v123, v123
  v_exp_f32 v91, v91
  v_exp_f32 v124, v124
  v_exp_f32 v92, v92
  v_exp_f32 v125, v125
  v_exp_f32 v93, v93
  v_exp_f32 v126, v126
  v_exp_f32 v94, v94
  v_exp_f32 v127, v127
  v_exp_f32 v95, v95
  v_exp_f32 v128, v128
  v_exp_f32 v96, v96
  v_exp_f32 v129, v129
  v_exp_f32 v97, v97
  v_exp_f32 v130, v130
  v_exp_f32 v98, v98
  v_exp_f32 v131, v131
  v_exp_f32 v99, v99
  v_exp_f32 v132, v132
  v_exp_f32 v100, v100
  v_exp_f32 v133, v133
  v_exp_f32 v101, v101
  v_pk_add_f32 v[102:103], v[88:89], v[90:91]
  v_pk_add_f32 v[134:135], v[120:121], v[122:123]
  v_pk_add_f32 v[102:103], v[102:103], v[92:93]
  v_pk_add_f32 v[134:135], v[134:135], v[124:125]
  v_pk_add_f32 v[102:103], v[102:103], v[94:95]
  v_pk_add_f32 v[134:135], v[134:135], v[126:127]
  v_pk_add_f32 v[102:103], v[102:103], v[96:97]
  v_pk_add_f32 v[134:135], v[134:135], v[128:129]
  v_pk_add_f32 v[102:103], v[102:103], v[98:99]
  v_pk_add_f32 v[134:135], v[134:135], v[130:131]
  v_pk_add_f32 v[102:103], v[102:103], v[100:101]
  v_pk_add_f32 v[134:135], v[134:135], v[132:133]
  v_add_f32 v10, v102, v103
  v_add_f32 v8, v134, v135
  s_nop 1
  v_permlane32_swap_b32 v10, v8
  v_add_f32 v10, v10, v8
  v_rcp_f32 v10, v10
  s_nop 0
  v_mov_b32 v8, v10
  s_nop 1
  v_permlane32_swap_b32 v10, v8
  v_pk_mul_f32 v[88:89], v[88:89], v[10:11] op_sel_hi:[1,0]
  v_pk_mul_f32 v[120:121], v[120:121], v[8:9] op_sel_hi:[1,0]
  v_pk_mul_f32 v[90:91], v[90:91], v[10:11] op_sel_hi:[1,0]
  v_pk_mul_f32 v[122:123], v[122:123], v[8:9] op_sel_hi:[1,0]
  v_pk_mul_f32 v[92:93], v[92:93], v[10:11] op_sel_hi:[1,0]
  v_pk_mul_f32 v[124:125], v[124:125], v[8:9] op_sel_hi:[1,0]
  v_pk_mul_f32 v[94:95], v[94:95], v[10:11] op_sel_hi:[1,0]
  v_pk_mul_f32 v[126:127], v[126:127], v[8:9] op_sel_hi:[1,0]
  v_pk_mul_f32 v[96:97], v[96:97], v[10:11] op_sel_hi:[1,0]
  v_pk_mul_f32 v[128:129], v[128:129], v[8:9] op_sel_hi:[1,0]
  v_pk_mul_f32 v[98:99], v[98:99], v[10:11] op_sel_hi:[1,0]
  v_pk_mul_f32 v[130:131], v[130:131], v[8:9] op_sel_hi:[1,0]
  v_pk_mul_f32 v[100:101], v[100:101], v[10:11] op_sel_hi:[1,0]
  v_pk_mul_f32 v[132:133], v[132:133], v[8:9] op_sel_hi:[1,0]
  v_cvt_pk_bf16_f32 v88, v88, v89
  v_cvt_pk_bf16_f32 v120, v120, v121
  v_cvt_pk_bf16_f32 v89, v90, v91
  v_cvt_pk_bf16_f32 v121, v122, v123
  v_cvt_pk_bf16_f32 v90, v92, v93
  v_cvt_pk_bf16_f32 v122, v124, v125
  v_cvt_pk_bf16_f32 v91, v94, 0
  v_cvt_pk_bf16_f32 v123, v126, 0
  v_cvt_pk_bf16_f32 v92, v95, v96
  v_cvt_pk_bf16_f32 v124, v127, v128
  v_cvt_pk_bf16_f32 v93, v97, v98
  v_cvt_pk_bf16_f32 v125, v129, v130
  v_cvt_pk_bf16_f32 v94, v99, v100
  v_cvt_pk_bf16_f32 v126, v131, v132
  v_cvt_pk_bf16_f32 v95, v101, 0
  v_cvt_pk_bf16_f32 v127, v133, 0
  v_bfe_u32 v3, v1, 2, 2
  v_lshrrev_b32 v4, 5, v1
  v_lshl_add_u32 v4, v4, 2, v3
  v_lshlrev_b32 v12, 8, v4
  v_lshlrev_b32 v16, 7, v4
  v_xor_b32 v3, s46, v3
  v_lshl_add_u32 v12, v3, 6, v12
  v_bfe_u32 v4, v1, 4, 1
  v_lshlrev_b32 v4, 5, v4
  v_and_b32 v3, 3, v1
  v_lshl_add_u32 v4, v3, 3, v4
  v_add_u32 v12, v12, v4
  v_add_u32 v13, 0x8000, v12
  v_add_u32 v16, v16, v4
  v_bfe_u32 v4, v1, 3, 1
  v_lshl_add_u32 v16, v4, 6, v16
  s_mov_b32 s89, 0
  s_lshl_b32 s1, s44, 2
  s_add_u32 s1, s1, s46
  s_lshl_b32 s1, s1, 4
  s_add_u32 s1, s1, s45
  s_lshl_b32 s88, s1, 11
  s_add_u32 s88, s88, 2097152
  s_lshl_b32 s1, s1, 2
  s_add_u32 s1, s1, 16781312
  v_add_u32 v29, 155648, v5
W_166:
  ds_read_b128 v[32:35], v2 offset:16
  ds_read_b32 v37, v2 offset:64
  ds_read_b128 v[56:59], v29 offset:0
  ds_read_b128 v[60:63], v29 offset:1024
  ds_read_b128 v[64:67], v29 offset:2048
  ds_read_b128 v[68:71], v29 offset:3072
  s_waitcnt lgkmcnt(4)
  v_readfirstlane_b32 s54, v37
  v_min_u32 v33, v33, v34
  s_nop 0
  v_readfirstlane_b32 s49, v33
  s_sub_u32 s90, s90, 1
  s_cbranch_scc1 WD_167
  s_cmp_ge_u32 s49, 3
  s_cbranch_scc1 WD_167
  s_cmp_lg_u32 s89, 0
  s_cbranch_scc1 NC_168
  v_readfirstlane_b32 s48, v32
  s_cmp_lt_u32 s48, 24
  s_cbranch_scc1 NC_168
  s_getpc_b64 s[94:95]
  s_cmp_ge_u32 s48, 23
  s_cbranch_scc0 REFRESH_4
  ds_read_b64_tr_b16 v[144:145], v12 offset:0
  ds_read_b64_tr_b16 v[146:147], v12 offset:2048
  ds_read_b64_tr_b16 v[148:149], v12 offset:4096
  ds_read_b64_tr_b16 v[150:151], v12 offset:6144
  ds_read_b64_tr_b16 v[152:153], v12 offset:8192
  ds_read_b64_tr_b16 v[154:155], v12 offset:10240
  ds_read_b64_tr_b16 v[156:157], v12 offset:12288
  ds_read_b64_tr_b16 v[158:159], v12 offset:14336
  s_getpc_b64 s[94:95]
  s_cmp_ge_u32 s48, 24
  s_cbranch_scc0 REFRESH_4
  ds_read_b64_tr_b16 v[160:161], v12 offset:16384
  ds_read_b64_tr_b16 v[162:163], v12 offset:18432
  ds_read_b64_tr_b16 v[164:165], v12 offset:20480
  ds_read_b64_tr_b16 v[166:167], v12 offset:22528
  ds_read_b64_tr_b16 v[168:169], v12 offset:24576
  ds_read_b64_tr_b16 v[170:171], v12 offset:26624
  ds_read_b64_tr_b16 v[172:173], v12 offset:28672
  ds_read_b64_tr_b16 v[174:175], v12 offset:30720
  s_mov_b32 s89, 1
  v_mov_b32 v3, 1
  ds_write_b32 v7, v3 offset:96
NC_168:
  s_branch W_166
WD_167:
  s_waitcnt lgkmcnt(3)
  v_mfma_f32_32x32x16_bf16 v[104:119], v[56:59], v[88:91], 0
  s_waitcnt lgkmcnt(2)
  v_mfma_f32_32x32x16_bf16 v[104:119], v[60:63], v[92:95], v[104:119]
  s_waitcnt lgkmcnt(1)
  v_mfma_f32_32x32x16_bf16 v[104:119], v[64:67], v[120:123], v[104:119]
  s_waitcnt lgkmcnt(0)
  v_mfma_f32_32x32x16_bf16 v[104:119], v[68:71], v[124:127], v[104:119]
  s_nop 11
  v_cndmask_b32 v3, v116, v104, s[92:93]
  v_mov_b32 v4, v3
  s_nop 1
  v_permlane32_swap_b32 v3, v4
  v_cndmask_b32 v8, v4, v3, s[92:93]
  v_add_f32 v8, 0x358637bd, v8
  v_rcp_f32 v8, v8
  s_nop 0
  v_pk_mul_f32 v[104:105], v[104:105], v[8:9] op_sel_hi:[1,0]
  v_pk_mul_f32 v[106:107], v[106:107], v[8:9] op_sel_hi:[1,0]
  v_pk_mul_f32 v[108:109], v[108:109], v[8:9] op_sel_hi:[1,0]
  v_pk_mul_f32 v[110:111], v[110:111], v[8:9] op_sel_hi:[1,0]
  v_pk_mul_f32 v[112:113], v[112:113], v[8:9] op_sel_hi:[1,0]
  v_pk_mul_f32 v[114:115], v[114:115], v[8:9] op_sel_hi:[1,0]
  v_pk_mul_f32 v[116:117], v[116:117], v[8:9] op_sel_hi:[1,0]
  v_pk_mul_f32 v[118:119], v[118:119], v[8:9] op_sel_hi:[1,0]
  v_cvt_pk_bf16_f32 v120, v104, v105
  v_cvt_pk_bf16_f32 v121, v106, v107
  v_cvt_pk_bf16_f32 v122, v108, v109
  v_cvt_pk_bf16_f32 v123, v110, v111
  v_cvt_pk_bf16_f32 v124, v112, v113
  v_cvt_pk_bf16_f32 v125, v114, v115
  v_cvt_pk_bf16_f32 v126, v116, v117
  v_cvt_pk_bf16_f32 v127, v118, v119
  v_cndmask_b32 v120, v120, 0, s[8:9]
  v_cndmask_b32 v126, v126, 0, s[10:11]
  v_cndmask_b32 v121, v121, 0, s[8:9]
  v_cndmask_b32 v127, v127, 0, s[10:11]
  s_cmp_eq_u32 s54, 0
  s_cbranch_scc1 CE_169
  buffer_store_dwordx4 v[120:123], v5, s[24:27], s88 offen offset:0
  buffer_store_dwordx4 v[124:127], v5, s[24:27], s88 offen offset:1024
CB_170:
  s_waitcnt vmcnt(2)
  v_permlane32_swap_b32 v48, v50
  v_permlane32_swap_b32 v49, v51
  v_permlane32_swap_b32 v52, v54
  v_permlane32_swap_b32 v53, v55
  v_lshlrev_b32 v88, 16, v48
  v_and_b32 v89, 0xffff0000, v48
  v_lshlrev_b32 v90, 16, v49
  v_and_b32 v91, 0xffff0000, v49
  v_lshlrev_b32 v92, 16, v50
  v_and_b32 v93, 0xffff0000, v50
  v_lshlrev_b32 v94, 16, v51
  v_and_b32 v95, 0xffff0000, v51
  v_lshlrev_b32 v96, 16, v52
  v_and_b32 v97, 0xffff0000, v52
  v_lshlrev_b32 v98, 16, v53
  v_and_b32 v99, 0xffff0000, v53
  v_lshlrev_b32 v100, 16, v54
  v_and_b32 v101, 0xffff0000, v54
  v_lshlrev_b32 v102, 16, v55
  v_and_b32 v103, 0xffff0000, v55
  s_lshl_b32 s49, s101, 6
  v_xor_b32 v16, s49, v16
  v_xor_b32 v17, 64, v16
  s_mul_i32 s49, s101, 28672
  s_add_u32 s49, s49, 98304
  v_add_u32 v18, s49, v16
  v_add_u32 v19, s49, v17
  s_and_b32 s52, s46, 1
  s_lshl_b32 s52, s52, 12
  v_add_u32 v14, s52, v5
  s_cmp_eq_u32 s101, 0
  s_cselect_b32 s49, 12, 14
  s_cselect_b32 s50, 14, 12
  s_lshl_b32 s49, s49, 12
  s_lshl_b32 s50, s50, 12
  v_add_u32 v15, s50, v14
  v_add_u32 v14, s49, v14
  v_xor_b32 v20, 8, v7
  s_lshl_b32 s88, s100, 15
  s_lshl_b32 s49, s101, 14
  s_add_u32 s88, s88, s49
  s_add_u32 s88, s88, 2097152
  s_lshl_b32 s52, s100, 6
  s_lshl_b32 s49, s101, 5
  s_add_u32 s52, s52, s49
  s_add_u32 s52, s52, 16781312
  s_waitcnt vmcnt(0)
  s_mov_b64 exec, 1
  s_cmp_eq_u32 s54, 0
  s_cbranch_scc1 CE_171
  buffer_store_dword v6, v5, s[24:27], s1 offen
CB_172:
  s_mov_b64 exec, -1
  v_mov_b32 v3, 9
  ds_write_b32 v7, v3
  s_cmp_ge_u32 s55, 28
  s_cbranch_scc1 FIN_173
  v_lshlrev_b32 v24, 2, v1
  s_mov_b64 exec, 0xff
  buffer_load_dword v25, v24, s[24:27], s52 offen sc1
  s_mov_b64 exec, -1
  s_mul_i32 s92, s98, 448
  s_lshl_b32 s49, s99, 3
  s_add_u32 s92, s92, s49
  s_lshl_b32 s49, s46, 1
  s_add_u32 s92, s92, s49
  s_lshl_b32 s92, s92, 10
  s_add_u32 s92, s92, 8388608
  s_add_u32 s4, s92, 229376
  s_lshl_b32 s93, s98, 9
  s_lshl_b32 s49, s99, 4
  s_add_u32 s93, s93, s49
  s_lshl_b32 s49, s46, 2
  s_add_u32 s93, s93, s49
  s_add_u32 s93, s93, 17235968
  s_add_u32 s5, s93, 256
  s_bitcmp1_b32 s99, 0
  s_cselect_b32 s49, s4, s92
  s_cselect_b32 s4, s92, s4
  s_mov_b32 s92, s49
  s_cselect_b32 s49, s5, s93
  s_cselect_b32 s5, s93, s5
  s_mov_b32 s93, s49
  s_lshl_b32 s6, s96, 8
  s_mul_i32 s49, s101, 112
  s_add_u32 s6, s6, s49
  s_add_u32 s6, s6, 17235968
  s_mul_i32 s9, s100, 114688
  s_mul_i32 s49, s101, 57344
  s_add_u32 s9, s9, s49
  s_add_u32 s9, s9, 8388608
  s_and_b32 s7, s96, 1
  s_xor_b32 s7, s7, s101
  s_lshr_b32 s49, s96, 1
  s_xor_b32 s49, s49, s3
  s_sub_u32 s50, 6, s7
  s_bitcmp1_b32 s49, 0
  s_cselect_b32 s7, s50, s7
  s_cselect_b32 s8, 5, 2
  s_bitcmp1_b32 s7, 0
  s_mov_b32 s10, 0x0f0f0f0f
  s_cselect_b32 s10, 0x00f0f0f0, s10
  s_getpc_b64 s[94:95]
  s_cmp_ge_u32 s48, 22
  s_cbranch_scc0 REFRESH_4
  ds_read_b64_tr_b16 v[80:81], v19 offset:0
  ds_read_b64_tr_b16 v[82:83], v19 offset:1024
  ds_read_b64_tr_b16 v[72:73], v18 offset:0
  ds_read_b64_tr_b16 v[74:75], v18 offset:1024
  s_branch PC_175
P_174:
  s_mov_b64 exec, 0xff
  buffer_load_dword v25, v24, s[24:27], s52 offen sc1
  s_mov_b64 exec, -1
  s_cmp_lg_u32 s89, 0
  s_cbranch_scc1 NC_177
  ds_read_b32 v32, v2 offset:16
  s_waitcnt lgkmcnt(0)
  v_readfirstlane_b32 s48, v32
  s_cmp_lt_u32 s48, 24
  s_cbranch_scc1 NC_177
  s_getpc_b64 s[94:95]
  s_cmp_ge_u32 s48, 23
  s_cbranch_scc0 REFRESH_4
  ds_read_b64_tr_b16 v[144:145], v12 offset:0
  ds_read_b64_tr_b16 v[146:147], v12 offset:2048
  ds_read_b64_tr_b16 v[148:149], v12 offset:4096
  ds_read_b64_tr_b16 v[150:151], v12 offset:6144
  ds_read_b64_tr_b16 v[152:153], v12 offset:8192
  ds_read_b64_tr_b16 v[154:155], v12 offset:10240
  ds_read_b64_tr_b16 v[156:157], v12 offset:12288
  ds_read_b64_tr_b16 v[158:159], v12 offset:14336
  s_getpc_b64 s[94:95]
  s_cmp_ge_u32 s48, 24
  s_cbranch_scc0 REFRESH_4
  ds_read_b64_tr_b16 v[160:161], v12 offset:16384
  ds_read_b64_tr_b16 v[162:163], v12 offset:18432
  ds_read_b64_tr_b16 v[164:165], v12 offset:20480
  ds_read_b64_tr_b16 v[166:167], v12 offset:22528
  ds_read_b64_tr_b16 v[168:169], v12 offset:24576
  ds_read_b64_tr_b16 v[170:171], v12 offset:26624
  ds_read_b64_tr_b16 v[172:173], v12 offset:28672
  ds_read_b64_tr_b16 v[174:175], v12 offset:30720
  s_mov_b32 s89, 1
  v_mov_b32 v3, 1
  ds_write_b32 v7, v3 offset:96
NC_177:
PC_175:
  s_waitcnt vmcnt(0)
  v_cmp_ne_u32 vcc, s53, v25
  s_sub_u32 s90, s90, 1
  s_cbranch_scc1 PD_176
  s_and_b32 s49, vcc_lo, 0xff
  s_cbranch_scc1 P_174
PD_176:
  s_mov_b32 s91, s88
  buffer_load_dwordx4 v[40:43], v5, s[24:27], s91 offen offset:0 sc1
  buffer_load_dwordx4 v[44:47], v5, s[24:27], s91 offen offset:1024 sc1
  buffer_load_dwordx4 v[48:51], v5, s[24:27], s91 offen offset:2048 sc1
  buffer_load_dwordx4 v[52:55], v5, s[24:27], s91 offen offset:3072 sc1
  s_add_u32 s91, s91, 4096
  buffer_load_dwordx4 v[56:59], v5, s[24:27], s91 offen offset:0 sc1
  buffer_load_dwordx4 v[60:63], v5, s[24:27], s91 offen offset:1024 sc1
  buffer_load_dwordx4 v[64:67], v5, s[24:27], s91 offen offset:2048 sc1
  buffer_load_dwordx4 v[68:71], v5, s[24:27], s91 offen offset:3072 sc1
  s_add_u32 s91, s91, 4096
  s_lshl_b32 s50, s97, 1
  s_add_u32 s50, s50, s101
  s_lshl_b32 s88, s100, 15
  s_add_u32 s88, s88, 4194304
  s_lshl_b32 s52, s50, 8
  s_add_u32 s52, s52, s88
  s_lshl_b32 s49, s50, 11
  s_add_u32 s88, s88, s49
  s_add_u32 s88, s88, 4096
  s_lshl_b32 s1, s50, 2
  s_lshl_b32 s49, s100, 6
  s_add_u32 s1, s1, s49
  s_add_u32 s1, s1, 16789504
  ds_read_b64_tr_b16 v[84:85], v19 offset:2048
  ds_read_b64_tr_b16 v[86:87], v19 offset:3072
  s_waitcnt vmcnt(7) lgkmcnt(4)
  v_mfma_f32_32x32x16_bf16 v[104:119], v[80:83], v[40:43], 0
  buffer_load_dwordx4 v[224:227], v5, s[24:27], s91 offen offset:0 sc1
  ds_read_b64_tr_b16 v[80:81], v19 offset:3072
  ds_read_b64_tr_b16 v[82:83], v19 offset:4096
  s_waitcnt vmcnt(7) lgkmcnt(2)
  v_mfma_f32_32x32x16_bf16 v[104:119], v[84:87], v[44:47], v[104:119]
  buffer_load_dwordx4 v[228:231], v5, s[24:27], s91 offen offset:1024 sc1
  ds_read_b64_tr_b16 v[84:85], v19 offset:5120
  ds_read_b64_tr_b16 v[86:87], v19 offset:6144
  s_waitcnt vmcnt(7) lgkmcnt(2)
  v_mfma_f32_32x32x16_bf16 v[104:119], v[80:83], v[48:51], v[104:119]
  buffer_load_dwordx4 v[232:235], v5, s[24:27], s91 offen offset:2048 sc1
  ds_read_b64_tr_b16 v[80:81], v19 offset:7168
  ds_read_b64_tr_b16 v[82:83], v19 offset:8192
  s_waitcnt vmcnt(7) lgkmcnt(2)
  v_mfma_f32_32x32x16_bf16 v[104:119], v[84:87], v[52:55], v[104:119]
  buffer_load_dwordx4 v[236:239], v5, s[24:27], s91 offen offset:3072 sc1
  s_add_u32 s91, s91, 4096
  ds_read_b64_tr_b16 v[84:85], v19 offset:9216
  ds_read_b64_tr_b16 v[86:87], v19 offset:10240
  s_waitcnt vmcnt(7) lgkmcnt(2)
  v_mfma_f32_32x32x16_bf16 v[104:119], v[80:83], v[56:59], v[104:119]
  buffer_load_dwordx4 v[240:243], v5, s[24:27], s91 offen offset:0 sc1
  v_mov_b32 v3, 1
  ds_write_b32 v7, v3 offset:256
  ds_read_b64_tr_b16 v[80:81], v19 offset:10240
  ds_read_b64_tr_b16 v[82:83], v19 offset:11264
  s_waitcnt vmcnt(7) lgkmcnt(3)
  v_mfma_f32_32x32x16_bf16 v[104:119], v[84:87], v[60:63], v[104:119]
  buffer_load_dwordx4 v[244:247], v5, s[24:27], s91 offen offset:1024 sc1
  ds_read_b64_tr_b16 v[76:77], v18 offset:2048
  ds_read_b64_tr_b16 v[78:79], v18 offset:3072
  v_mfma_f32_32x32x16_bf16 v[88:103], v[72:75], v[40:43], v[88:103]
  ds_read_b64_tr_b16 v[84:85], v19 offset:12288
  ds_read_b64_tr_b16 v[86:87], v19 offset:13312
  s_waitcnt vmcnt(7) lgkmcnt(4)
  v_mfma_f32_32x32x16_bf16 v[104:119], v[80:83], v[64:67], v[104:119]
  buffer_load_dwordx4 v[248:251], v5, s[24:27], s91 offen offset:2048 sc1
  ds_read_b64_tr_b16 v[72:73], v18 offset:3072
  ds_read_b64_tr_b16 v[74:75], v18 offset:4096
  s_waitcnt lgkmcnt(4)
  v_mfma_f32_32x32x16_bf16 v[88:103], v[76:79], v[44:47], v[88:103]
  ds_read_b64_tr_b16 v[80:81], v19 offset:14336
  ds_read_b64_tr_b16 v[82:83], v19 offset:15360
  s_waitcnt vmcnt(7) lgkmcnt(4)
  v_mfma_f32_32x32x16_bf16 v[104:119], v[84:87], v[68:71], v[104:119]
  buffer_load_dwordx4 v[252:255], v5, s[24:27], s91 offen offset:3072 sc1
  s_add_u32 s91, s91, 4096
  ds_read_b64_tr_b16 v[76:77], v18 offset:5120
  ds_read_b64_tr_b16 v[78:79], v18 offset:6144
  s_waitcnt lgkmcnt(4)
  v_mfma_f32_32x32x16_bf16 v[88:103], v[72:75], v[48:51], v[88:103]
  ds_read_b64_tr_b16 v[84:85], v19 offset:16384
  ds_read_b64_tr_b16 v[86:87], v19 offset:17408
  s_waitcnt vmcnt(7) lgkmcnt(4)
  v_mfma_f32_32x32x16_bf16 v[104:119], v[80:83], v[224:227], v[104:119]
  ds_read_b64_tr_b16 v[72:73], v18 offset:7168
  ds_read_b64_tr_b16 v[74:75], v18 offset:8192
  s_waitcnt lgkmcnt(4)
  v_mfma_f32_32x32x16_bf16 v[88:103], v[76:79], v[52:55], v[88:103]
  ds_read_b64_tr_b16 v[80:81], v19 offset:17408
  ds_read_b64_tr_b16 v[82:83], v19 offset:18432
  s_waitcnt vmcnt(6) lgkmcnt(4)
  v_mfma_f32_32x32x16_bf16 v[104:119], v[84:87], v[228:231], v[104:119]
  ds_read_b64_tr_b16 v[76:77], v18 offset:9216
  ds_read_b64_tr_b16 v[78:79], v18 offset:10240
  s_waitcnt lgkmcnt(4)
  v_mfma_f32_32x32x16_bf16 v[88:103], v[72:75], v[56:59], v[88:103]
  ds_read_b64_tr_b16 v[84:85], v19 offset:19456
  ds_read_b64_tr_b16 v[86:87], v19 offset:20480
  s_waitcnt vmcnt(5) lgkmcnt(4)
  v_mfma_f32_32x32x16_bf16 v[104:119], v[80:83], v[232:235], v[104:119]
  ds_read_b64_tr_b16 v[72:73], v18 offset:10240
  ds_read_b64_tr_b16 v[74:75], v18 offset:11264
  s_waitcnt lgkmcnt(4)
  v_mfma_f32_32x32x16_bf16 v[88:103], v[76:79], v[60:63], v[88:103]
  ds_read_b32 v37, v2 offset:16
  ds_read_b64_tr_b16 v[80:81], v19 offset:21504
  ds_read_b64_tr_b16 v[82:83], v19 offset:22528
  s_waitcnt vmcnt(4) lgkmcnt(5)
  v_mfma_f32_32x32x16_bf16 v[104:119], v[84:87], v[236:239], v[104:119]
  ds_read_b64_tr_b16 v[76:77], v18 offset:12288
  ds_read_b64_tr_b16 v[78:79], v18 offset:13312
  s_waitcnt lgkmcnt(5)
  v_mfma_f32_32x32x16_bf16 v[88:103], v[72:75], v[64:67], v[88:103]
  ds_read_b64_tr_b16 v[84:85], v19 offset:23552
  ds_read_b64_tr_b16 v[86:87], v19 offset:24576
  s_waitcnt vmcnt(3) lgkmcnt(4)
  v_mfma_f32_32x32x16_bf16 v[104:119], v[80:83], v[240:243], v[104:119]
  ds_read_b64_tr_b16 v[72:73], v18 offset:14336
  ds_read_b64_tr_b16 v[74:75], v18 offset:15360
  s_waitcnt lgkmcnt(4)
  v_mfma_f32_32x32x16_bf16 v[88:103], v[76:79], v[68:71], v[88:103]
  ds_read_b64_tr_b16 v[80:81], v19 offset:24576
  ds_read_b64_tr_b16 v[82:83], v19 offset:25600
  s_waitcnt vmcnt(2) lgkmcnt(4)
  v_mfma_f32_32x32x16_bf16 v[104:119], v[84:87], v[244:247], v[104:119]
  ds_read_b64_tr_b16 v[76:77], v18 offset:16384
  ds_read_b64_tr_b16 v[78:79], v18 offset:17408
  s_waitcnt lgkmcnt(4)
  v_mfma_f32_32x32x16_bf16 v[88:103], v[72:75], v[224:227], v[88:103]
  ds_read_b64_tr_b16 v[84:85], v19 offset:26624
  ds_read_b64_tr_b16 v[86:87], v19 offset:27648
  s_waitcnt vmcnt(1) lgkmcnt(4)
  v_mfma_f32_32x32x16_bf16 v[104:119], v[80:83], v[248:251], v[104:119]
  ds_read_b64_tr_b16 v[72:73], v18 offset:17408
  ds_read_b64_tr_b16 v[74:75], v18 offset:18432
  s_waitcnt lgkmcnt(4)
  v_mfma_f32_32x32x16_bf16 v[88:103], v[76:79], v[228:231], v[88:103]
  v_readfirstlane_b32 s48, v37
  s_waitcnt vmcnt(0) lgkmcnt(2)
  v_mfma_f32_32x32x16_bf16 v[104:119], v[84:87], v[252:255], v[104:119]
  ds_read_b64_tr_b16 v[76:77], v18 offset:19456
  ds_read_b64_tr_b16 v[78:79], v18 offset:20480
  s_waitcnt lgkmcnt(2)
  v_mfma_f32_32x32x16_bf16 v[88:103], v[72:75], v[232:235], v[88:103]
  s_getpc_b64 s[94:95]
  s_cmp_ge_u32 s48, 27
  s_cbranch_scc0 REFRESH_4
  ds_read_b64_tr_b16 v[72:73], v18 offset:21504
  ds_read_b64_tr_b16 v[74:75], v18 offset:22528
  s_waitcnt lgkmcnt(2)
  v_mfma_f32_32x32x16_bf16 v[88:103], v[76:79], v[236:239], v[88:103]
  s_nop 0
  ds_write_b128 v14, v[104:107] offset:0
  ds_write_b128 v14, v[108:111] offset:1024
  ds_write_b128 v14, v[112:115] offset:2048
  ds_write_b128 v14, v[116:119] offset:3072
  v_mov_b32 v3, 10
  ds_write_b32 v7, v3
  ds_read_b64_tr_b16 v[76:77], v18 offset:23552
  ds_read_b64_tr_b16 v[78:79], v18 offset:24576
  s_waitcnt lgkmcnt(7)
  v_mfma_f32_32x32x16_bf16 v[88:103], v[72:75], v[240:243], v[88:103]
  ds_read_b64_tr_b16 v[72:73], v18 offset:24576
  ds_read_b64_tr_b16 v[74:75], v18 offset:25600
  s_waitcnt lgkmcnt(2)
  v_mfma_f32_32x32x16_bf16 v[88:103], v[76:79], v[244:247], v[88:103]
  ds_read_b64_tr_b16 v[76:77], v18 offset:26624
  ds_read_b64_tr_b16 v[78:79], v18 offset:27648
  s_waitcnt lgkmcnt(2)
  v_mfma_f32_32x32x16_bf16 v[88:103], v[72:75], v[248:251], v[88:103]
  s_waitcnt lgkmcnt(0)
  v_mfma_f32_32x32x16_bf16 v[88:103], v[76:79], v[252:255], v[88:103]
W_178:
  ds_read_b32 v32, v20
  ds_read_b128 v[72:75], v15 offset:0
  ds_read_b128 v[76:79], v15 offset:1024
  ds_read_b128 v[80:83], v15 offset:2048
  ds_read_b128 v[84:87], v15 offset:3072
  s_waitcnt lgkmcnt(4)
  v_readfirstlane_b32 s49, v32
  s_sub_u32 s90, s90, 1
  s_cbranch_scc1 WD_179
  s_cmp_ge_u32 s49, 10
  s_cbranch_scc0 W_178
WD_179:
  s_waitcnt lgkmcnt(3)
  s_nop 1
  v_pk_add_f32 v[88:89], v[88:89], v[72:73]
  v_pk_add_f32 v[90:91], v[90:91], v[74:75]
  s_waitcnt lgkmcnt(2)
  v_pk_add_f32 v[92:93], v[92:93], v[76:77]
  v_pk_add_f32 v[94:95], v[94:95], v[78:79]
  s_waitcnt lgkmcnt(1)
  v_pk_add_f32 v[96:97], v[96:97], v[80:81]
  v_pk_add_f32 v[98:99], v[98:99], v[82:83]
  s_waitcnt lgkmcnt(0)
  v_pk_add_f32 v[100:101], v[100:101], v[84:85]
  v_pk_add_f32 v[102:103], v[102:103], v[86:87]
  v_mov_b32 v3, 11
  ds_write_b32 v7, v3
  v_cvt_pk_bf16_f32 v120, v88, v89
  v_cvt_pk_bf16_f32 v121, v90, v91
  v_cvt_pk_bf16_f32 v122, v92, v93
  v_cvt_pk_bf16_f32 v123, v94, v95
  v_cvt_pk_bf16_f32 v124, v96, v97
  v_cvt_pk_bf16_f32 v125, v98, v99
  v_cvt_pk_bf16_f32 v126, v100, v101
  v_cvt_pk_bf16_f32 v127, v102, v103
  s_cmp_eq_u32 s54, 0
  s_cbranch_scc1 CE_180
  buffer_store_dwordx4 v[120:123], v5, s[24:27], s88 offen offset:0
  buffer_store_dwordx4 v[124:127], v5, s[24:27], s88 offen offset:1024
CB_181:
  v_mov_b32 v8, 0
  v_mov_b32 v9, 0
  v_dot2c_f32_bf16 v8, s51, v120
  v_dot2c_f32_bf16 v9, v120, v120
  v_dot2c_f32_bf16 v8, s51, v121
  v_dot2c_f32_bf16 v9, v121, v121
  v_dot2c_f32_bf16 v8, s51, v122
  v_dot2c_f32_bf16 v9, v122, v122
  v_dot2c_f32_bf16 v8, s51, v123
  v_dot2c_f32_bf16 v9, v123, v123
  v_dot2c_f32_bf16 v8, s51, v124
  v_dot2c_f32_bf16 v9, v124, v124
  v_dot2c_f32_bf16 v8, s51, v125
  v_dot2c_f32_bf16 v9, v125, v125
  v_dot2c_f32_bf16 v8, s51, v126
  v_dot2c_f32_bf16 v9, v126, v126
  v_dot2c_f32_bf16 v8, s51, v127
  v_dot2c_f32_bf16 v9, v127, v127
  v_lshlrev_b32 v10, 2, v1
  s_nop 1
  v_permlane32_swap_b32 v8, v9
  v_add_f32 v8, v8, v9
  s_cmp_eq_u32 s54, 0
  s_cbranch_scc1 CE_182
  buffer_store_dword v8, v10, s[24:27], s52 offen
CB_183:
  s_cmp_lg_u32 s89, 0
  s_cbranch_scc1 NC_184
  s_getpc_b64 s[94:95]
  s_cmp_ge_u32 s48, 23
  s_cbranch_scc0 REFRESH_4
  ds_read_b64_tr_b16 v[144:145], v12 offset:0
  ds_read_b64_tr_b16 v[146:147], v12 offset:2048
  ds_read_b64_tr_b16 v[148:149], v12 offset:4096
  ds_read_b64_tr_b16 v[150:151], v12 offset:6144
  ds_read_b64_tr_b16 v[152:153], v12 offset:8192
  ds_read_b64_tr_b16 v[154:155], v12 offset:10240
  ds_read_b64_tr_b16 v[156:157], v12 offset:12288
  ds_read_b64_tr_b16 v[158:159], v12 offset:14336
  s_getpc_b64 s[94:95]
  s_cmp_ge_u32 s48, 24
  s_cbranch_scc0 REFRESH_4
  ds_read_b64_tr_b16 v[160:161], v12 offset:16384
  ds_read_b64_tr_b16 v[162:163], v12 offset:18432
  ds_read_b64_tr_b16 v[164:165], v12 offset:20480
  ds_read_b64_tr_b16 v[166:167], v12 offset:22528
  ds_read_b64_tr_b16 v[168:169], v12 offset:24576
  ds_read_b64_tr_b16 v[170:171], v12 offset:26624
  ds_read_b64_tr_b16 v[172:173], v12 offset:28672
  ds_read_b64_tr_b16 v[174:175], v12 offset:30720
  s_mov_b32 s89, 1
  v_mov_b32 v3, 1
  ds_write_b32 v7, v3 offset:96
NC_184:
  s_getpc_b64 s[94:95]
  s_cmp_ge_u32 s48, 25
  s_cbranch_scc0 REFRESH_4
  ds_read_b64_tr_b16 v[176:177], v13 offset:32768
  ds_read_b64_tr_b16 v[178:179], v13 offset:34816
  ds_read_b64_tr_b16 v[180:181], v13 offset:36864
  ds_read_b64_tr_b16 v[182:183], v13 offset:38912
  ds_read_b64_tr_b16 v[184:185], v13 offset:40960
  ds_read_b64_tr_b16 v[186:187], v13 offset:43008
  ds_read_b64_tr_b16 v[188:189], v13 offset:45056
  ds_read_b64_tr_b16 v[190:191], v13 offset:47104
  s_getpc_b64 s[94:95]
  s_cmp_ge_u32 s48, 26
  s_cbranch_scc0 REFRESH_4
  ds_read_b64_tr_b16 v[192:193], v13 offset:49152
  ds_read_b64_tr_b16 v[194:195], v13 offset:51200
  ds_read_b64_tr_b16 v[196:197], v13 offset:53248
  ds_read_b64_tr_b16 v[198:199], v13 offset:55296
  ds_read_b64_tr_b16 v[200:201], v13 offset:57344
  ds_read_b64_tr_b16 v[202:203], v13 offset:59392
  ds_read_b64_tr_b16 v[204:205], v13 offset:61440
  ds_read_b64_tr_b16 v[206:207], v13 offset:63488
  s_waitcnt vmcnt(0)
  s_mov_b64 exec, 1
  s_cmp_eq_u32 s54, 0
  s_cbranch_scc1 CE_185
  buffer_store_dword v6, v5, s[24:27], s1 offen
CB_186:
  s_mov_b64 exec, -1
  v_mov_b32 v22, 0
  v_mov_b32 v23, 0
  s_waitcnt lgkmcnt(0)
  v_dot2c_f32_bf16 v22, s51, v144
  v_dot2c_f32_bf16 v23, s51, v145
  v_dot2c_f32_bf16 v22, s51, v146
  v_dot2c_f32_bf16 v23, s51, v147
  v_dot2c_f32_bf16 v22, s51, v148
  v_dot2c_f32_bf16 v23, s51, v149
  v_dot2c_f32_bf16 v22, s51, v150
  v_dot2c_f32_bf16 v23, s51, v151
  v_dot2c_f32_bf16 v22, s51, v152
  v_dot2c_f32_bf16 v23, s51, v153
  v_dot2c_f32_bf16 v22, s51, v154
  v_dot2c_f32_bf16 v23, s51, v155
  v_dot2c_f32_bf16 v22, s51, v156
  v_dot2c_f32_bf16 v23, s51, v157
  v_dot2c_f32_bf16 v22, s51, v158
  v_dot2c_f32_bf16 v23, s51, v159
  s_getpc_b64 s[94:95]
  s_cmp_ge_u32 s48, 27
  s_cbranch_scc0 REFRESH_4
  ds_read_b64_tr_b16 v[208:209], v13 offset:0
  ds_read_b64_tr_b16 v[210:211], v13 offset:2048
  ds_read_b64_tr_b16 v[212:213], v13 offset:4096
  ds_read_b64_tr_b16 v[214:215], v13 offset:6144
  ds_read_b64_tr_b16 v[216:217], v13 offset:8192
  ds_read_b64_tr_b16 v[218:219], v13 offset:10240
  ds_read_b64_tr_b16 v[220:221], v13 offset:12288
  ds_read_b64_tr_b16 v[222:223], v13 offset:14336
  v_dot2c_f32_bf16 v22, s51, v160
  v_dot2c_f32_bf16 v23, s51, v161
  v_dot2c_f32_bf16 v22, s51, v162
  v_dot2c_f32_bf16 v23, s51, v163
  v_dot2c_f32_bf16 v22, s51, v164
  v_dot2c_f32_bf16 v23, s51, v165
  v_dot2c_f32_bf16 v22, s51, v166
  v_dot2c_f32_bf16 v23, s51, v167
  v_dot2c_f32_bf16 v22, s51, v168
  v_dot2c_f32_bf16 v23, s51, v169
  v_dot2c_f32_bf16 v22, s51, v170
  v_dot2c_f32_bf16 v23, s51, v171
  v_dot2c_f32_bf16 v22, s51, v172
  v_dot2c_f32_bf16 v23, s51, v173
  v_dot2c_f32_bf16 v22, s51, v174
  v_dot2c_f32_bf16 v23, s51, v175
  s_getpc_b64 s[94:95]
  s_cmp_ge_u32 s48, 28
  s_cbranch_scc0 REFRESH_4
  ds_read_b64_tr_b16 v[224:225], v12 offset:0
  ds_read_b64_tr_b16 v[226:227], v12 offset:2048
  ds_read_b64_tr_b16 v[228:229], v12 offset:4096
  ds_read_b64_tr_b16 v[230:231], v12 offset:6144
  ds_read_b64_tr_b16 v[232:233], v12 offset:8192
  ds_read_b64_tr_b16 v[234:235], v12 offset:10240
  ds_read_b64_tr_b16 v[236:237], v12 offset:12288
  ds_read_b64_tr_b16 v[238:239], v12 offset:14336
  v_dot2c_f32_bf16 v22, s51, v176
  v_dot2c_f32_bf16 v23, s51, v177
  v_dot2c_f32_bf16 v22, s51, v178
  v_dot2c_f32_bf16 v23, s51, v179
  v_dot2c_f32_bf16 v22, s51, v180
  v_dot2c_f32_bf16 v23, s51, v181
  v_dot2c_f32_bf16 v22, s51, v182
  v_dot2c_f32_bf16 v23, s51, v183
  v_dot2c_f32_bf16 v22, s51, v184
  v_dot2c_f32_bf16 v23, s51, v185
  v_dot2c_f32_bf16 v22, s51, v186
  v_dot2c_f32_bf16 v23, s51, v187
  v_dot2c_f32_bf16 v22, s51, v188
  v_dot2c_f32_bf16 v23, s51, v189
  v_dot2c_f32_bf16 v22, s51, v190
  v_dot2c_f32_bf16 v23, s51, v191
  s_getpc_b64 s[94:95]
  s_cmp_ge_u32 s48, 29
  s_cbranch_scc0 REFRESH_4
  ds_read_b64_tr_b16 v[240:241], v12 offset:16384
  ds_read_b64_tr_b16 v[242:243], v12 offset:18432
  ds_read_b64_tr_b16 v[244:245], v12 offset:20480
  ds_read_b64_tr_b16 v[246:247], v12 offset:22528
  ds_read_b64_tr_b16 v[248:249], v12 offset:24576
  ds_read_b64_tr_b16 v[250:251], v12 offset:26624
  ds_read_b64_tr_b16 v[252:253], v12 offset:28672
  ds_read_b64_tr_b16 v[254:255], v12 offset:30720
  v_mov_b32 v3, 12
  ds_write_b32 v7, v3
  v_dot2c_f32_bf16 v22, s51, v192
  v_dot2c_f32_bf16 v23, s51, v193
  v_dot2c_f32_bf16 v22, s51, v194
  v_dot2c_f32_bf16 v23, s51, v195
  v_dot2c_f32_bf16 v22, s51, v196
  v_dot2c_f32_bf16 v23, s51, v197
  v_dot2c_f32_bf16 v22, s51, v198
  v_dot2c_f32_bf16 v23, s51, v199
  v_dot2c_f32_bf16 v22, s51, v200
  v_dot2c_f32_bf16 v23, s51, v201
  v_dot2c_f32_bf16 v22, s51, v202
  v_dot2c_f32_bf16 v23, s51, v203
  v_dot2c_f32_bf16 v22, s51, v204
  v_dot2c_f32_bf16 v23, s51, v205
  v_dot2c_f32_bf16 v22, s51, v206
  v_dot2c_f32_bf16 v23, s51, v207
  s_waitcnt lgkmcnt(15)
  v_dot2c_f32_bf16 v22, s51, v208
  v_dot2c_f32_bf16 v23, s51, v209
  v_dot2c_f32_bf16 v22, s51, v210
  v_dot2c_f32_bf16 v23, s51, v211
  v_dot2c_f32_bf16 v22, s51, v212
  v_dot2c_f32_bf16 v23, s51, v213
  v_dot2c_f32_bf16 v22, s51, v214
  v_dot2c_f32_bf16 v23, s51, v215
  v_dot2c_f32_bf16 v22, s51, v216
  v_dot2c_f32_bf16 v23, s51, v217
  v_dot2c_f32_bf16 v22, s51, v218
  v_dot2c_f32_bf16 v23, s51, v219
  v_dot2c_f32_bf16 v22, s51, v220
  v_dot2c_f32_bf16 v23, s51, v221
  v_dot2c_f32_bf16 v22, s51, v222
  v_dot2c_f32_bf16 v23, s51, v223
  s_waitcnt lgkmcnt(9)
  v_dot2c_f32_bf16 v22, s51, v224
  v_dot2c_f32_bf16 v23, s51, v225
  v_dot2c_f32_bf16 v22, s51, v226
  v_dot2c_f32_bf16 v23, s51, v227
  v_dot2c_f32_bf16 v22, s51, v228
  v_dot2c_f32_bf16 v23, s51, v229
  v_dot2c_f32_bf16 v22, s51, v230
  v_dot2c_f32_bf16 v23, s51, v231
  v_dot2c_f32_bf16 v22, s51, v232
  v_dot2c_f32_bf16 v23, s51, v233
  v_dot2c_f32_bf16 v22, s51, v234
  v_dot2c_f32_bf16 v23, s51, v235
  v_dot2c_f32_bf16 v22, s51, v236
  v_dot2c_f32_bf16 v23, s51, v237
  v_dot2c_f32_bf16 v22, s51, v238
  v_dot2c_f32_bf16 v23, s51, v239
  s_waitcnt lgkmcnt(1)
  v_dot2c_f32_bf16 v22, s51, v240
  v_dot2c_f32_bf16 v23, s51, v241
  v_dot2c_f32_bf16 v22, s51, v242
  v_dot2c_f32_bf16 v23, s51, v243
  v_dot2c_f32_bf16 v22, s51, v244
  v_dot2c_f32_bf16 v23, s51, v245
  v_dot2c_f32_bf16 v22, s51, v246
  v_dot2c_f32_bf16 v23, s51, v247
  v_dot2c_f32_bf16 v22, s51, v248
  v_dot2c_f32_bf16 v23, s51, v249
  v_dot2c_f32_bf16 v22, s51, v250
  v_dot2c_f32_bf16 v23, s51, v251
  v_dot2c_f32_bf16 v22, s51, v252
  v_dot2c_f32_bf16 v23, s51, v253
  v_dot2c_f32_bf16 v22, s51, v254
  v_dot2c_f32_bf16 v23, s51, v255
  s_nop 2
  v_add_f32 v22, v22, v23
  v_cvt_pk_bf16_f32 v140, v22, v22
  v_and_b32 v3, 0xffff0000, v140
  v_sub_f32 v3, v22, v3
  v_cvt_pk_bf16_f32 v141, v3, 0
  s_mov_b32 s11, s88
  s_mov_b32 s88, s92
  s_mov_b32 s1, s93
  v_add_u32 v30, 98304, v5
  v_add_u32 v31, 65536, v5
  s_getpc_b64 s[94:95]
  s_cmp_ge_u32 s0, 10
  s_cbranch_scc0 REFRESH_7
  ds_read_b128 v[40:43], v30 offset:0
  ds_read_b32 v37, v2 offset:28
  ds_read_b128 v[44:47], v30 offset:1024
  ds_read_b128 v[48:51], v30 offset:2048
  ds_read_b128 v[52:55], v30 offset:3072
  ds_read_b128 v[56:59], v30 offset:4096
  ds_read_b128 v[60:63], v30 offset:5120
  ds_read_b128 v[64:67], v30 offset:6144
  s_waitcnt lgkmcnt(5)
  v_mfma_f32_32x32x16_bf16 v[88:103], v[144:147], v[40:43], 0
  v_readfirstlane_b32 s0, v37
  ds_read_b128 v[68:71], v30 offset:7168
  v_mfma_f32_32x32x16_bf16 v[88:103], v[148:151], v[44:47], v[88:103]
  s_getpc_b64 s[94:95]
  s_cmp_ge_u32 s0, 11
  s_cbranch_scc0 REFRESH_7
  ds_read_b128 v[40:43], v30 offset:8192
  ds_read_b32 v37, v2 offset:28
  s_waitcnt lgkmcnt(6)
  v_mfma_f32_32x32x16_bf16 v[88:103], v[152:155], v[48:51], v[88:103]
  ds_read_b128 v[44:47], v30 offset:9216
  v_mfma_f32_32x32x16_bf16 v[88:103], v[156:159], v[52:55], v[88:103]
  ds_read_b128 v[48:51], v30 offset:10240
  s_waitcnt lgkmcnt(6)
  v_mfma_f32_32x32x16_bf16 v[88:103], v[160:163], v[56:59], v[88:103]
  ds_read_b128 v[52:55], v30 offset:11264
  v_mfma_f32_32x32x16_bf16 v[88:103], v[164:167], v[60:63], v[88:103]
  ds_read_b128 v[56:59], v30 offset:12288
  s_waitcnt lgkmcnt(6)
  v_mfma_f32_32x32x16_bf16 v[88:103], v[168:171], v[64:67], v[88:103]
  ds_read_b128 v[60:63], v30 offset:13312
  v_mfma_f32_32x32x16_bf16 v[88:103], v[172:175], v[68:71], v[88:103]
  ds_read_b128 v[64:67], v30 offset:14336
  s_waitcnt lgkmcnt(5)
  v_mfma_f32_32x32x16_bf16 v[88:103], v[176:179], v[40:43], v[88:103]
  v_readfirstlane_b32 s0, v37
  ds_read_b128 v[68:71], v30 offset:15360
  v_mfma_f32_32x32x16_bf16 v[88:103], v[180:183], v[44:47], v[88:103]
  s_getpc_b64 s[94:95]
  s_cmp_ge_u32 s0, 13
  s_cbranch_scc0 REFRESH_7
  ds_read_b128 v[40:43], v30 offset:16384
  ds_read_b32 v37, v2 offset:28
  s_waitcnt lgkmcnt(6)
  v_mfma_f32_32x32x16_bf16 v[88:103], v[184:187], v[48:51], v[88:103]
  ds_read_b128 v[44:47], v30 offset:17408
  v_mfma_f32_32x32x16_bf16 v[88:103], v[188:191], v[52:55], v[88:103]
  ds_read_b128 v[48:51], v30 offset:18432
  s_waitcnt lgkmcnt(6)
  v_mfma_f32_32x32x16_bf16 v[88:103], v[192:195], v[56:59], v[88:103]
  ds_read_b128 v[52:55], v30 offset:19456
  v_mfma_f32_32x32x16_bf16 v[88:103], v[196:199], v[60:63], v[88:103]
  ds_read_b128 v[56:59], v30 offset:20480
  s_waitcnt lgkmcnt(6)
  v_mfma_f32_32x32x16_bf16 v[88:103], v[200:203], v[64:67], v[88:103]
  ds_read_b128 v[60:63], v30 offset:21504
  v_mfma_f32_32x32x16_bf16 v[88:103], v[204:207], v[68:71], v[88:103]
  ds_read_b128 v[64:67], v30 offset:22528
  ds_read_b128 v[8:11], v2 offset:16
  ds_read_b128 v[128:131], v29 offset:0
  s_waitcnt lgkmcnt(7)
  v_mfma_f32_32x32x16_bf16 v[88:103], v[208:211], v[40:43], v[88:103]
  v_readfirstlane_b32 s0, v37
  ds_read_b128 v[68:71], v30 offset:23552
  v_mov_b32 v3, 12
  ds_write_b32 v7, v3 offset:256
  v_mfma_f32_32x32x16_bf16 v[88:103], v[212:215], v[44:47], v[88:103]
  s_getpc_b64 s[94:95]
  s_cmp_ge_u32 s0, 14
  s_cbranch_scc0 REFRESH_7
  ds_read_b128 v[40:43], v30 offset:24576
  s_waitcnt lgkmcnt(8)
  v_mfma_f32_32x32x16_bf16 v[88:103], v[216:219], v[48:51], v[88:103]
  ds_read_b128 v[44:47], v30 offset:25600
  v_mfma_f32_32x32x16_bf16 v[88:103], v[220:223], v[52:55], v[88:103]
  ds_read_b128 v[48:51], v30 offset:26624
  s_waitcnt lgkmcnt(8)
  v_mfma_f32_32x32x16_bf16 v[88:103], v[224:227], v[56:59], v[88:103]
  ds_read_b128 v[52:55], v30 offset:27648
  v_mfma_f32_32x32x16_bf16 v[88:103], v[228:231], v[60:63], v[88:103]
  s_getpc_b64 s[94:95]
  s_cmp_ge_u32 s0, 16
  s_cbranch_scc0 REFRESH_7
  ds_read_b128 v[56:59], v30 offset:28672
  ds_read_b32 v37, v2 offset:28
  s_waitcnt lgkmcnt(7)
  v_mfma_f32_32x32x16_bf16 v[88:103], v[232:235], v[64:67], v[88:103]
  ds_read_b128 v[60:63], v30 offset:29696
  v_mfma_f32_32x32x16_bf16 v[88:103], v[236:239], v[68:71], v[88:103]
  ds_read_b128 v[64:67], v30 offset:30720
  v_readfirstlane_b32 s48, v8
  v_readfirstlane_b32 s52, v10
  s_waitcnt lgkmcnt(6)
  v_mfma_f32_32x32x16_bf16 v[88:103], v[240:243], v[40:43], v[88:103]
  ds_read_b128 v[68:71], v30 offset:31744
  v_mov_b32 v3, 16
  ds_write_b32 v7, v3 offset:256
  s_cmp_ge_u32 s52, 4
  s_cbranch_scc0 CE_187
CB_188:
  v_mov_b32 v136, v128
  v_mov_b32 v137, v129
  v_mfma_f32_32x32x16_bf16 v[88:103], v[244:247], v[44:47], v[88:103]
  ds_read_b128 v[40:43], v30 offset:32768
  s_waitcnt lgkmcnt(7)
  v_mfma_f32_32x32x16_bf16 v[88:103], v[248:251], v[48:51], v[88:103]
  ds_read_b128 v[44:47], v30 offset:33792
  v_mfma_f32_32x32x16_bf16 v[88:103], v[252:255], v[52:55], v[88:103]
  v_mfma_f32_32x32x16_bf16 v[88:103], v[140:143], v[136:139], v[88:103]
  v_mov_b32 v132, v130
  v_mov_b32 v133, v131
  ds_read_b128 v[48:51], v30 offset:34816
  s_waitcnt lgkmcnt(6)
  v_mfma_f32_32x32x16_bf16 v[104:119], v[144:147], v[56:59], 0
  v_readfirstlane_b32 s0, v37
  ds_read_b128 v[52:55], v30 offset:35840
  v_mfma_f32_32x32x16_bf16 v[104:119], v[148:151], v[60:63], v[104:119]
  s_nop 3
  v_mul_f32 v72, v88, v133
  v_mul_f32 v73, v89, v133
  v_exp_f32 v72, v72
  v_mul_f32 v74, v90, v133
  s_getpc_b64 s[94:95]
  s_cmp_ge_u32 s0, 17
  s_cbranch_scc0 REFRESH_7
  ds_read_b128 v[56:59], v30 offset:36864
  ds_read_b32 v37, v2 offset:28
  s_waitcnt lgkmcnt(7)
  v_mfma_f32_32x32x16_bf16 v[104:119], v[152:155], v[64:67], v[104:119]
  v_exp_f32 v73, v73
  v_mul_f32 v75, v91, v133
  v_exp_f32 v74, v74
  ds_read_b128 v[60:63], v30 offset:37888
  v_mfma_f32_32x32x16_bf16 v[104:119], v[156:159], v[68:71], v[104:119]
  v_mul_f32 v76, v92, v133
  v_exp_f32 v75, v75
  v_mul_f32 v77, v93, v133
  v_exp_f32 v76, v76
  ds_read_b128 v[64:67], v30 offset:38912
  s_waitcnt lgkmcnt(6)
  v_mfma_f32_32x32x16_bf16 v[104:119], v[160:163], v[40:43], v[104:119]
  v_mul_f32 v78, v94, v133
  v_exp_f32 v77, v77
  v_mul_f32 v79, v95, v133
  ds_read_b128 v[68:71], v30 offset:39936
  v_mov_b32 v3, 20
  ds_write_b32 v7, v3 offset:256
  v_mfma_f32_32x32x16_bf16 v[104:119], v[164:167], v[44:47], v[104:119]
  v_exp_f32 v78, v78
  v_exp_f32 v79, v79
  v_fma_f32 v72, v72, v132, v132
  v_fma_f32 v73, v73, v132, v132
  ds_read_b128 v[40:43], v30 offset:40960
  s_waitcnt lgkmcnt(7)
  v_mfma_f32_32x32x16_bf16 v[104:119], v[168:171], v[48:51], v[104:119]
  v_rcp_f32 v72, v72
  v_fma_f32 v74, v74, v132, v132
  v_rcp_f32 v73, v73
  ds_read_b128 v[44:47], v30 offset:41984
  v_mfma_f32_32x32x16_bf16 v[104:119], v[172:175], v[52:55], v[104:119]
  v_fma_f32 v75, v75, v132, v132
  v_rcp_f32 v74, v74
  v_fma_f32 v76, v76, v132, v132
  ds_read_b128 v[48:51], v30 offset:43008
  s_waitcnt lgkmcnt(6)
  v_mfma_f32_32x32x16_bf16 v[104:119], v[176:179], v[56:59], v[104:119]
  v_rcp_f32 v75, v75
  v_fma_f32 v77, v77, v132, v132
  v_rcp_f32 v76, v76
  v_fma_f32 v78, v78, v132, v132
  v_readfirstlane_b32 s0, v37
  ds_read_b128 v[52:55], v30 offset:44032
  v_mfma_f32_32x32x16_bf16 v[104:119], v[180:183], v[60:63], v[104:119]
  v_rcp_f32 v77, v77
  v_fma_f32 v79, v79, v132, v132
  v_rcp_f32 v78, v78
  s_getpc_b64 s[94:95]
  s_cmp_ge_u32 s0, 18
  s_cbranch_scc0 REFRESH_7
  ds_read_b128 v[56:59], v30 offset:45056
  s_waitcnt lgkmcnt(6)
  v_mfma_f32_32x32x16_bf16 v[104:119], v[184:187], v[64:67], v[104:119]
  v_rcp_f32 v79, v79
  v_mul_f32 v72, v72, v88
  v_mul_f32 v73, v73, v89
  v_mul_f32 v74, v74, v90
  ds_read_b128 v[60:63], v30 offset:46080
  v_mfma_f32_32x32x16_bf16 v[104:119], v[188:191], v[68:71], v[104:119]
  v_mul_f32 v75, v75, v91
  v_mul_f32 v76, v76, v92
  v_mul_f32 v77, v77, v93
  ds_read_b128 v[64:67], v30 offset:47104
  s_waitcnt lgkmcnt(5)
  v_mfma_f32_32x32x16_bf16 v[104:119], v[192:195], v[40:43], v[104:119]
  v_mul_f32 v78, v78, v94
  v_mul_f32 v79, v79, v95
  v_cvt_pk_bf16_f32 v88, v72, v73
  v_cvt_pk_bf16_f32 v89, v74, v75
  ds_read_b128 v[68:71], v30 offset:48128
  v_mov_b32 v3, 24
  ds_write_b32 v7, v3 offset:256
  v_mfma_f32_32x32x16_bf16 v[104:119], v[196:199], v[44:47], v[104:119]
  v_cvt_pk_bf16_f32 v90, v76, v77
  v_cvt_pk_bf16_f32 v91, v78, v79
  v_mul_f32 v80, v96, v133
  ds_read_b128 v[40:43], v30 offset:49152
  ds_read_b32 v37, v2 offset:28
  s_waitcnt lgkmcnt(7)
  v_mfma_f32_32x32x16_bf16 v[104:119], v[200:203], v[48:51], v[104:119]
  v_mul_f32 v81, v97, v133
  v_exp_f32 v80, v80
  v_mul_f32 v82, v98, v133
  ds_read_b128 v[44:47], v30 offset:50176
  v_mfma_f32_32x32x16_bf16 v[104:119], v[204:207], v[52:55], v[104:119]
  v_exp_f32 v81, v81
  v_mul_f32 v83, v99, v133
  v_exp_f32 v82, v82
  v_mul_f32 v84, v100, v133
  ds_read_b128 v[48:51], v30 offset:51200
  ds_read_b128 v[8:11], v2 offset:16
  ds_read_b128 v[128:131], v29 offset:1024
  s_waitcnt lgkmcnt(9)
  v_mfma_f32_32x32x16_bf16 v[104:119], v[208:211], v[56:59], v[104:119]
  v_exp_f32 v83, v83
  v_mul_f32 v85, v101, v133
  v_exp_f32 v84, v84
  ds_read_b128 v[52:55], v30 offset:52224
  v_mfma_f32_32x32x16_bf16 v[104:119], v[212:215], v[60:63], v[104:119]
  v_mul_f32 v86, v102, v133
  v_exp_f32 v85, v85
  v_mul_f32 v87, v103, v133
  v_exp_f32 v86, v86
  ds_read_b128 v[56:59], v30 offset:53248
  s_waitcnt lgkmcnt(9)
  v_mfma_f32_32x32x16_bf16 v[104:119], v[216:219], v[64:67], v[104:119]
  v_exp_f32 v87, v87
  v_fma_f32 v80, v80, v132, v132
  v_fma_f32 v81, v81, v132, v132
  ds_read_b128 v[60:63], v30 offset:54272
  v_mfma_f32_32x32x16_bf16 v[104:119], v[220:223], v[68:71], v[104:119]
  v_rcp_f32 v80, v80
  v_fma_f32 v82, v82, v132, v132
  v_rcp_f32 v81, v81
  v_fma_f32 v83, v83, v132, v132
  ds_read_b128 v[64:67], v30 offset:55296
  s_waitcnt lgkmcnt(7)
  v_mfma_f32_32x32x16_bf16 v[104:119], v[224:227], v[40:43], v[104:119]
  v_rcp_f32 v82, v82
  v_fma_f32 v84, v84, v132, v132
  v_rcp_f32 v83, v83
  v_readfirstlane_b32 s0, v37
  ds_read_b128 v[68:71], v30 offset:56320
  v_mov_b32 v3, 28
  ds_write_b32 v7, v3 offset:256
  v_mfma_f32_32x32x16_bf16 v[104:119], v[228:231], v[44:47], v[104:119]
  v_fma_f32 v85, v85, v132, v132
  v_rcp_f32 v84, v84
  v_fma_f32 v86, v86, v132, v132
  s_getpc_b64 s[94:95]
  s_cmp_ge_u32 s0, 20
  s_cbranch_scc0 REFRESH_7
  ds_read_b128 v[40:43], v5 offset:0
  ds_read_b32 v37, v2 offset:28
  s_waitcnt lgkmcnt(7)
  v_mfma_f32_32x32x16_bf16 v[104:119], v[232:235], v[48:51], v[104:119]
  v_rcp_f32 v85, v85
  v_fma_f32 v87, v87, v132, v132
  v_rcp_f32 v86, v86
  v_rcp_f32 v87, v87
  ds_read_b128 v[44:47], v5 offset:1024
  v_mfma_f32_32x32x16_bf16 v[104:119], v[236:239], v[52:55], v[104:119]
  v_mul_f32 v80, v80, v96
  v_mul_f32 v81, v81, v97
  v_mul_f32 v82, v82, v98
  ds_read_b128 v[48:51], v5 offset:2048
  v_readfirstlane_b32 s48, v8
  v_readfirstlane_b32 s52, v9
  s_waitcnt lgkmcnt(7)
  v_mfma_f32_32x32x16_bf16 v[104:119], v[240:243], v[56:59], v[104:119]
  v_mul_f32 v83, v83, v99
  v_mul_f32 v84, v84, v100
  v_mul_f32 v85, v85, v101
  v_mul_f32 v86, v86, v102
  ds_read_b128 v[52:55], v5 offset:3072
  s_cmp_ge_u32 s52, 4
  s_cbranch_scc0 CE_191
CB_192:
  v_mov_b32 v136, v128
  v_mov_b32 v137, v129
  v_mfma_f32_32x32x16_bf16 v[104:119], v[244:247], v[60:63], v[104:119]
  v_mul_f32 v87, v87, v103
  v_cvt_pk_bf16_f32 v92, v80, v81
  v_cvt_pk_bf16_f32 v93, v82, v83
  ds_read_b128 v[56:59], v5 offset:4096
  s_waitcnt lgkmcnt(7)
  v_mfma_f32_32x32x16_bf16 v[104:119], v[248:251], v[64:67], v[104:119]
  v_cvt_pk_bf16_f32 v94, v84, v85
  v_cvt_pk_bf16_f32 v95, v86, v87
  buffer_store_dwordx4 v[88:91], v5, s[24:27], s88 offen offset:0 sc1
  buffer_store_dwordx4 v[92:95], v5, s[24:27], s88 offen offset:1024 sc1
  s_add_u32 s88, s88, 114688
  ds_read_b128 v[60:63], v5 offset:5120
  v_mfma_f32_32x32x16_bf16 v[104:119], v[252:255], v[68:71], v[104:119]
  v_mfma_f32_32x32x16_bf16 v[104:119], v[140:143], v[136:139], v[104:119]
  v_mov_b32 v132, v130
  v_mov_b32 v133, v131
  ds_read_b128 v[64:67], v5 offset:6144
  s_waitcnt lgkmcnt(5)
  v_mfma_f32_32x32x16_bf16 v[88:103], v[144:147], v[40:43], 0
  v_readfirstlane_b32 s0, v37
  ds_read_b128 v[68:71], v5 offset:7168
  v_mov_b32 v3, 32
  ds_write_b32 v7, v3 offset:256
  v_mfma_f32_32x32x16_bf16 v[88:103], v[148:151], v[44:47], v[88:103]
  s_nop 1
  v_mul_f32 v72, v104, v133
  v_mul_f32 v73, v105, v133
  v_exp_f32 v72, v72
  v_mul_f32 v74, v106, v133
  s_getpc_b64 s[94:95]
  s_cmp_ge_u32 s0, 21
  s_cbranch_scc0 REFRESH_7
  ds_read_b128 v[40:43], v5 offset:8192
  ds_read_b32 v37, v2 offset:28
  s_waitcnt lgkmcnt(7)
  v_mfma_f32_32x32x16_bf16 v[88:103], v[152:155], v[48:51], v[88:103]
  v_exp_f32 v73, v73
  v_mul_f32 v75, v107, v133
  v_exp_f32 v74, v74
  ds_read_b128 v[44:47], v5 offset:9216
  v_mfma_f32_32x32x16_bf16 v[88:103], v[156:159], v[52:55], v[88:103]
  v_mul_f32 v76, v108, v133
  v_exp_f32 v75, v75
  v_mul_f32 v77, v109, v133
  v_exp_f32 v76, v76
  ds_read_b128 v[48:51], v5 offset:10240
  s_waitcnt lgkmcnt(7)
  v_mfma_f32_32x32x16_bf16 v[88:103], v[160:163], v[56:59], v[88:103]
  v_mul_f32 v78, v110, v133
  v_exp_f32 v77, v77
  v_mul_f32 v79, v111, v133
  ds_read_b128 v[52:55], v5 offset:11264
  v_mfma_f32_32x32x16_bf16 v[88:103], v[164:167], v[60:63], v[88:103]
  v_exp_f32 v78, v78
  v_exp_f32 v79, v79
  v_fma_f32 v72, v72, v132, v132
  v_fma_f32 v73, v73, v132, v132
  ds_read_b128 v[56:59], v5 offset:12288
  s_waitcnt lgkmcnt(7)
  v_mfma_f32_32x32x16_bf16 v[88:103], v[168:171], v[64:67], v[88:103]
  v_rcp_f32 v72, v72
  v_fma_f32 v74, v74, v132, v132
  v_rcp_f32 v73, v73
  ds_read_b128 v[60:63], v5 offset:13312
  v_mfma_f32_32x32x16_bf16 v[88:103], v[172:175], v[68:71], v[88:103]
  v_fma_f32 v75, v75, v132, v132
  v_rcp_f32 v74, v74
  v_fma_f32 v76, v76, v132, v132
  ds_read_b128 v[64:67], v5 offset:14336
  s_waitcnt lgkmcnt(5)
  v_mfma_f32_32x32x16_bf16 v[88:103], v[176:179], v[40:43], v[88:103]
  v_rcp_f32 v75, v75
  v_fma_f32 v77, v77, v132, v132
  v_rcp_f32 v76, v76
  v_fma_f32 v78, v78, v132, v132
  v_readfirstlane_b32 s0, v37
  ds_read_b128 v[68:71], v5 offset:15360
  v_mov_b32 v3, 36
  ds_write_b32 v7, v3 offset:256
  v_mfma_f32_32x32x16_bf16 v[88:103], v[180:183], v[44:47], v[88:103]
  v_rcp_f32 v77, v77
  v_fma_f32 v79, v79, v132, v132
  v_rcp_f32 v78, v78
  s_getpc_b64 s[94:95]
  s_cmp_ge_u32 s0, 22
  s_cbranch_scc0 REFRESH_7
  ds_read_b128 v[40:43], v5 offset:16384
  s_waitcnt lgkmcnt(6)
  v_mfma_f32_32x32x16_bf16 v[88:103], v[184:187], v[48:51], v[88:103]
  v_rcp_f32 v79, v79
  v_mul_f32 v72, v72, v104
  v_mul_f32 v73, v73, v105
  v_mul_f32 v74, v74, v106
  ds_read_b128 v[44:47], v5 offset:17408
  v_mfma_f32_32x32x16_bf16 v[88:103], v[188:191], v[52:55], v[88:103]
  v_mul_f32 v75, v75, v107
  v_mul_f32 v76, v76, v108
  v_mul_f32 v77, v77, v109
  ds_read_b128 v[48:51], v5 offset:18432
  s_waitcnt lgkmcnt(6)
  v_mfma_f32_32x32x16_bf16 v[88:103], v[192:195], v[56:59], v[88:103]
  v_mul_f32 v78, v78, v110
  v_mul_f32 v79, v79, v111
  v_cvt_pk_bf16_f32 v104, v72, v73
  v_cvt_pk_bf16_f32 v105, v74, v75
  ds_read_b128 v[52:55], v5 offset:19456
  v_mfma_f32_32x32x16_bf16 v[88:103], v[196:199], v[60:63], v[88:103]
  v_cvt_pk_bf16_f32 v106, v76, v77
  v_cvt_pk_bf16_f32 v107, v78, v79
  v_mul_f32 v80, v112, v133
  ds_read_b128 v[56:59], v5 offset:20480
  ds_read_b32 v37, v2 offset:28
  s_waitcnt lgkmcnt(7)
  v_mfma_f32_32x32x16_bf16 v[88:103], v[200:203], v[64:67], v[88:103]
  v_mul_f32 v81, v113, v133
  v_exp_f32 v80, v80
  v_mul_f32 v82, v114, v133
  ds_read_b128 v[60:63], v5 offset:21504
  v_mfma_f32_32x32x16_bf16 v[88:103], v[204:207], v[68:71], v[88:103]
  v_exp_f32 v81, v81
  v_mul_f32 v83, v115, v133
  v_exp_f32 v82, v82
  v_mul_f32 v84, v116, v133
  ds_read_b128 v[64:67], v5 offset:22528
  ds_read_b128 v[8:11], v2 offset:16
  ds_read_b128 v[128:131], v29 offset:2048
  s_waitcnt lgkmcnt(8)
  v_mfma_f32_32x32x16_bf16 v[88:103], v[208:211], v[40:43], v[88:103]
  v_exp_f32 v83, v83
  v_mul_f32 v85, v117, v133
  v_exp_f32 v84, v84
  ds_read_b128 v[68:71], v5 offset:23552
  v_mov_b32 v3, 40
  ds_write_b32 v7, v3 offset:256
  v_mfma_f32_32x32x16_bf16 v[88:103], v[212:215], v[44:47], v[88:103]
  v_mul_f32 v86, v118, v133
  v_exp_f32 v85, v85
  v_mul_f32 v87, v119, v133
  v_exp_f32 v86, v86
  ds_read_b128 v[40:43], v5 offset:24576
  s_waitcnt lgkmcnt(9)
  v_mfma_f32_32x32x16_bf16 v[88:103], v[216:219], v[48:51], v[88:103]
  v_exp_f32 v87, v87
  v_fma_f32 v80, v80, v132, v132
  v_fma_f32 v81, v81, v132, v132
  ds_read_b128 v[44:47], v5 offset:25600
  v_mfma_f32_32x32x16_bf16 v[88:103], v[220:223], v[52:55], v[88:103]
  v_rcp_f32 v80, v80
  v_fma_f32 v82, v82, v132, v132
  v_rcp_f32 v81, v81
  v_fma_f32 v83, v83, v132, v132
  ds_read_b128 v[48:51], v5 offset:26624
  s_waitcnt lgkmcnt(8)
  v_mfma_f32_32x32x16_bf16 v[88:103], v[224:227], v[56:59], v[88:103]
  v_rcp_f32 v82, v82
  v_fma_f32 v84, v84, v132, v132
  v_rcp_f32 v83, v83
  v_readfirstlane_b32 s0, v37
  ds_read_b128 v[52:55], v5 offset:27648
  v_mov_b32 v3, 42
  ds_write_b32 v7, v3 offset:256
  v_mfma_f32_32x32x16_bf16 v[88:103], v[228:231], v[60:63], v[88:103]
  v_fma_f32 v85, v85, v132, v132
  v_rcp_f32 v84, v84
  v_fma_f32 v86, v86, v132, v132
  s_getpc_b64 s[94:95]
  s_cmp_ge_u32 s0, 24
  s_cbranch_scc0 REFRESH_7
  ds_read_b128 v[56:59], v31 offset:0
  ds_read_b32 v37, v2 offset:28
  s_waitcnt lgkmcnt(8)
  v_mfma_f32_32x32x16_bf16 v[88:103], v[232:235], v[64:67], v[88:103]
  v_rcp_f32 v85, v85
  v_fma_f32 v87, v87, v132, v132
  v_rcp_f32 v86, v86
  v_rcp_f32 v87, v87
  ds_read_b128 v[60:63], v31 offset:1024
  v_mfma_f32_32x32x16_bf16 v[88:103], v[236:239], v[68:71], v[88:103]
  v_mul_f32 v80, v80, v112
  v_mul_f32 v81, v81, v113
  v_mul_f32 v82, v82, v114
  ds_read_b128 v[64:67], v31 offset:2048
  v_readfirstlane_b32 s48, v8
  v_readfirstlane_b32 s52, v10
  s_waitcnt lgkmcnt(7)
  v_mfma_f32_32x32x16_bf16 v[88:103], v[240:243], v[40:43], v[88:103]
  v_mul_f32 v83, v83, v115
  v_mul_f32 v84, v84, v116
  v_mul_f32 v85, v85, v117
  v_mul_f32 v86, v86, v118
  ds_read_b128 v[68:71], v31 offset:3072
  s_cmp_ge_u32 s52, 5
  s_cbranch_scc0 CE_195
CB_196:
  v_mov_b32 v136, v128
  v_mov_b32 v137, v129
  v_mfma_f32_32x32x16_bf16 v[88:103], v[244:247], v[44:47], v[88:103]
  v_mul_f32 v87, v87, v119
  v_cvt_pk_bf16_f32 v108, v80, v81
  v_cvt_pk_bf16_f32 v109, v82, v83
  ds_read_b128 v[40:43], v31 offset:4096
  s_waitcnt lgkmcnt(7)
  v_mfma_f32_32x32x16_bf16 v[88:103], v[248:251], v[48:51], v[88:103]
  v_cvt_pk_bf16_f32 v110, v84, v85
  v_cvt_pk_bf16_f32 v111, v86, v87
  buffer_store_dwordx4 v[104:107], v5, s[24:27], s88 offen offset:0 sc1
  buffer_store_dwordx4 v[108:111], v5, s[24:27], s88 offen offset:1024 sc1
  ds_read_b128 v[44:47], v31 offset:5120
  v_mfma_f32_32x32x16_bf16 v[88:103], v[252:255], v[52:55], v[88:103]
  v_mfma_f32_32x32x16_bf16 v[88:103], v[140:143], v[136:139], v[88:103]
  v_mov_b32 v132, v130
  v_mov_b32 v133, v131
  ds_read_b128 v[48:51], v31 offset:6144
  s_waitcnt lgkmcnt(5)
  v_mfma_f32_32x32x16_bf16 v[104:119], v[144:147], v[56:59], 0
  v_readfirstlane_b32 s0, v37
  ds_read_b128 v[52:55], v31 offset:7168
  v_mov_b32 v3, 46
  ds_write_b32 v7, v3 offset:256
  v_mfma_f32_32x32x16_bf16 v[104:119], v[148:151], v[60:63], v[104:119]
  s_nop 1
  v_mul_f32 v72, v88, v133
  v_mul_f32 v73, v89, v133
  v_exp_f32 v72, v72
  v_mul_f32 v74, v90, v133
  s_getpc_b64 s[94:95]
  s_cmp_ge_u32 s0, 25
  s_cbranch_scc0 REFRESH_7
  ds_read_b128 v[56:59], v31 offset:8192
  ds_read_b32 v37, v2 offset:28
  s_waitcnt lgkmcnt(7)
  v_mfma_f32_32x32x16_bf16 v[104:119], v[152:155], v[64:67], v[104:119]
  v_exp_f32 v73, v73
  v_mul_f32 v75, v91, v133
  v_exp_f32 v74, v74
  ds_read_b128 v[60:63], v31 offset:9216
  v_mfma_f32_32x32x16_bf16 v[104:119], v[156:159], v[68:71], v[104:119]
  v_mul_f32 v76, v92, v133
  v_exp_f32 v75, v75
  v_mul_f32 v77, v93, v133
  v_exp_f32 v76, v76
  ds_read_b128 v[64:67], v31 offset:10240
  s_waitcnt lgkmcnt(7)
  v_mfma_f32_32x32x16_bf16 v[104:119], v[160:163], v[40:43], v[104:119]
  v_mul_f32 v78, v94, v133
  v_exp_f32 v77, v77
  v_mul_f32 v79, v95, v133
  ds_read_b128 v[68:71], v31 offset:11264
  v_mfma_f32_32x32x16_bf16 v[104:119], v[164:167], v[44:47], v[104:119]
  v_exp_f32 v78, v78
  v_exp_f32 v79, v79
  v_fma_f32 v72, v72, v132, v132
  v_fma_f32 v73, v73, v132, v132
  ds_read_b128 v[40:43], v31 offset:12288
  s_waitcnt lgkmcnt(7)
  v_mfma_f32_32x32x16_bf16 v[104:119], v[168:171], v[48:51], v[104:119]
  v_rcp_f32 v72, v72
  v_fma_f32 v74, v74, v132, v132
  v_rcp_f32 v73, v73
  ds_read_b128 v[44:47], v31 offset:13312
  v_mfma_f32_32x32x16_bf16 v[104:119], v[172:175], v[52:55], v[104:119]
  v_fma_f32 v75, v75, v132, v132
  v_rcp_f32 v74, v74
  v_fma_f32 v76, v76, v132, v132
  ds_read_b128 v[48:51], v31 offset:14336
  s_waitcnt lgkmcnt(5)
  v_mfma_f32_32x32x16_bf16 v[104:119], v[176:179], v[56:59], v[104:119]
  v_rcp_f32 v75, v75
  v_fma_f32 v77, v77, v132, v132
  v_rcp_f32 v76, v76
  v_fma_f32 v78, v78, v132, v132
  v_readfirstlane_b32 s0, v37
  ds_read_b128 v[52:55], v31 offset:15360
  v_mov_b32 v3, 50
  ds_write_b32 v7, v3 offset:256
  v_mfma_f32_32x32x16_bf16 v[104:119], v[180:183], v[60:63], v[104:119]
  v_rcp_f32 v77, v77
  v_fma_f32 v79, v79, v132, v132
  v_rcp_f32 v78, v78
  s_getpc_b64 s[94:95]
  s_cmp_ge_u32 s0, 26
  s_cbranch_scc0 REFRESH_7
  ds_read_b128 v[56:59], v31 offset:16384
  s_waitcnt lgkmcnt(6)
  v_mfma_f32_32x32x16_bf16 v[104:119], v[184:187], v[64:67], v[104:119]
  v_rcp_f32 v79, v79
  v_mul_f32 v72, v72, v88
  v_mul_f32 v73, v73, v89
  v_mul_f32 v74, v74, v90
  ds_read_b128 v[60:63], v31 offset:17408
  s_waitcnt vmcnt(0)
  s_mov_b64 exec, 1
  s_cmp_eq_u32 s54, 0
  s_cbranch_scc1 CE_199
  buffer_store_dword v6, v5, s[24:27], s1 offen
CB_200:
  s_mov_b64 exec, -1
  v_mfma_f32_32x32x16_bf16 v[104:119], v[188:191], v[68:71], v[104:119]
  v_mul_f32 v75, v75, v91
  v_mul_f32 v76, v76, v92
  v_mul_f32 v77, v77, v93
  ds_read_b128 v[64:67], v31 offset:18432
  s_waitcnt lgkmcnt(6)
  v_mfma_f32_32x32x16_bf16 v[104:119], v[192:195], v[40:43], v[104:119]
  v_mul_f32 v78, v78, v94
  v_mul_f32 v79, v79, v95
  v_cvt_pk_bf16_f32 v88, v72, v73
  v_cvt_pk_bf16_f32 v89, v74, v75
  ds_read_b128 v[68:71], v31 offset:19456
  v_mfma_f32_32x32x16_bf16 v[104:119], v[196:199], v[44:47], v[104:119]
  v_cvt_pk_bf16_f32 v90, v76, v77
  v_cvt_pk_bf16_f32 v91, v78, v79
  v_mul_f32 v80, v96, v133
  ds_read_b128 v[40:43], v31 offset:20480
  s_waitcnt lgkmcnt(6)
  v_mfma_f32_32x32x16_bf16 v[104:119], v[200:203], v[48:51], v[104:119]
  v_mul_f32 v81, v97, v133
  v_exp_f32 v80, v80
  v_mul_f32 v82, v98, v133
  ds_read_b128 v[44:47], v31 offset:21504
  v_mfma_f32_32x32x16_bf16 v[104:119], v[204:207], v[52:55], v[104:119]
  v_exp_f32 v81, v81
  v_mul_f32 v83, v99, v133
  v_exp_f32 v82, v82
  v_mul_f32 v84, v100, v133
  ds_read_b128 v[48:51], v31 offset:22528
  ds_read_b128 v[8:11], v2 offset:16
  ds_read_b128 v[128:131], v29 offset:3072
  s_waitcnt lgkmcnt(7)
  v_mfma_f32_32x32x16_bf16 v[104:119], v[208:211], v[56:59], v[104:119]
  v_exp_f32 v83, v83
  v_mul_f32 v85, v101, v133
  v_exp_f32 v84, v84
  ds_read_b128 v[52:55], v31 offset:23552
  v_mov_b32 v3, 54
  ds_write_b32 v7, v3 offset:256
  v_mfma_f32_32x32x16_bf16 v[104:119], v[212:215], v[60:63], v[104:119]
  v_mul_f32 v86, v102, v133
  v_exp_f32 v85, v85
  v_mul_f32 v87, v103, v133
  v_exp_f32 v86, v86
  ds_read_b128 v[56:59], v31 offset:24576
  s_waitcnt lgkmcnt(8)
  v_mfma_f32_32x32x16_bf16 v[104:119], v[216:219], v[64:67], v[104:119]
  v_exp_f32 v87, v87
  v_fma_f32 v80, v80, v132, v132
  v_fma_f32 v81, v81, v132, v132
  ds_read_b128 v[60:63], v31 offset:25600
  v_mfma_f32_32x32x16_bf16 v[104:119], v[220:223], v[68:71], v[104:119]
  v_rcp_f32 v80, v80
  v_fma_f32 v82, v82, v132, v132
  v_rcp_f32 v81, v81
  v_fma_f32 v83, v83, v132, v132
  ds_read_b128 v[64:67], v31 offset:26624
  s_waitcnt lgkmcnt(8)
  v_mfma_f32_32x32x16_bf16 v[104:119], v[224:227], v[40:43], v[104:119]
  v_rcp_f32 v82, v82
  v_fma_f32 v84, v84, v132, v132
  v_rcp_f32 v83, v83
  ds_read_b128 v[68:71], v31 offset:27648
  v_mov_b32 v3, 56
  ds_write_b32 v7, v3 offset:256
  v_mfma_f32_32x32x16_bf16 v[104:119], v[228:231], v[44:47], v[104:119]
  v_fma_f32 v85, v85, v132, v132
  v_rcp_f32 v84, v84
  v_fma_f32 v86, v86, v132, v132
  s_waitcnt lgkmcnt(6)
  v_mfma_f32_32x32x16_bf16 v[104:119], v[232:235], v[48:51], v[104:119]
  v_rcp_f32 v85, v85
  v_fma_f32 v87, v87, v132, v132
  v_rcp_f32 v86, v86
  v_rcp_f32 v87, v87
  v_mfma_f32_32x32x16_bf16 v[104:119], v[236:239], v[52:55], v[104:119]
  v_mul_f32 v80, v80, v96
  v_mul_f32 v81, v81, v97
  v_mul_f32 v82, v82, v98
  v_readfirstlane_b32 s48, v8
  v_readfirstlane_b32 s52, v9
  s_waitcnt lgkmcnt(3)
  v_mfma_f32_32x32x16_bf16 v[104:119], v[240:243], v[56:59], v[104:119]
  v_mul_f32 v83, v83, v99
  v_mul_f32 v84, v84, v100
  v_mul_f32 v85, v85, v101
  v_mul_f32 v86, v86, v102
  s_cmp_ge_u32 s52, 5
  s_cbranch_scc0 CE_201
CB_202:
  v_mov_b32 v136, v128
  v_mov_b32 v137, v129
  s_mov_b64 exec, 0xfffffff
  buffer_load_dword v25, v24, s[24:27], s6 offen sc1
  s_mov_b64 exec, -1
  v_mfma_f32_32x32x16_bf16 v[104:119], v[244:247], v[60:63], v[104:119]
  v_mul_f32 v87, v87, v103
  v_cvt_pk_bf16_f32 v92, v80, v81
  v_cvt_pk_bf16_f32 v93, v82, v83
  s_waitcnt lgkmcnt(1)
  v_mfma_f32_32x32x16_bf16 v[104:119], v[248:251], v[64:67], v[104:119]
  v_cvt_pk_bf16_f32 v94, v84, v85
  v_cvt_pk_bf16_f32 v95, v86, v87
  buffer_store_dwordx4 v[88:91], v5, s[24:27], s4 offen offset:0 sc1
  buffer_store_dwordx4 v[92:95], v5, s[24:27], s4 offen offset:1024 sc1
  s_add_u32 s4, s4, 114688
  v_mfma_f32_32x32x16_bf16 v[104:119], v[252:255], v[68:71], v[104:119]
  v_mfma_f32_32x32x16_bf16 v[104:119], v[140:143], v[136:139], v[104:119]
  v_mov_b32 v132, v130
  v_mov_b32 v133, v131
  s_waitcnt vmcnt(2)
  v_cmp_ne_u32 vcc, s53, v25
  s_and_b32 s49, vcc_lo, s10
  s_cbranch_scc1 CE_205
CB_206:
  s_lshl_b32 s91, s7, 13
  s_add_u32 s91, s91, s9
  s_add_u32 s7, s7, s8
  s_cmp_ge_u32 s7, 7
  s_cselect_b32 s50, 7, 0
  s_sub_u32 s7, s7, s50
  buffer_load_dwordx4 v[144:147], v5, s[24:27], s91 offen offset:0 sc1
  buffer_load_dwordx4 v[148:151], v5, s[24:27], s91 offen offset:1024 sc1
  buffer_load_dwordx4 v[152:155], v5, s[24:27], s91 offen offset:2048 sc1
  buffer_load_dwordx4 v[156:159], v5, s[24:27], s91 offen offset:3072 sc1
  s_add_u32 s91, s91, 4096
  buffer_load_dwordx4 v[160:163], v5, s[24:27], s91 offen offset:0 sc1
  buffer_load_dwordx4 v[164:167], v5, s[24:27], s91 offen offset:1024 sc1
  buffer_load_dwordx4 v[168:171], v5, s[24:27], s91 offen offset:2048 sc1
  buffer_load_dwordx4 v[172:175], v5, s[24:27], s91 offen offset:3072 sc1
  v_pk_mul_f32 v[72:73], v[104:105], v[132:133] op_sel:[0,1] op_sel_hi:[1,1]
  v_pk_mul_f32 v[74:75], v[106:107], v[132:133] op_sel:[0,1] op_sel_hi:[1,1]
  v_pk_mul_f32 v[76:77], v[108:109], v[132:133] op_sel:[0,1] op_sel_hi:[1,1]
  v_pk_mul_f32 v[78:79], v[110:111], v[132:133] op_sel:[0,1] op_sel_hi:[1,1]
  v_pk_mul_f32 v[80:81], v[112:113], v[132:133] op_sel:[0,1] op_sel_hi:[1,1]
  v_pk_mul_f32 v[82:83], v[114:115], v[132:133] op_sel:[0,1] op_sel_hi:[1,1]
  v_pk_mul_f32 v[84:85], v[116:117], v[132:133] op_sel:[0,1] op_sel_hi:[1,1]
  v_pk_mul_f32 v[86:87], v[118:119], v[132:133] op_sel:[0,1] op_sel_hi:[1,1]
  v_exp_f32 v72, v72
  v_exp_f32 v73, v73
  v_exp_f32 v74, v74
  v_exp_f32 v75, v75
  v_exp_f32 v76, v76
  v_exp_f32 v77, v77
  v_exp_f32 v78, v78
  v_exp_f32 v79, v79
  v_exp_f32 v80, v80
  v_exp_f32 v81, v81
  v_exp_f32 v82, v82
  v_exp_f32 v83, v83
  v_exp_f32 v84, v84
  v_exp_f32 v85, v85
  v_exp_f32 v86, v86
  v_exp_f32 v87, v87
  v_pk_fma_f32 v[72:73], v[72:73], v[132:133], v[132:133] op_sel_hi:[1,0,0]
  v_pk_fma_f32 v[74:75], v[74:75], v[132:133], v[132:133] op_sel_hi:[1,0,0]
  v_pk_fma_f32 v[76:77], v[76:77], v[132:133], v[132:133] op_sel_hi:[1,0,0]
  v_pk_fma_f32 v[78:79], v[78:79], v[132:133], v[132:133] op_sel_hi:[1,0,0]
  v_pk_fma_f32 v[80:81], v[80:81], v[132:133], v[132:133] op_sel_hi:[1,0,0]
  v_pk_fma_f32 v[82:83], v[82:83], v[132:133], v[132:133] op_sel_hi:[1,0,0]
  v_pk_fma_f32 v[84:85], v[84:85], v[132:133], v[132:133] op_sel_hi:[1,0,0]
  v_pk_fma_f32 v[86:87], v[86:87], v[132:133], v[132:133] op_sel_hi:[1,0,0]
  v_rcp_f32 v72, v72
  v_rcp_f32 v73, v73
  v_rcp_f32 v74, v74
  v_rcp_f32 v75, v75
  v_rcp_f32 v76, v76
  v_rcp_f32 v77, v77
  v_rcp_f32 v78, v78
  v_rcp_f32 v79, v79
  v_rcp_f32 v80, v80
  v_rcp_f32 v81, v81
  v_rcp_f32 v82, v82
  v_rcp_f32 v83, v83
  v_rcp_f32 v84, v84
  v_rcp_f32 v85, v85
  v_rcp_f32 v86, v86
  v_rcp_f32 v87, v87
  v_pk_mul_f32 v[72:73], v[72:73], v[104:105]
  v_pk_mul_f32 v[74:75], v[74:75], v[106:107]
  v_pk_mul_f32 v[76:77], v[76:77], v[108:109]
  v_pk_mul_f32 v[78:79], v[78:79], v[110:111]
  v_pk_mul_f32 v[80:81], v[80:81], v[112:113]
  v_pk_mul_f32 v[82:83], v[82:83], v[114:115]
  v_pk_mul_f32 v[84:85], v[84:85], v[116:117]
  v_pk_mul_f32 v[86:87], v[86:87], v[118:119]
  v_cvt_pk_bf16_f32 v104, v72, v73
  v_cvt_pk_bf16_f32 v105, v74, v75
  v_cvt_pk_bf16_f32 v106, v76, v77
  v_cvt_pk_bf16_f32 v107, v78, v79
  v_cvt_pk_bf16_f32 v108, v80, v81
  v_cvt_pk_bf16_f32 v109, v82, v83
  v_cvt_pk_bf16_f32 v110, v84, v85
  v_cvt_pk_bf16_f32 v111, v86, v87
  buffer_store_dwordx4 v[104:107], v5, s[24:27], s4 offen offset:0 sc1
  buffer_store_dwordx4 v[108:111], v5, s[24:27], s4 offen offset:1024 sc1
  s_getpc_b64 s[94:95]
  s_cmp_ge_u32 s48, 31
  s_cbranch_scc0 REFRESH_4
  s_cmp_eq_u32 s101, 0
  s_cselect_b32 s49, 8, 10
  s_lshl_b32 s49, s49, 12
  v_add_u32 v18, s49, v16
  v_add_u32 v19, s49, v17
  ds_read_b64_tr_b16 v[40:41], v18 offset:0
  ds_read_b64_tr_b16 v[42:43], v18 offset:1024
  ds_read_b64_tr_b16 v[44:45], v19 offset:0
  ds_read_b64_tr_b16 v[46:47], v19 offset:1024
  ds_read_b32 v37, v2 offset:16
  ds_read_b64_tr_b16 v[48:49], v18 offset:2048
  ds_read_b64_tr_b16 v[50:51], v18 offset:3072
  ds_read_b64_tr_b16 v[52:53], v19 offset:2048
  ds_read_b64_tr_b16 v[54:55], v19 offset:3072
  s_lshl_b32 s91, s7, 13
  s_add_u32 s91, s91, s9
  s_add_u32 s7, s7, s8
  s_cmp_ge_u32 s7, 7
  s_cselect_b32 s50, 7, 0
  s_sub_u32 s7, s7, s50
  buffer_load_dwordx4 v[176:179], v5, s[24:27], s91 offen offset:0 sc1
  buffer_load_dwordx4 v[180:183], v5, s[24:27], s91 offen offset:1024 sc1
  v_lshlrev_b32 v88, 16, v120
  v_and_b32 v89, 0xffff0000, v120
  v_lshlrev_b32 v90, 16, v121
  v_and_b32 v91, 0xffff0000, v121
  v_lshlrev_b32 v92, 16, v122
  v_and_b32 v93, 0xffff0000, v122
  v_lshlrev_b32 v94, 16, v123
  v_and_b32 v95, 0xffff0000, v123
  v_lshlrev_b32 v96, 16, v124
  v_and_b32 v97, 0xffff0000, v124
  v_lshlrev_b32 v98, 16, v125
  v_and_b32 v99, 0xffff0000, v125
  v_lshlrev_b32 v100, 16, v126
  v_and_b32 v101, 0xffff0000, v126
  v_lshlrev_b32 v102, 16, v127
  v_and_b32 v103, 0xffff0000, v127
  ds_read_b64_tr_b16 v[56:57], v18 offset:4096
  ds_read_b64_tr_b16 v[58:59], v18 offset:5120
  ds_read_b64_tr_b16 v[60:61], v19 offset:4096
  ds_read_b64_tr_b16 v[62:63], v19 offset:5120
  s_waitcnt vmcnt(11) lgkmcnt(9)
  v_mfma_f32_32x32x16_bf16 v[104:119], v[44:47], v[144:147], 0
  buffer_load_dwordx4 v[184:187], v5, s[24:27], s91 offen offset:2048 sc1
  v_mfma_f32_32x32x16_bf16 v[88:103], v[40:43], v[144:147], v[88:103]
  s_waitcnt lgkmcnt(8)
  v_readfirstlane_b32 s48, v37
  ds_read_b64_tr_b16 v[64:65], v18 offset:6144
  ds_read_b64_tr_b16 v[66:67], v18 offset:7168
  ds_read_b64_tr_b16 v[68:69], v19 offset:6144
  ds_read_b64_tr_b16 v[70:71], v19 offset:7168
  v_mov_b32 v3, 17
  ds_write_b32 v7, v3
  s_waitcnt vmcnt(11) lgkmcnt(9)
  v_mfma_f32_32x32x16_bf16 v[104:119], v[52:55], v[148:151], v[104:119]
  buffer_load_dwordx4 v[188:191], v5, s[24:27], s91 offen offset:3072 sc1
  s_add_u32 s91, s91, 4096
  v_mfma_f32_32x32x16_bf16 v[88:103], v[48:51], v[148:151], v[88:103]
  s_getpc_b64 s[94:95]
  s_cmp_ge_u32 s48, 33
  s_cbranch_scc0 REFRESH_4
  s_cmp_eq_u32 s101, 0
  s_cselect_b32 s49, 24, 26
  s_lshl_b32 s49, s49, 12
  v_add_u32 v18, s49, v16
  v_add_u32 v19, s49, v17
  ds_read_b64_tr_b16 v[40:41], v18 offset:0
  ds_read_b64_tr_b16 v[42:43], v18 offset:1024
  ds_read_b64_tr_b16 v[44:45], v19 offset:0
  ds_read_b64_tr_b16 v[46:47], v19 offset:1024
  ds_read_b32 v37, v2 offset:16
  s_waitcnt vmcnt(11) lgkmcnt(10)
  v_mfma_f32_32x32x16_bf16 v[104:119], v[60:63], v[152:155], v[104:119]
  buffer_load_dwordx4 v[192:195], v5, s[24:27], s91 offen offset:0 sc1
  v_mfma_f32_32x32x16_bf16 v[88:103], v[56:59], v[152:155], v[88:103]
  ds_read_b64_tr_b16 v[48:49], v18 offset:2048
  ds_read_b64_tr_b16 v[50:51], v18 offset:3072
  ds_read_b64_tr_b16 v[52:53], v19 offset:2048
  ds_read_b64_tr_b16 v[54:55], v19 offset:3072
  s_waitcnt vmcnt(5) lgkmcnt(10)
  v_mfma_f32_32x32x16_bf16 v[104:119], v[68:71], v[156:159], v[104:119]
  s_mov_b64 exec, 1
  s_cmp_eq_u32 s54, 0
  s_cbranch_scc1 CE_208
  buffer_store_dword v6, v5, s[24:27], s5 offen
CB_209:
  s_mov_b64 exec, -1
  buffer_load_dwordx4 v[196:199], v5, s[24:27], s91 offen offset:1024 sc1
  v_mfma_f32_32x32x16_bf16 v[88:103], v[64:67], v[156:159], v[88:103]
  ds_read_b64_tr_b16 v[56:57], v18 offset:4096
  ds_read_b64_tr_b16 v[58:59], v18 offset:5120
  ds_read_b64_tr_b16 v[60:61], v19 offset:4096
  ds_read_b64_tr_b16 v[62:63], v19 offset:5120
  s_waitcnt vmcnt(12) lgkmcnt(9)
  v_mfma_f32_32x32x16_bf16 v[104:119], v[44:47], v[160:163], v[104:119]
  buffer_load_dwordx4 v[200:203], v5, s[24:27], s91 offen offset:2048 sc1
  v_mfma_f32_32x32x16_bf16 v[88:103], v[40:43], v[160:163], v[88:103]
  s_waitcnt lgkmcnt(8)
  v_readfirstlane_b32 s48, v37
  ds_read_b64_tr_b16 v[64:65], v18 offset:6144
  ds_read_b64_tr_b16 v[66:67], v18 offset:7168
  ds_read_b64_tr_b16 v[68:69], v19 offset:6144
  ds_read_b64_tr_b16 v[70:71], v19 offset:7168
  v_mov_b32 v3, 18
  ds_write_b32 v7, v3
  s_waitcnt vmcnt(12) lgkmcnt(9)
  v_mfma_f32_32x32x16_bf16 v[104:119], v[52:55], v[164:167], v[104:119]
  buffer_load_dwordx4 v[204:207], v5, s[24:27], s91 offen offset:3072 sc1
  v_mfma_f32_32x32x16_bf16 v[88:103], v[48:51], v[164:167], v[88:103]
  s_getpc_b64 s[94:95]
  s_cmp_ge_u32 s48, 35
  s_cbranch_scc0 REFRESH_4
  s_cmp_eq_u32 s101, 0
  s_cselect_b32 s49, 12, 14
  s_lshl_b32 s49, s49, 12
  v_add_u32 v18, s49, v16
  v_add_u32 v19, s49, v17
  ds_read_b64_tr_b16 v[40:41], v18 offset:0
  ds_read_b64_tr_b16 v[42:43], v18 offset:1024
  ds_read_b64_tr_b16 v[44:45], v19 offset:0
  ds_read_b64_tr_b16 v[46:47], v19 offset:1024
  ds_read_b32 v37, v2 offset:16
  s_waitcnt vmcnt(12) lgkmcnt(10)
  v_mfma_f32_32x32x16_bf16 v[104:119], v[60:63], v[168:171], v[104:119]
  s_lshl_b32 s91, s7, 13
  s_add_u32 s91, s91, s9
  s_add_u32 s7, s7, s8
  s_cmp_ge_u32 s7, 7
  s_cselect_b32 s50, 7, 0
  s_sub_u32 s7, s7, s50
  buffer_load_dwordx4 v[208:211], v5, s[24:27], s91 offen offset:0 sc1
  v_mfma_f32_32x32x16_bf16 v[88:103], v[56:59], v[168:171], v[88:103]
  ds_read_b64_tr_b16 v[48:49], v18 offset:2048
  ds_read_b64_tr_b16 v[50:51], v18 offset:3072
  ds_read_b64_tr_b16 v[52:53], v19 offset:2048
  ds_read_b64_tr_b16 v[54:55], v19 offset:3072
  s_waitcnt vmcnt(12) lgkmcnt(10)
  v_mfma_f32_32x32x16_bf16 v[104:119], v[68:71], v[172:175], v[104:119]
  buffer_load_dwordx4 v[212:215], v5, s[24:27], s91 offen offset:1024 sc1
  v_mfma_f32_32x32x16_bf16 v[88:103], v[64:67], v[172:175], v[88:103]
  ds_read_b64_tr_b16 v[56:57], v18 offset:4096
  ds_read_b64_tr_b16 v[58:59], v18 offset:5120
  ds_read_b64_tr_b16 v[60:61], v19 offset:4096
  ds_read_b64_tr_b16 v[62:63], v19 offset:5120
  s_waitcnt vmcnt(10) lgkmcnt(9)
  v_mfma_f32_32x32x16_bf16 v[104:119], v[44:47], v[176:179], v[104:119]
  buffer_load_dwordx4 v[216:219], v5, s[24:27], s91 offen offset:2048 sc1
  v_mfma_f32_32x32x16_bf16 v[88:103], v[40:43], v[176:179], v[88:103]
  s_waitcnt lgkmcnt(8)
  v_readfirstlane_b32 s48, v37
  ds_read_b64_tr_b16 v[64:65], v18 offset:6144
  ds_read_b64_tr_b16 v[66:67], v18 offset:7168
  ds_read_b64_tr_b16 v[68:69], v19 offset:6144
  ds_read_b64_tr_b16 v[70:71], v19 offset:7168
  v_mov_b32 v3, 19
  ds_write_b32 v7, v3
  s_waitcnt vmcnt(10) lgkmcnt(9)
  v_mfma_f32_32x32x16_bf16 v[104:119], v[52:55], v[180:183], v[104:119]
  s_mov_b64 exec, 0xfffffff
  buffer_load_dword v25, v24, s[24:27], s6 offen sc1
  s_mov_b64 exec, -1
  buffer_load_dwordx4 v[220:223], v5, s[24:27], s91 offen offset:3072 sc1
  s_add_u32 s91, s91, 4096
  v_mfma_f32_32x32x16_bf16 v[88:103], v[48:51], v[180:183], v[88:103]
  s_getpc_b64 s[94:95]
  s_cmp_ge_u32 s48, 37
  s_cbranch_scc0 REFRESH_4
  s_cmp_eq_u32 s101, 0
  s_cselect_b32 s49, 28, 30
  s_lshl_b32 s49, s49, 12
  v_add_u32 v18, s49, v16
  v_add_u32 v19, s49, v17
  ds_read_b64_tr_b16 v[40:41], v18 offset:0
  ds_read_b64_tr_b16 v[42:43], v18 offset:1024
  ds_read_b64_tr_b16 v[44:45], v19 offset:0
  ds_read_b64_tr_b16 v[46:47], v19 offset:1024
  ds_read_b32 v37, v2 offset:16
  s_waitcnt vmcnt(11) lgkmcnt(10)
  v_mfma_f32_32x32x16_bf16 v[104:119], v[60:63], v[184:187], v[104:119]
  buffer_load_dwordx4 v[224:227], v5, s[24:27], s91 offen offset:0 sc1
  v_mfma_f32_32x32x16_bf16 v[88:103], v[56:59], v[184:187], v[88:103]
  ds_read_b64_tr_b16 v[48:49], v18 offset:2048
  ds_read_b64_tr_b16 v[50:51], v18 offset:3072
  ds_read_b64_tr_b16 v[52:53], v19 offset:2048
  ds_read_b64_tr_b16 v[54:55], v19 offset:3072
  s_waitcnt vmcnt(11) lgkmcnt(10)
  v_mfma_f32_32x32x16_bf16 v[104:119], v[68:71], v[188:191], v[104:119]
  buffer_load_dwordx4 v[228:231], v5, s[24:27], s91 offen offset:1024 sc1
  v_mfma_f32_32x32x16_bf16 v[88:103], v[64:67], v[188:191], v[88:103]
  ds_read_b64_tr_b16 v[56:57], v18 offset:4096
  ds_read_b64_tr_b16 v[58:59], v18 offset:5120
  ds_read_b64_tr_b16 v[60:61], v19 offset:4096
  ds_read_b64_tr_b16 v[62:63], v19 offset:5120
  s_waitcnt vmcnt(11) lgkmcnt(9)
  v_mfma_f32_32x32x16_bf16 v[104:119], v[44:47], v[192:195], v[104:119]
  buffer_load_dwordx4 v[232:235], v5, s[24:27], s91 offen offset:2048 sc1
  v_mfma_f32_32x32x16_bf16 v[88:103], v[40:43], v[192:195], v[88:103]
  s_waitcnt lgkmcnt(8)
  v_readfirstlane_b32 s48, v37
  ds_read_b64_tr_b16 v[64:65], v18 offset:6144
  ds_read_b64_tr_b16 v[66:67], v18 offset:7168
  ds_read_b64_tr_b16 v[68:69], v19 offset:6144
  ds_read_b64_tr_b16 v[70:71], v19 offset:7168
  v_mov_b32 v3, 20
  ds_write_b32 v7, v3
  s_waitcnt vmcnt(10) lgkmcnt(9)
  v_mfma_f32_32x32x16_bf16 v[104:119], v[52:55], v[196:199], v[104:119]
  buffer_load_dwordx4 v[236:239], v5, s[24:27], s91 offen offset:3072 sc1
  v_mfma_f32_32x32x16_bf16 v[88:103], v[48:51], v[196:199], v[88:103]
  s_getpc_b64 s[94:95]
  s_cmp_ge_u32 s48, 39
  s_cbranch_scc0 REFRESH_4
  s_cmp_eq_u32 s101, 0
  s_cselect_b32 s49, 32, 34
  s_lshl_b32 s49, s49, 12
  v_add_u32 v18, s49, v16
  v_add_u32 v19, s49, v17
  ds_read_b64_tr_b16 v[40:41], v18 offset:0
  ds_read_b64_tr_b16 v[42:43], v18 offset:1024
  ds_read_b64_tr_b16 v[44:45], v19 offset:0
  ds_read_b64_tr_b16 v[46:47], v19 offset:1024
  ds_read_b32 v37, v2 offset:16
  s_waitcnt vmcnt(5) lgkmcnt(10)
  v_mfma_f32_32x32x16_bf16 v[104:119], v[60:63], v[200:203], v[104:119]
  v_cmp_ne_u32 vcc, s53, v25
  s_and_b32 s49, vcc_lo, 0xfffffff
  s_cbranch_scc1 CE_210
CB_211:
  s_lshl_b32 s91, s7, 13
  s_add_u32 s91, s91, s9
  s_add_u32 s7, s7, s8
  s_cmp_ge_u32 s7, 7
  s_cselect_b32 s50, 7, 0
  s_sub_u32 s7, s7, s50
  buffer_load_dwordx4 v[240:243], v5, s[24:27], s91 offen offset:0 sc1
  v_mfma_f32_32x32x16_bf16 v[88:103], v[56:59], v[200:203], v[88:103]
  ds_read_b64_tr_b16 v[48:49], v18 offset:2048
  ds_read_b64_tr_b16 v[50:51], v18 offset:3072
  ds_read_b64_tr_b16 v[52:53], v19 offset:2048
  ds_read_b64_tr_b16 v[54:55], v19 offset:3072
  s_waitcnt vmcnt(10) lgkmcnt(10)
  v_mfma_f32_32x32x16_bf16 v[104:119], v[68:71], v[204:207], v[104:119]
  buffer_load_dwordx4 v[244:247], v5, s[24:27], s91 offen offset:1024 sc1
  v_mfma_f32_32x32x16_bf16 v[88:103], v[64:67], v[204:207], v[88:103]
  ds_read_b64_tr_b16 v[56:57], v18 offset:4096
  ds_read_b64_tr_b16 v[58:59], v18 offset:5120
  ds_read_b64_tr_b16 v[60:61], v19 offset:4096
  ds_read_b64_tr_b16 v[62:63], v19 offset:5120
  s_waitcnt vmcnt(10) lgkmcnt(9)
  v_mfma_f32_32x32x16_bf16 v[104:119], v[44:47], v[208:211], v[104:119]
  buffer_load_dwordx4 v[248:251], v5, s[24:27], s91 offen offset:2048 sc1
  v_mfma_f32_32x32x16_bf16 v[88:103], v[40:43], v[208:211], v[88:103]
  s_waitcnt lgkmcnt(8)
  v_readfirstlane_b32 s48, v37
  ds_read_b64_tr_b16 v[64:65], v18 offset:6144
  ds_read_b64_tr_b16 v[66:67], v18 offset:7168
  ds_read_b64_tr_b16 v[68:69], v19 offset:6144
  ds_read_b64_tr_b16 v[70:71], v19 offset:7168
  v_mov_b32 v3, 21
  ds_write_b32 v7, v3
  s_waitcnt vmcnt(10) lgkmcnt(9)
  v_mfma_f32_32x32x16_bf16 v[104:119], v[52:55], v[212:215], v[104:119]
  buffer_load_dwordx4 v[252:255], v5, s[24:27], s91 offen offset:3072 sc1
  s_add_u32 s91, s91, 4096
  v_mfma_f32_32x32x16_bf16 v[88:103], v[48:51], v[212:215], v[88:103]
  s_getpc_b64 s[94:95]
  s_cmp_ge_u32 s48, 41
  s_cbranch_scc0 REFRESH_4
  s_cmp_eq_u32 s101, 0
  s_cselect_b32 s49, 36, 0
  s_lshl_b32 s49, s49, 12
  v_add_u32 v18, s49, v16
  v_add_u32 v19, s49, v17
  ds_read_b64_tr_b16 v[40:41], v18 offset:0
  ds_read_b64_tr_b16 v[42:43], v18 offset:1024
  ds_read_b64_tr_b16 v[44:45], v19 offset:0
  ds_read_b64_tr_b16 v[46:47], v19 offset:1024
  ds_read_b32 v37, v2 offset:16
  s_waitcnt vmcnt(10) lgkmcnt(10)
  v_mfma_f32_32x32x16_bf16 v[104:119], v[60:63], v[216:219], v[104:119]
  buffer_load_dwordx4 v[144:147], v5, s[24:27], s91 offen offset:0 sc1
  v_mfma_f32_32x32x16_bf16 v[88:103], v[56:59], v[216:219], v[88:103]
  ds_read_b64_tr_b16 v[48:49], v18 offset:2048
  ds_read_b64_tr_b16 v[50:51], v18 offset:3072
  ds_read_b64_tr_b16 v[52:53], v19 offset:2048
  ds_read_b64_tr_b16 v[54:55], v19 offset:3072
  s_waitcnt vmcnt(9) lgkmcnt(10)
  v_mfma_f32_32x32x16_bf16 v[104:119], v[68:71], v[220:223], v[104:119]
  buffer_load_dwordx4 v[148:151], v5, s[24:27], s91 offen offset:1024 sc1
  v_mfma_f32_32x32x16_bf16 v[88:103], v[64:67], v[220:223], v[88:103]
  ds_read_b64_tr_b16 v[56:57], v18 offset:4096
  ds_read_b64_tr_b16 v[58:59], v18 offset:5120
  ds_read_b64_tr_b16 v[60:61], v19 offset:4096
  ds_read_b64_tr_b16 v[62:63], v19 offset:5120
  s_waitcnt vmcnt(9) lgkmcnt(9)
  v_mfma_f32_32x32x16_bf16 v[104:119], v[44:47], v[224:227], v[104:119]
  buffer_load_dwordx4 v[152:155], v5, s[24:27], s91 offen offset:2048 sc1
  v_mfma_f32_32x32x16_bf16 v[88:103], v[40:43], v[224:227], v[88:103]
  s_waitcnt lgkmcnt(8)
  v_readfirstlane_b32 s48, v37
  ds_read_b64_tr_b16 v[64:65], v18 offset:6144
  ds_read_b64_tr_b16 v[66:67], v18 offset:7168
  ds_read_b64_tr_b16 v[68:69], v19 offset:6144
  ds_read_b64_tr_b16 v[70:71], v19 offset:7168
  v_mov_b32 v3, 22
  ds_write_b32 v7, v3
  s_waitcnt vmcnt(9) lgkmcnt(9)
  v_mfma_f32_32x32x16_bf16 v[104:119], v[52:55], v[228:231], v[104:119]
  buffer_load_dwordx4 v[156:159], v5, s[24:27], s91 offen offset:3072 sc1
  v_mfma_f32_32x32x16_bf16 v[88:103], v[48:51], v[228:231], v[88:103]
  s_getpc_b64 s[94:95]
  s_cmp_ge_u32 s48, 43
  s_cbranch_scc0 REFRESH_4
  s_cmp_eq_u32 s101, 0
  s_cselect_b32 s49, 2, 4
  s_lshl_b32 s49, s49, 12
  v_add_u32 v18, s49, v16
  v_add_u32 v19, s49, v17
  ds_read_b64_tr_b16 v[40:41], v18 offset:0
  ds_read_b64_tr_b16 v[42:43], v18 offset:1024
  ds_read_b64_tr_b16 v[44:45], v19 offset:0
  ds_read_b64_tr_b16 v[46:47], v19 offset:1024
  ds_read_b32 v37, v2 offset:16
  s_waitcnt vmcnt(9) lgkmcnt(10)
  v_mfma_f32_32x32x16_bf16 v[104:119], v[60:63], v[232:235], v[104:119]
  s_lshl_b32 s91, s7, 13
  s_add_u32 s91, s91, s9
  s_add_u32 s7, s7, s8
  s_cmp_ge_u32 s7, 7
  s_cselect_b32 s50, 7, 0
  s_sub_u32 s7, s7, s50
  buffer_load_dwordx4 v[160:163], v5, s[24:27], s91 offen offset:0 sc1
  v_mfma_f32_32x32x16_bf16 v[88:103], v[56:59], v[232:235], v[88:103]
  ds_read_b64_tr_b16 v[48:49], v18 offset:2048
  ds_read_b64_tr_b16 v[50:51], v18 offset:3072
  ds_read_b64_tr_b16 v[52:53], v19 offset:2048
  ds_read_b64_tr_b16 v[54:55], v19 offset:3072
  s_waitcnt vmcnt(9) lgkmcnt(10)
  v_mfma_f32_32x32x16_bf16 v[104:119], v[68:71], v[236:239], v[104:119]
  buffer_load_dwordx4 v[164:167], v5, s[24:27], s91 offen offset:1024 sc1
  v_mfma_f32_32x32x16_bf16 v[88:103], v[64:67], v[236:239], v[88:103]
  ds_read_b64_tr_b16 v[56:57], v18 offset:4096
  ds_read_b64_tr_b16 v[58:59], v18 offset:5120
  ds_read_b64_tr_b16 v[60:61], v19 offset:4096
  ds_read_b64_tr_b16 v[62:63], v19 offset:5120
  s_waitcnt vmcnt(9) lgkmcnt(9)
  v_mfma_f32_32x32x16_bf16 v[104:119], v[44:47], v[240:243], v[104:119]
  buffer_load_dwordx4 v[168:171], v5, s[24:27], s91 offen offset:2048 sc1
  v_mfma_f32_32x32x16_bf16 v[88:103], v[40:43], v[240:243], v[88:103]
  s_waitcnt lgkmcnt(8)
  v_readfirstlane_b32 s48, v37
  ds_read_b64_tr_b16 v[64:65], v18 offset:6144
  ds_read_b64_tr_b16 v[66:67], v18 offset:7168
  ds_read_b64_tr_b16 v[68:69], v19 offset:6144
  ds_read_b64_tr_b16 v[70:71], v19 offset:7168
  s_waitcnt vmcnt(9) lgkmcnt(8)
  v_mfma_f32_32x32x16_bf16 v[104:119], v[52:55], v[244:247], v[104:119]
  buffer_load_dwordx4 v[172:175], v5, s[24:27], s91 offen offset:3072 sc1
  s_add_u32 s91, s91, 4096
  v_mfma_f32_32x32x16_bf16 v[88:103], v[48:51], v[244:247], v[88:103]
  s_getpc_b64 s[94:95]
  s_cmp_ge_u32 s48, 45
  s_cbranch_scc0 REFRESH_4
  s_cmp_eq_u32 s101, 0
  s_cselect_b32 s49, 6, 16
  s_lshl_b32 s49, s49, 12
  v_add_u32 v18, s49, v16
  v_add_u32 v19, s49, v17
  ds_read_b64_tr_b16 v[40:41], v18 offset:0
  ds_read_b64_tr_b16 v[42:43], v18 offset:1024
  ds_read_b64_tr_b16 v[44:45], v19 offset:0
  ds_read_b64_tr_b16 v[46:47], v19 offset:1024
  ds_read_b32 v37, v2 offset:16
  s_waitcnt vmcnt(9) lgkmcnt(9)
  v_mfma_f32_32x32x16_bf16 v[104:119], v[60:63], v[248:251], v[104:119]
  buffer_load_dwordx4 v[176:179], v5, s[24:27], s91 offen offset:0 sc1
  v_mfma_f32_32x32x16_bf16 v[88:103], v[56:59], v[248:251], v[88:103]
  ds_read_b64_tr_b16 v[48:49], v18 offset:2048
  ds_read_b64_tr_b16 v[50:51], v18 offset:3072
  ds_read_b64_tr_b16 v[52:53], v19 offset:2048
  ds_read_b64_tr_b16 v[54:55], v19 offset:3072
  s_waitcnt vmcnt(9) lgkmcnt(9)
  v_mfma_f32_32x32x16_bf16 v[104:119], v[68:71], v[252:255], v[104:119]
  buffer_load_dwordx4 v[180:183], v5, s[24:27], s91 offen offset:1024 sc1
  v_mfma_f32_32x32x16_bf16 v[88:103], v[64:67], v[252:255], v[88:103]
  ds_read_b64_tr_b16 v[56:57], v18 offset:4096
  ds_read_b64_tr_b16 v[58:59], v18 offset:5120
  ds_read_b64_tr_b16 v[60:61], v19 offset:4096
  ds_read_b64_tr_b16 v[62:63], v19 offset:5120
  s_waitcnt vmcnt(9) lgkmcnt(9)
  v_mfma_f32_32x32x16_bf16 v[104:119], v[44:47], v[144:147], v[104:119]
  buffer_load_dwordx4 v[184:187], v5, s[24:27], s91 offen offset:2048 sc1
  v_mfma_f32_32x32x16_bf16 v[88:103], v[40:43], v[144:147], v[88:103]
  s_waitcnt lgkmcnt(8)
  v_readfirstlane_b32 s48, v37
  ds_read_b64_tr_b16 v[64:65], v18 offset:6144
  ds_read_b64_tr_b16 v[66:67], v18 offset:7168
  ds_read_b64_tr_b16 v[68:69], v19 offset:6144
  ds_read_b64_tr_b16 v[70:71], v19 offset:7168
  s_waitcnt vmcnt(9) lgkmcnt(8)
  v_mfma_f32_32x32x16_bf16 v[104:119], v[52:55], v[148:151], v[104:119]
  buffer_load_dwordx4 v[188:191], v5, s[24:27], s91 offen offset:3072 sc1
  v_mfma_f32_32x32x16_bf16 v[88:103], v[48:51], v[148:151], v[88:103]
  s_getpc_b64 s[94:95]
  s_cmp_ge_u32 s48, 47
  s_cbranch_scc0 REFRESH_4
  s_cmp_eq_u32 s101, 0
  s_cselect_b32 s49, 18, 20
  s_lshl_b32 s49, s49, 12
  v_add_u32 v18, s49, v16
  v_add_u32 v19, s49, v17
  ds_read_b64_tr_b16 v[40:41], v18 offset:0
  ds_read_b64_tr_b16 v[42:43], v18 offset:1024
  ds_read_b64_tr_b16 v[44:45], v19 offset:0
  ds_read_b64_tr_b16 v[46:47], v19 offset:1024
  ds_read_b32 v37, v2 offset:16
  s_waitcnt vmcnt(9) lgkmcnt(9)
  v_mfma_f32_32x32x16_bf16 v[104:119], v[60:63], v[152:155], v[104:119]
  s_lshl_b32 s91, s7, 13
  s_add_u32 s91, s91, s9
  s_add_u32 s7, s7, s8
  s_cmp_ge_u32 s7, 7
  s_cselect_b32 s50, 7, 0
  s_sub_u32 s7, s7, s50
  buffer_load_dwordx4 v[192:195], v5, s[24:27], s91 offen offset:0 sc1
  v_mfma_f32_32x32x16_bf16 v[88:103], v[56:59], v[152:155], v[88:103]
  ds_read_b64_tr_b16 v[48:49], v18 offset:2048
  ds_read_b64_tr_b16 v[50:51], v18 offset:3072
  ds_read_b64_tr_b16 v[52:53], v19 offset:2048
  ds_read_b64_tr_b16 v[54:55], v19 offset:3072
  s_waitcnt vmcnt(9) lgkmcnt(9)
  v_mfma_f32_32x32x16_bf16 v[104:119], v[68:71], v[156:159], v[104:119]
  buffer_load_dwordx4 v[196:199], v5, s[24:27], s91 offen offset:1024 sc1
  v_mfma_f32_32x32x16_bf16 v[88:103], v[64:67], v[156:159], v[88:103]
  ds_read_b64_tr_b16 v[56:57], v18 offset:4096
  ds_read_b64_tr_b16 v[58:59], v18 offset:5120
  ds_read_b64_tr_b16 v[60:61], v19 offset:4096
  ds_read_b64_tr_b16 v[62:63], v19 offset:5120
  s_waitcnt vmcnt(9) lgkmcnt(9)
  v_mfma_f32_32x32x16_bf16 v[104:119], v[44:47], v[160:163], v[104:119]
  buffer_load_dwordx4 v[200:203], v5, s[24:27], s91 offen offset:2048 sc1
  v_mfma_f32_32x32x16_bf16 v[88:103], v[40:43], v[160:163], v[88:103]
  s_waitcnt lgkmcnt(8)
  v_readfirstlane_b32 s48, v37
  ds_read_b64_tr_b16 v[64:65], v18 offset:6144
  ds_read_b64_tr_b16 v[66:67], v18 offset:7168
  ds_read_b64_tr_b16 v[68:69], v19 offset:6144
  ds_read_b64_tr_b16 v[70:71], v19 offset:7168
  s_waitcnt vmcnt(9) lgkmcnt(8)
  v_mfma_f32_32x32x16_bf16 v[104:119], v[52:55], v[164:167], v[104:119]
  buffer_load_dwordx4 v[204:207], v5, s[24:27], s91 offen offset:3072 sc1
  s_add_u32 s91, s91, 4096
  v_mfma_f32_32x32x16_bf16 v[88:103], v[48:51], v[164:167], v[88:103]
  s_getpc_b64 s[94:95]
  s_cmp_ge_u32 s48, 49
  s_cbranch_scc0 REFRESH_4
  s_cmp_eq_u32 s101, 0
  s_cselect_b32 s49, 22, 8
  s_lshl_b32 s49, s49, 12
  v_add_u32 v18, s49, v16
  v_add_u32 v19, s49, v17
  ds_read_b64_tr_b16 v[40:41], v18 offset:0
  ds_read_b64_tr_b16 v[42:43], v18 offset:1024
  ds_read_b64_tr_b16 v[44:45], v19 offset:0
  ds_read_b64_tr_b16 v[46:47], v19 offset:1024
  ds_read_b32 v37, v2 offset:16
  s_waitcnt vmcnt(9) lgkmcnt(9)
  v_mfma_f32_32x32x16_bf16 v[104:119], v[60:63], v[168:171], v[104:119]
  buffer_load_dwordx4 v[208:211], v5, s[24:27], s91 offen offset:0 sc1
  v_mfma_f32_32x32x16_bf16 v[88:103], v[56:59], v[168:171], v[88:103]
  ds_read_b64_tr_b16 v[48:49], v18 offset:2048
  ds_read_b64_tr_b16 v[50:51], v18 offset:3072
  ds_read_b64_tr_b16 v[52:53], v19 offset:2048
  ds_read_b64_tr_b16 v[54:55], v19 offset:3072
  s_waitcnt vmcnt(9) lgkmcnt(9)
  v_mfma_f32_32x32x16_bf16 v[104:119], v[68:71], v[172:175], v[104:119]
  buffer_load_dwordx4 v[212:215], v5, s[24:27], s91 offen offset:1024 sc1
  v_mfma_f32_32x32x16_bf16 v[88:103], v[64:67], v[172:175], v[88:103]
  ds_read_b64_tr_b16 v[56:57], v18 offset:4096
  ds_read_b64_tr_b16 v[58:59], v18 offset:5120
  ds_read_b64_tr_b16 v[60:61], v19 offset:4096
  ds_read_b64_tr_b16 v[62:63], v19 offset:5120
  s_waitcnt vmcnt(9) lgkmcnt(9)
  v_mfma_f32_32x32x16_bf16 v[104:119], v[44:47], v[176:179], v[104:119]
  buffer_load_dwordx4 v[216:219], v5, s[24:27], s91 offen offset:2048 sc1
  v_mfma_f32_32x32x16_bf16 v[88:103], v[40:43], v[176:179], v[88:103]
  s_waitcnt lgkmcnt(8)
  v_readfirstlane_b32 s48, v37
  ds_read_b64_tr_b16 v[64:65], v18 offset:6144
  ds_read_b64_tr_b16 v[66:67], v18 offset:7168
  ds_read_b64_tr_b16 v[68:69], v19 offset:6144
  ds_read_b64_tr_b16 v[70:71], v19 offset:7168
  s_waitcnt vmcnt(9) lgkmcnt(8)
  v_mfma_f32_32x32x16_bf16 v[104:119], v[52:55], v[180:183], v[104:119]
  buffer_load_dwordx4 v[220:223], v5, s[24:27], s91 offen offset:3072 sc1
  v_mfma_f32_32x32x16_bf16 v[88:103], v[48:51], v[180:183], v[88:103]
  s_getpc_b64 s[94:95]
  s_cmp_ge_u32 s48, 51
  s_cbranch_scc0 REFRESH_4
  s_cmp_eq_u32 s101, 0
  s_cselect_b32 s49, 10, 24
  s_lshl_b32 s49, s49, 12
  v_add_u32 v18, s49, v16
  v_add_u32 v19, s49, v17
  ds_read_b64_tr_b16 v[40:41], v18 offset:0
  ds_read_b64_tr_b16 v[42:43], v18 offset:1024
  ds_read_b64_tr_b16 v[44:45], v19 offset:0
  ds_read_b64_tr_b16 v[46:47], v19 offset:1024
  ds_read_b32 v37, v2 offset:16
  s_waitcnt vmcnt(9) lgkmcnt(9)
  v_mfma_f32_32x32x16_bf16 v[104:119], v[60:63], v[184:187], v[104:119]
  s_lshl_b32 s91, s7, 13
  s_add_u32 s91, s91, s9
  s_add_u32 s7, s7, s8
  s_cmp_ge_u32 s7, 7
  s_cselect_b32 s50, 7, 0
  s_sub_u32 s7, s7, s50
  buffer_load_dwordx4 v[224:227], v5, s[24:27], s91 offen offset:0 sc1
  v_mfma_f32_32x32x16_bf16 v[88:103], v[56:59], v[184:187], v[88:103]
  ds_read_b64_tr_b16 v[48:49], v18 offset:2048
  ds_read_b64_tr_b16 v[50:51], v18 offset:3072
  ds_read_b64_tr_b16 v[52:53], v19 offset:2048
  ds_read_b64_tr_b16 v[54:55], v19 offset:3072
  s_waitcnt vmcnt(9) lgkmcnt(9)
  v_mfma_f32_32x32x16_bf16 v[104:119], v[68:71], v[188:191], v[104:119]
  buffer_load_dwordx4 v[228:231], v5, s[24:27], s91 offen offset:1024 sc1
  v_mfma_f32_32x32x16_bf16 v[88:103], v[64:67], v[188:191], v[88:103]
  ds_read_b64_tr_b16 v[56:57], v18 offset:4096
  ds_read_b64_tr_b16 v[58:59], v18 offset:5120
  ds_read_b64_tr_b16 v[60:61], v19 offset:4096
  ds_read_b64_tr_b16 v[62:63], v19 offset:5120
  s_waitcnt vmcnt(9) lgkmcnt(9)
  v_mfma_f32_32x32x16_bf16 v[104:119], v[44:47], v[192:195], v[104:119]
  buffer_load_dwordx4 v[232:235], v5, s[24:27], s91 offen offset:2048 sc1
  v_mfma_f32_32x32x16_bf16 v[88:103], v[40:43], v[192:195], v[88:103]
  s_waitcnt lgkmcnt(8)
  v_readfirstlane_b32 s48, v37
  ds_read_b64_tr_b16 v[64:65], v18 offset:6144
  ds_read_b64_tr_b16 v[66:67], v18 offset:7168
  ds_read_b64_tr_b16 v[68:69], v19 offset:6144
  ds_read_b64_tr_b16 v[70:71], v19 offset:7168
  s_waitcnt vmcnt(9) lgkmcnt(8)
  v_mfma_f32_32x32x16_bf16 v[104:119], v[52:55], v[196:199], v[104:119]
  buffer_load_dwordx4 v[236:239], v5, s[24:27], s91 offen offset:3072 sc1
  s_add_u32 s91, s91, 4096
  v_mfma_f32_32x32x16_bf16 v[88:103], v[48:51], v[196:199], v[88:103]
  s_getpc_b64 s[94:95]
  s_cmp_ge_u32 s48, 53
  s_cbranch_scc0 REFRESH_4
  s_cmp_eq_u32 s101, 0
  s_cselect_b32 s49, 26, 28
  s_lshl_b32 s49, s49, 12
  v_add_u32 v18, s49, v16
  v_add_u32 v19, s49, v17
  ds_read_b64_tr_b16 v[40:41], v18 offset:0
  ds_read_b64_tr_b16 v[42:43], v18 offset:1024
  ds_read_b64_tr_b16 v[44:45], v19 offset:0
  ds_read_b64_tr_b16 v[46:47], v19 offset:1024
  ds_read_b32 v37, v2 offset:16
  s_waitcnt vmcnt(9) lgkmcnt(9)
  v_mfma_f32_32x32x16_bf16 v[104:119], v[60:63], v[200:203], v[104:119]
  buffer_load_dwordx4 v[240:243], v5, s[24:27], s91 offen offset:0 sc1
  v_mfma_f32_32x32x16_bf16 v[88:103], v[56:59], v[200:203], v[88:103]
  ds_read_b64_tr_b16 v[48:49], v18 offset:2048
  ds_read_b64_tr_b16 v[50:51], v18 offset:3072
  ds_read_b64_tr_b16 v[52:53], v19 offset:2048
  ds_read_b64_tr_b16 v[54:55], v19 offset:3072
  s_waitcnt vmcnt(9) lgkmcnt(9)
  v_mfma_f32_32x32x16_bf16 v[104:119], v[68:71], v[204:207], v[104:119]
  buffer_load_dwordx4 v[244:247], v5, s[24:27], s91 offen offset:1024 sc1
  v_mfma_f32_32x32x16_bf16 v[88:103], v[64:67], v[204:207], v[88:103]
  ds_read_b64_tr_b16 v[56:57], v18 offset:4096
  ds_read_b64_tr_b16 v[58:59], v18 offset:5120
  ds_read_b64_tr_b16 v[60:61], v19 offset:4096
  ds_read_b64_tr_b16 v[62:63], v19 offset:5120
  s_waitcnt vmcnt(9) lgkmcnt(9)
  v_mfma_f32_32x32x16_bf16 v[104:119], v[44:47], v[208:211], v[104:119]
  buffer_load_dwordx4 v[248:251], v5, s[24:27], s91 offen offset:2048 sc1
  v_mfma_f32_32x32x16_bf16 v[88:103], v[40:43], v[208:211], v[88:103]
  s_waitcnt lgkmcnt(8)
  v_readfirstlane_b32 s48, v37
  ds_read_b64_tr_b16 v[64:65], v18 offset:6144
  ds_read_b64_tr_b16 v[66:67], v18 offset:7168
  ds_read_b64_tr_b16 v[68:69], v19 offset:6144
  ds_read_b64_tr_b16 v[70:71], v19 offset:7168
  s_waitcnt vmcnt(9) lgkmcnt(8)
  v_mfma_f32_32x32x16_bf16 v[104:119], v[52:55], v[212:215], v[104:119]
  buffer_load_dwordx4 v[252:255], v5, s[24:27], s91 offen offset:3072 sc1
  v_mfma_f32_32x32x16_bf16 v[88:103], v[48:51], v[212:215], v[88:103]
  s_getpc_b64 s[94:95]
  s_cmp_ge_u32 s48, 55
  s_cbranch_scc0 REFRESH_4
  s_cmp_eq_u32 s101, 0
  s_cselect_b32 s49, 30, 32
  s_lshl_b32 s49, s49, 12
  v_add_u32 v18, s49, v16
  v_add_u32 v19, s49, v17
  ds_read_b64_tr_b16 v[40:41], v18 offset:0
  ds_read_b64_tr_b16 v[42:43], v18 offset:1024
  ds_read_b64_tr_b16 v[44:45], v19 offset:0
  ds_read_b64_tr_b16 v[46:47], v19 offset:1024
  ds_read_b32 v37, v2 offset:16
  s_waitcnt vmcnt(9) lgkmcnt(9)
  v_mfma_f32_32x32x16_bf16 v[104:119], v[60:63], v[216:219], v[104:119]
  v_mfma_f32_32x32x16_bf16 v[88:103], v[56:59], v[216:219], v[88:103]
  ds_read_b64_tr_b16 v[48:49], v18 offset:2048
  ds_read_b64_tr_b16 v[50:51], v18 offset:3072
  ds_read_b64_tr_b16 v[52:53], v19 offset:2048
  ds_read_b64_tr_b16 v[54:55], v19 offset:3072
  s_waitcnt vmcnt(8) lgkmcnt(9)
  v_mfma_f32_32x32x16_bf16 v[104:119], v[68:71], v[220:223], v[104:119]
  v_mfma_f32_32x32x16_bf16 v[88:103], v[64:67], v[220:223], v[88:103]
  ds_read_b64_tr_b16 v[56:57], v18 offset:4096
  ds_read_b64_tr_b16 v[58:59], v18 offset:5120
  ds_read_b64_tr_b16 v[60:61], v19 offset:4096
  ds_read_b64_tr_b16 v[62:63], v19 offset:5120
  s_waitcnt vmcnt(7) lgkmcnt(9)
  v_mfma_f32_32x32x16_bf16 v[104:119], v[44:47], v[224:227], v[104:119]
  v_mfma_f32_32x32x16_bf16 v[88:103], v[40:43], v[224:227], v[88:103]
  s_waitcnt lgkmcnt(8)
  v_readfirstlane_b32 s48, v37
  ds_read_b64_tr_b16 v[64:65], v18 offset:6144
  ds_read_b64_tr_b16 v[66:67], v18 offset:7168
  ds_read_b64_tr_b16 v[68:69], v19 offset:6144
  ds_read_b64_tr_b16 v[70:71], v19 offset:7168
  s_waitcnt vmcnt(6) lgkmcnt(8)
  v_mfma_f32_32x32x16_bf16 v[104:119], v[52:55], v[228:231], v[104:119]
  v_mfma_f32_32x32x16_bf16 v[88:103], v[48:51], v[228:231], v[88:103]
  s_getpc_b64 s[94:95]
  s_cmp_ge_u32 s48, 57
  s_cbranch_scc0 REFRESH_4
  s_cmp_eq_u32 s101, 0
  s_cselect_b32 s49, 34, 36
  s_lshl_b32 s49, s49, 12
  v_add_u32 v18, s49, v16
  v_add_u32 v19, s49, v17
  ds_read_b64_tr_b16 v[40:41], v18 offset:0
  ds_read_b64_tr_b16 v[42:43], v18 offset:1024
  ds_read_b64_tr_b16 v[44:45], v19 offset:0
  ds_read_b64_tr_b16 v[46:47], v19 offset:1024
  s_waitcnt vmcnt(5) lgkmcnt(8)
  v_mfma_f32_32x32x16_bf16 v[104:119], v[60:63], v[232:235], v[104:119]
  v_mfma_f32_32x32x16_bf16 v[88:103], v[56:59], v[232:235], v[88:103]
  ds_read_b64_tr_b16 v[48:49], v18 offset:2048
  ds_read_b64_tr_b16 v[50:51], v18 offset:3072
  ds_read_b64_tr_b16 v[52:53], v19 offset:2048
  ds_read_b64_tr_b16 v[54:55], v19 offset:3072
  s_waitcnt vmcnt(4) lgkmcnt(8)
  v_mfma_f32_32x32x16_bf16 v[104:119], v[68:71], v[236:239], v[104:119]
  v_mfma_f32_32x32x16_bf16 v[88:103], v[64:67], v[236:239], v[88:103]
  ds_read_b64_tr_b16 v[56:57], v18 offset:4096
  ds_read_b64_tr_b16 v[58:59], v18 offset:5120
  ds_read_b64_tr_b16 v[60:61], v19 offset:4096
  ds_read_b64_tr_b16 v[62:63], v19 offset:5120
  s_waitcnt vmcnt(3) lgkmcnt(8)
  v_mfma_f32_32x32x16_bf16 v[104:119], v[44:47], v[240:243], v[104:119]
  v_mfma_f32_32x32x16_bf16 v[88:103], v[40:43], v[240:243], v[88:103]
  ds_read_b64_tr_b16 v[64:65], v18 offset:6144
  ds_read_b64_tr_b16 v[66:67], v18 offset:7168
  ds_read_b64_tr_b16 v[68:69], v19 offset:6144
  ds_read_b64_tr_b16 v[70:71], v19 offset:7168
  s_waitcnt vmcnt(2) lgkmcnt(8)
  v_mfma_f32_32x32x16_bf16 v[104:119], v[52:55], v[244:247], v[104:119]
  v_mfma_f32_32x32x16_bf16 v[88:103], v[48:51], v[244:247], v[88:103]
  s_waitcnt vmcnt(1) lgkmcnt(4)
  v_mfma_f32_32x32x16_bf16 v[104:119], v[60:63], v[248:251], v[104:119]
  v_mfma_f32_32x32x16_bf16 v[88:103], v[56:59], v[248:251], v[88:103]
  s_waitcnt vmcnt(0) lgkmcnt(0)
  v_mfma_f32_32x32x16_bf16 v[104:119], v[68:71], v[252:255], v[104:119]
  v_mfma_f32_32x32x16_bf16 v[88:103], v[64:67], v[252:255], v[88:103]
  v_readfirstlane_b32 s52, v15
  v_readfirstlane_b32 s50, v39
  v_and_b32 v8, 31, v1
  v_mul_u32_u24 v8, 80, v8
  v_lshrrev_b32 v4, 5, v1
  v_lshl_add_u32 v8, v4, 3, v8
  v_add_u32 v8, s52, v8
  v_lshrrev_b32 v4, 2, v1
  v_and_b32 v11, 3, v1
  v_lshlrev_b32 v11, 4, v11
  v_mul_u32_u24 v9, 80, v4
  v_add3_u32 v9, v9, v11, s52
  v_mul_u32_u24 v10, 896, v4
  v_add_u32 v10, v10, v11
  s_add_u32 s52, s50, 14336
  ds_write_b128 v14, v[104:107] offset:0
  ds_write_b128 v14, v[108:111] offset:1024
  ds_write_b128 v14, v[112:115] offset:2048
  ds_write_b128 v14, v[116:119] offset:3072
  v_mov_b32 v3, 31
  ds_write_b32 v7, v3
W_213:
  ds_read_b32 v32, v20
  ds_read_b128 v[72:75], v15 offset:0
  ds_read_b128 v[76:79], v15 offset:1024
  ds_read_b128 v[80:83], v15 offset:2048
  ds_read_b128 v[84:87], v15 offset:3072
  s_waitcnt lgkmcnt(4)
  v_readfirstlane_b32 s49, v32
  s_sub_u32 s90, s90, 1
  s_cbranch_scc1 WD_214
  s_cmp_ge_u32 s49, 31
  s_cbranch_scc0 W_213
WD_214:
  s_waitcnt lgkmcnt(3)
  v_pk_add_f32 v[88:89], v[88:89], v[72:73]
  v_pk_add_f32 v[90:91], v[90:91], v[74:75]
  s_waitcnt lgkmcnt(2)
  v_pk_add_f32 v[92:93], v[92:93], v[76:77]
  v_pk_add_f32 v[94:95], v[94:95], v[78:79]
  s_waitcnt lgkmcnt(1)
  v_pk_add_f32 v[96:97], v[96:97], v[80:81]
  v_pk_add_f32 v[98:99], v[98:99], v[82:83]
  s_waitcnt lgkmcnt(0)
  v_pk_add_f32 v[100:101], v[100:101], v[84:85]
  v_pk_add_f32 v[102:103], v[102:103], v[86:87]
  v_cvt_pk_bf16_f32 v120, v88, v89
  v_cvt_pk_bf16_f32 v121, v90, v91
  v_cvt_pk_bf16_f32 v122, v92, v93
  v_cvt_pk_bf16_f32 v123, v94, v95
  v_cvt_pk_bf16_f32 v124, v96, v97
  v_cvt_pk_bf16_f32 v125, v98, v99
  v_cvt_pk_bf16_f32 v126, v100, v101
  v_cvt_pk_bf16_f32 v127, v102, v103
  ds_write_b64 v8, v[120:121] offset:0
  ds_write_b64 v8, v[122:123] offset:16
  ds_write_b64 v8, v[124:125] offset:32
  ds_write_b64 v8, v[126:127] offset:48
  ds_read_b128 v[120:123], v9 offset:0
  ds_read_b128 v[124:127], v9 offset:1280
  s_waitcnt lgkmcnt(1)
  buffer_store_dwordx4 v[120:123], v10, s[40:43], s50 offen nt
  s_waitcnt lgkmcnt(0)
  buffer_store_dwordx4 v[124:127], v10, s[40:43], s52 offen nt
  s_or_b32 s49, s55, s46
  s_or_b32 s49, s49, s3
  s_cmp_lg_u32 s49, 0
  s_cbranch_scc1 FIN_173
  s_mov_b32 s49, 16818176
  s_mov_b64 exec, 1
  buffer_store_dword v6, v5, s[24:27], s49 offen
  s_mov_b64 exec, -1
FIN_173:
END_1:
  s_endpgm
H0_3:
  s_nop 4
  s_setprio 2
  v_mov_b32 v36, v40
  v_mov_b32 v37, v41
  v_mov_b32 v38, v42
  v_mov_b32 v39, v43
  s_add_u32 s82, s80, 16818176
  s_addc_u32 s83, s81, 0
  s_load_dword s53, s[82:83], 0
  s_mov_b32 s20, s68
  s_and_b32 s21, s69, 0xffff
  s_mov_b32 s22, 0x6200
  s_mov_b32 s23, 0x20000
  s_mul_i32 s96, s55, 37
  s_lshr_b32 s96, s96, 8
  s_mul_i32 s97, s96, 7
  s_sub_u32 s97, s55, s97
  s_lshr_b32 s98, s96, 1
  s_mul_i32 s99, s98, 14
  s_sub_u32 s99, s55, s99
  s_lshl2_add_u32 s96, s3, s96
  s_lshl1_add_u32 s98, s3, s98
  v_lshlrev_b32 v5, 4, v1
  s_mov_b32 s54, 0
  s_mov_b32 s51, 0x3f803f80
  s_mov_b32 s28, s70
  s_and_b32 s29, s71, 0xffff
  s_mov_b32 s30, 0x62000
  s_mov_b32 s31, 0x20000
  s_mov_b32 s32, s74
  s_and_b32 s33, s75, 0xffff
  s_mov_b32 s34, 0x188000
  s_mov_b32 s35, 0x20000
  s_mov_b32 s36, s76
  s_and_b32 s37, s77, 0xffff
  s_mov_b32 s38, 0x188000
  s_mov_b32 s39, 0x20000
  s_mov_b32 s40, s78
  s_and_b32 s41, s79, 0xffff
  s_mov_b32 s42, 0x1c0000
  s_mov_b32 s43, 0x20000
  s_mov_b32 s24, s80
  s_and_b32 s25, s81, 0xffff
  s_mov_b32 s26, 0x1200000
  s_mov_b32 s27, 0x20000
  v_lshrrev_b32 v12, 3, v1
  v_mul_u32_u24 v12, 896, v12
  v_and_b32 v4, 7, v1
  v_lshrrev_b32 v3, 2, v1
  v_and_b32 v3, 4, v3
  v_xor_b32 v4, v4, v3
  v_lshl_add_u32 v12, v4, 4, v12
  v_add_u32 v13, 6144, v12
  v_add_u32 v14, 12288, v12
  v_add_u32 v15, 18432, v12
  v_lshrrev_b32 v20, 4, v1
  v_mul_u32_u24 v20, 3584, v20
  v_and_b32 v4, 15, v1
  v_lshrrev_b32 v3, 2, v1
  v_and_b32 v3, 12, v3
  v_xor_b32 v4, v4, v3
  v_lshl_add_u32 v20, v4, 4, v20
  v_add_u32 v21, 13312, v20
  v_add_u32 v22, 26624, v20
  v_add_u32 v23, 39936, v20
  s_lshl_b32 s88, s97, 7
  s_and_b32 s100, s98, 1
  s_mul_i32 s100, s100, 3
  s_add_u32 s100, s100, s3
  s_lshr_b32 s49, s99, 1
  s_add_u32 s100, s100, s49
  s_mul_i32 s49, s100, 37
  s_lshr_b32 s49, s49, 8
  s_mul_i32 s49, s49, 7
  s_sub_u32 s100, s100, s49
  s_and_b32 s101, s96, 3
  s_lshl_b32 s101, s101, 1
  s_add_u32 s101, s101, s3
  s_cmp_ge_u32 s101, 7
  s_cselect_b32 s49, 7, 0
  s_sub_u32 s101, s101, s49
  s_and_b32 s8, s96, 1
  s_lshr_b32 s49, s96, 1
  s_xor_b32 s49, s49, s3
  s_sub_u32 s50, 6, s8
  s_bitcmp1_b32 s49, 0
  s_cselect_b32 s8, s50, s8
  s_cselect_b32 s10, 5, 2
  s_and_b32 s9, s96, 1
  s_xor_b32 s9, s9, 1
  s_lshr_b32 s49, s96, 1
  s_xor_b32 s49, s49, s3
  s_sub_u32 s50, 6, s9
  s_bitcmp1_b32 s49, 0
  s_cselect_b32 s9, s50, s9
  s_cselect_b32 s10, 5, 2
  s_setprio 0
W_13:
  ds_read_b128 v[32:35], v2 offset:0
  s_waitcnt lgkmcnt(0)
  v_min3_u32 v32, v32, v33, v34
  v_min_u32 v32, v32, v35
  s_nop 0
  v_readfirstlane_b32 s49, v32
  s_sub_u32 s90, s90, 1
  s_cbranch_scc1 WD_14
  s_cmp_ge_u32 s49, 1
  s_cbranch_scc0 W_13
WD_14:
  s_setprio 2
  s_cmp_ge_u32 s0, 5
  s_cbranch_scc1 WD_15
  s_setprio 0
W_16:
  ds_read_b32 v32, v2 offset:28
  s_waitcnt lgkmcnt(0)
  v_readfirstlane_b32 s0, v32
  s_sub_u32 s90, s90, 1
  s_cbranch_scc1 WD_15
  s_cmp_ge_u32 s0, 5
  s_cbranch_scc0 W_16
  s_setprio 2
WD_15:
  s_add_u32 s49, s47, 0
  s_cmp_ge_u32 s49, 7
  s_cselect_b32 s50, 7, 0
  s_sub_u32 s49, s49, s50
  s_mul_i32 s49, s49, 172032
  s_add_u32 s49, s49, 1792
  s_mov_b32 m0, 0
  s_nop 0
  buffer_load_dwordx4 v36, s[16:19], s49 offen offset:0 lds
  buffer_load_dwordx4 v37, s[16:19], s49 offen offset:1024 lds
  buffer_load_dwordx4 v38, s[16:19], s49 offen offset:2048 lds
  buffer_load_dwordx4 v39, s[16:19], s49 offen offset:3072 lds
  s_add_u32 s49, s47, 1
  s_cmp_ge_u32 s49, 7
  s_cselect_b32 s50, 7, 0
  s_sub_u32 s49, s49, s50
  s_mul_i32 s49, s49, 172032
  s_add_u32 s49, s49, 1792
  s_mov_b32 m0, 4096
  s_nop 0
  buffer_load_dwordx4 v36, s[16:19], s49 offen offset:0 lds
  buffer_load_dwordx4 v37, s[16:19], s49 offen offset:1024 lds
  buffer_load_dwordx4 v38, s[16:19], s49 offen offset:2048 lds
  buffer_load_dwordx4 v39, s[16:19], s49 offen offset:3072 lds
  s_add_u32 s49, s47, 2
  s_cmp_ge_u32 s49, 7
  s_cselect_b32 s50, 7, 0
  s_sub_u32 s49, s49, s50
  s_mul_i32 s49, s49, 172032
  s_add_u32 s49, s49, 1792
  s_mov_b32 m0, 8192
  s_nop 0
  buffer_load_dwordx4 v36, s[16:19], s49 offen offset:0 lds
  buffer_load_dwordx4 v37, s[16:19], s49 offen offset:1024 lds
  buffer_load_dwordx4 v38, s[16:19], s49 offen offset:2048 lds
  buffer_load_dwordx4 v39, s[16:19], s49 offen offset:3072 lds
  s_add_u32 s49, s47, 3
  s_cmp_ge_u32 s49, 7
  s_cselect_b32 s50, 7, 0
  s_sub_u32 s49, s49, s50
  s_mul_i32 s49, s49, 172032
  s_add_u32 s49, s49, 1792
  s_mov_b32 m0, 12288
  s_nop 0
  buffer_load_dwordx4 v36, s[16:19], s49 offen offset:0 lds
  buffer_load_dwordx4 v37, s[16:19], s49 offen offset:1024 lds
  buffer_load_dwordx4 v38, s[16:19], s49 offen offset:2048 lds
  buffer_load_dwordx4 v39, s[16:19], s49 offen offset:3072 lds
  s_add_u32 s49, s47, 4
  s_cmp_ge_u32 s49, 7
  s_cselect_b32 s50, 7, 0
  s_sub_u32 s49, s49, s50
  s_mul_i32 s49, s49, 172032
  s_add_u32 s49, s49, 1792
  s_mov_b32 m0, 16384
  s_nop 0
  buffer_load_dwordx4 v36, s[16:19], s49 offen offset:0 lds
  buffer_load_dwordx4 v37, s[16:19], s49 offen offset:1024 lds
  buffer_load_dwordx4 v38, s[16:19], s49 offen offset:2048 lds
  buffer_load_dwordx4 v39, s[16:19], s49 offen offset:3072 lds
  s_add_u32 s49, s47, 5
  s_cmp_ge_u32 s49, 7
  s_cselect_b32 s50, 7, 0
  s_sub_u32 s49, s49, s50
  s_mul_i32 s49, s49, 172032
  s_add_u32 s49, s49, 1792
  s_mov_b32 m0, 20480
  s_nop 0
  buffer_load_dwordx4 v36, s[16:19], s49 offen offset:0 lds
  buffer_load_dwordx4 v37, s[16:19], s49 offen offset:1024 lds
  buffer_load_dwordx4 v38, s[16:19], s49 offen offset:2048 lds
  buffer_load_dwordx4 v39, s[16:19], s49 offen offset:3072 lds
  s_add_u32 s49, s47, 6
  s_cmp_ge_u32 s49, 7
  s_cselect_b32 s50, 7, 0
  s_sub_u32 s49, s49, s50
  s_mul_i32 s49, s49, 172032
  s_add_u32 s49, s49, 1792
  s_mov_b32 m0, 24576
  s_waitcnt vmcnt(20)
  v_mov_b32 v3, 8
  ds_write_b32 v7, v3
  buffer_load_dwordx4 v36, s[16:19], s49 offen offset:0 lds
  buffer_load_dwordx4 v37, s[16:19], s49 offen offset:1024 lds
  buffer_load_dwordx4 v38, s[16:19], s49 offen offset:2048 lds
  buffer_load_dwordx4 v39, s[16:19], s49 offen offset:3072 lds
  s_cmp_lt_u32 s55, 28
  s_cbranch_scc1 ACT_18
  s_setprio 0
W_19:
  ds_read_b128 v[32:35], v2 offset:0
  s_waitcnt lgkmcnt(0)
  v_min3_u32 v32, v32, v33, v34
  v_min_u32 v32, v32, v35
  s_nop 0
  v_readfirstlane_b32 s49, v32
  s_sub_u32 s90, s90, 1
  s_cbranch_scc1 WD_20
  s_cmp_ge_u32 s49, 2
  s_cbranch_scc0 W_19
WD_20:
  s_setprio 2
  s_add_u32 s49, s47, 0
  s_cmp_ge_u32 s49, 7
  s_cselect_b32 s50, 7, 0
  s_sub_u32 s49, s49, s50
  s_mul_i32 s49, s49, 172032
  s_mov_b32 m0, 32768
  s_waitcnt vmcnt(20)
  v_mov_b32 v3, 9
  ds_write_b32 v7, v3
  buffer_load_dwordx4 v36, s[16:19], s49 offen offset:0 lds
  buffer_load_dwordx4 v37, s[16:19], s49 offen offset:1024 lds
  buffer_load_dwordx4 v38, s[16:19], s49 offen offset:2048 lds
  buffer_load_dwordx4 v39, s[16:19], s49 offen offset:3072 lds
  s_add_u32 s49, s47, 1
  s_cmp_ge_u32 s49, 7
  s_cselect_b32 s50, 7, 0
  s_sub_u32 s49, s49, s50
  s_mul_i32 s49, s49, 172032
  s_mov_b32 m0, 36864
  s_waitcnt vmcnt(20)
  v_mov_b32 v3, 10
  ds_write_b32 v7, v3
  buffer_load_dwordx4 v36, s[16:19], s49 offen offset:0 lds
  buffer_load_dwordx4 v37, s[16:19], s49 offen offset:1024 lds
  buffer_load_dwordx4 v38, s[16:19], s49 offen offset:2048 lds
  buffer_load_dwordx4 v39, s[16:19], s49 offen offset:3072 lds
  s_add_u32 s49, s47, 2
  s_cmp_ge_u32 s49, 7
  s_cselect_b32 s50, 7, 0
  s_sub_u32 s49, s49, s50
  s_mul_i32 s49, s49, 172032
  s_mov_b32 m0, 40960
  s_waitcnt vmcnt(20)
  v_mov_b32 v3, 11
  ds_write_b32 v7, v3
  buffer_load_dwordx4 v36, s[16:19], s49 offen offset:0 lds
  buffer_load_dwordx4 v37, s[16:19], s49 offen offset:1024 lds
  buffer_load_dwordx4 v38, s[16:19], s49 offen offset:2048 lds
  buffer_load_dwordx4 v39, s[16:19], s49 offen offset:3072 lds
  s_add_u32 s49, s47, 3
  s_cmp_ge_u32 s49, 7
  s_cselect_b32 s50, 7, 0
  s_sub_u32 s49, s49, s50
  s_mul_i32 s49, s49, 172032
  s_mov_b32 m0, 45056
  s_waitcnt vmcnt(20)
  v_mov_b32 v3, 12
  ds_write_b32 v7, v3
  buffer_load_dwordx4 v36, s[16:19], s49 offen offset:0 lds
  buffer_load_dwordx4 v37, s[16:19], s49 offen offset:1024 lds
  buffer_load_dwordx4 v38, s[16:19], s49 offen offset:2048 lds
  buffer_load_dwordx4 v39, s[16:19], s49 offen offset:3072 lds
  s_add_u32 s49, s47, 4
  s_cmp_ge_u32 s49, 7
  s_cselect_b32 s50, 7, 0
  s_sub_u32 s49, s49, s50
  s_mul_i32 s49, s49, 172032
  s_mov_b32 m0, 49152
  s_waitcnt vmcnt(20)
  v_mov_b32 v3, 13
  ds_write_b32 v7, v3
  buffer_load_dwordx4 v36, s[16:19], s49 offen offset:0 lds
  buffer_load_dwordx4 v37, s[16:19], s49 offen offset:1024 lds
  buffer_load_dwordx4 v38, s[16:19], s49 offen offset:2048 lds
  buffer_load_dwordx4 v39, s[16:19], s49 offen offset:3072 lds
  s_add_u32 s49, s47, 5
  s_cmp_ge_u32 s49, 7
  s_cselect_b32 s50, 7, 0
  s_sub_u32 s49, s49, s50
  s_mul_i32 s49, s49, 172032
  s_mov_b32 m0, 53248
  s_waitcnt vmcnt(20)
  v_mov_b32 v3, 14
  ds_write_b32 v7, v3
  buffer_load_dwordx4 v36, s[16:19], s49 offen offset:0 lds
  buffer_load_dwordx4 v37, s[16:19], s49 offen offset:1024 lds
  buffer_load_dwordx4 v38, s[16:19], s49 offen offset:2048 lds
  buffer_load_dwordx4 v39, s[16:19], s49 offen offset:3072 lds
  s_add_u32 s49, s47, 6
  s_cmp_ge_u32 s49, 7
  s_cselect_b32 s50, 7, 0
  s_sub_u32 s49, s49, s50
  s_mul_i32 s49, s49, 172032
  s_mov_b32 m0, 57344
  s_waitcnt vmcnt(20)
  v_mov_b32 v3, 15
  ds_write_b32 v7, v3
  buffer_load_dwordx4 v36, s[16:19], s49 offen offset:0 lds
  buffer_load_dwordx4 v37, s[16:19], s49 offen offset:1024 lds
  buffer_load_dwordx4 v38, s[16:19], s49 offen offset:2048 lds
  buffer_load_dwordx4 v39, s[16:19], s49 offen offset:3072 lds
  s_waitcnt vmcnt(20)
  v_mov_b32 v3, 16
  ds_write_b32 v7, v3
  s_waitcnt vmcnt(16)
  v_mov_b32 v3, 17
  ds_write_b32 v7, v3
  s_waitcnt vmcnt(12)
  v_mov_b32 v3, 18
  ds_write_b32 v7, v3
  s_waitcnt vmcnt(8)
  v_mov_b32 v3, 19
  ds_write_b32 v7, v3
  s_waitcnt vmcnt(4)
  v_mov_b32 v3, 20
  ds_write_b32 v7, v3
  s_waitcnt vmcnt(0)
  v_mov_b32 v3, 21
  ds_write_b32 v7, v3
  v_lshlrev_b32 v36, 7, v1
  s_setprio 0
W_21:
  ds_read_b128 v[32:35], v2 offset:0
  s_waitcnt lgkmcnt(0)
  v_min3_u32 v32, v32, v33, v34
  v_min_u32 v32, v32, v35
  s_nop 0
  v_readfirstlane_b32 s49, v32
  s_sub_u32 s90, s90, 1
  s_cbranch_scc1 WD_22
  s_cmp_ge_u32 s49, 9
  s_cbranch_scc0 ZZ_23
WD_22:
  s_setprio 2
  s_mul_i32 s49, s3, 262144
  s_sub_u32 s50, s55, 28
  s_mul_i32 s50, s50, 65536
  s_add_u32 s49, s49, s50
  s_add_u32 s49, s49, 4194304
  s_mov_b32 s52, 8
T_24:
  buffer_load_dword v37, v36, s[24:27], s49 offen sc1
  s_add_u32 s49, s49, 8192
  s_waitcnt vmcnt(6)
  s_sub_u32 s52, s52, 1
  s_cmp_lg_u32 s52, 0
  s_cbranch_scc1 T_24
  s_mul_i32 s49, s3, 229376
  s_sub_u32 s50, s55, 28
  s_mul_i32 s50, s50, 57344
  s_add_u32 s49, s49, s50
  s_add_u32 s49, s49, 0
  s_mov_b32 s52, 7
T_25:
  buffer_load_dword v37, v36, s[36:39], s49 offen sc1
  s_add_u32 s49, s49, 8192
  s_waitcnt vmcnt(6)
  s_sub_u32 s52, s52, 1
  s_cmp_lg_u32 s52, 0
  s_cbranch_scc1 T_25
  s_branch LEND_17
ACT_18:
  s_add_u32 s49, s100, 4
  s_cmp_ge_u32 s49, 7
  s_cselect_b32 s50, 7, 0
  s_sub_u32 s49, s49, s50
  s_mul_i32 s49, s49, 229376
  s_lshl_b32 s50, s99, 8
  s_add_u32 s49, s49, s50
  s_waitcnt vmcnt(20)
  v_mov_b32 v3, 9
  ds_write_b32 v7, v3
  buffer_load_dwordx4 v[64:67], v20, s[32:35], s49 offen offset:0
  buffer_load_dwordx4 v[68:71], v21, s[32:35], s49 offen offset:1024
  buffer_load_dwordx4 v[72:75], v22, s[32:35], s49 offen offset:2048
  buffer_load_dwordx4 v[76:79], v23, s[32:35], s49 offen offset:3072
  s_add_u32 s49, s49, 57344
  s_waitcnt vmcnt(20)
  v_mov_b32 v3, 10
  ds_write_b32 v7, v3
  buffer_load_dwordx4 v[80:83], v20, s[32:35], s49 offen offset:0
  buffer_load_dwordx4 v[84:87], v21, s[32:35], s49 offen offset:1024
  buffer_load_dwordx4 v[88:91], v22, s[32:35], s49 offen offset:2048
  buffer_load_dwordx4 v[92:95], v23, s[32:35], s49 offen offset:3072
  s_add_u32 s49, s49, 57344
  s_waitcnt vmcnt(20)
  v_mov_b32 v3, 11
  ds_write_b32 v7, v3
  buffer_load_dwordx4 v[96:99], v20, s[32:35], s49 offen offset:0
  buffer_load_dwordx4 v[100:103], v21, s[32:35], s49 offen offset:1024
  buffer_load_dwordx4 v[104:107], v22, s[32:35], s49 offen offset:2048
  buffer_load_dwordx4 v[108:111], v23, s[32:35], s49 offen offset:3072
  s_add_u32 s49, s49, 57344
  s_waitcnt vmcnt(20)
  v_mov_b32 v3, 12
  ds_write_b32 v7, v3
  buffer_load_dwordx4 v[112:115], v20, s[32:35], s49 offen offset:0
  buffer_load_dwordx4 v[116:119], v21, s[32:35], s49 offen offset:1024
  buffer_load_dwordx4 v[120:123], v22, s[32:35], s49 offen offset:2048
  buffer_load_dwordx4 v[124:127], v23, s[32:35], s49 offen offset:3072
  s_add_u32 s49, s49, 57344
  s_add_u32 s49, s100, 5
  s_cmp_ge_u32 s49, 7
  s_cselect_b32 s50, 7, 0
  s_sub_u32 s49, s49, s50
  s_mul_i32 s49, s49, 229376
  s_lshl_b32 s50, s99, 8
  s_add_u32 s49, s49, s50
  s_waitcnt vmcnt(20)
  v_mov_b32 v3, 13
  ds_write_b32 v7, v3
  buffer_load_dwordx4 v[128:131], v20, s[32:35], s49 offen offset:0
  buffer_load_dwordx4 v[132:135], v21, s[32:35], s49 offen offset:1024
  buffer_load_dwordx4 v[136:139], v22, s[32:35], s49 offen offset:2048
  buffer_load_dwordx4 v[140:143], v23, s[32:35], s49 offen offset:3072
  s_add_u32 s49, s49, 57344
  s_waitcnt vmcnt(20)
  v_mov_b32 v3, 14
  ds_write_b32 v7, v3
  buffer_load_dwordx4 v[144:147], v20, s[32:35], s49 offen offset:0
  buffer_load_dwordx4 v[148:151], v21, s[32:35], s49 offen offset:1024
  buffer_load_dwordx4 v[152:155], v22, s[32:35], s49 offen offset:2048
  buffer_load_dwordx4 v[156:159], v23, s[32:35], s49 offen offset:3072
  s_add_u32 s49, s49, 57344
  s_waitcnt vmcnt(20)
  buffer_load_dwordx4 v[160:163], v20, s[32:35], s49 offen offset:0
  buffer_load_dwordx4 v[164:167], v21, s[32:35], s49 offen offset:1024
  buffer_load_dwordx4 v[168:171], v22, s[32:35], s49 offen offset:2048
  buffer_load_dwordx4 v[172:175], v23, s[32:35], s49 offen offset:3072
  s_add_u32 s49, s49, 57344
  s_waitcnt vmcnt(20)
  buffer_load_dwordx4 v[176:179], v20, s[32:35], s49 offen offset:0
  buffer_load_dwordx4 v[180:183], v21, s[32:35], s49 offen offset:1024
  buffer_load_dwordx4 v[184:187], v22, s[32:35], s49 offen offset:2048
  buffer_load_dwordx4 v[188:191], v23, s[32:35], s49 offen offset:3072
  s_add_u32 s49, s49, 57344
  s_setprio 0
W_26:
  ds_read_b128 v[32:35], v2 offset:0
  s_waitcnt lgkmcnt(0)
  v_min3_u32 v32, v32, v33, v34
  v_min_u32 v32, v32, v35
  s_nop 0
  v_readfirstlane_b32 s49, v32
  s_sub_u32 s90, s90, 1
  s_cbranch_scc1 WD_27
  s_cmp_ge_u32 s49, 2
  s_cbranch_scc0 W_26
WD_27:
  s_setprio 2
  s_add_u32 s49, s47, 0
  s_cmp_ge_u32 s49, 7
  s_cselect_b32 s50, 7, 0
  s_sub_u32 s49, s49, s50
  s_mul_i32 s49, s49, 172032
  s_mov_b32 m0, 32768
  s_waitcnt vmcnt(20)
  buffer_load_dwordx4 v36, s[16:19], s49 offen offset:0 lds
  buffer_load_dwordx4 v37, s[16:19], s49 offen offset:1024 lds
  buffer_load_dwordx4 v38, s[16:19], s49 offen offset:2048 lds
  buffer_load_dwordx4 v39, s[16:19], s49 offen offset:3072 lds
  s_add_u32 s49, s47, 1
  s_cmp_ge_u32 s49, 7
  s_cselect_b32 s50, 7, 0
  s_sub_u32 s49, s49, s50
  s_mul_i32 s49, s49, 172032
  s_mov_b32 m0, 36864
  s_waitcnt vmcnt(20)
  buffer_load_dwordx4 v36, s[16:19], s49 offen offset:0 lds
  buffer_load_dwordx4 v37, s[16:19], s49 offen offset:1024 lds
  buffer_load_dwordx4 v38, s[16:19], s49 offen offset:2048 lds
  buffer_load_dwordx4 v39, s[16:19], s49 offen offset:3072 lds
  s_add_u32 s49, s47, 2
  s_cmp_ge_u32 s49, 7
  s_cselect_b32 s50, 7, 0
  s_sub_u32 s49, s49, s50
  s_mul_i32 s49, s49, 172032
  s_mov_b32 m0, 40960
  s_waitcnt vmcnt(20)
  buffer_load_dwordx4 v36, s[16:19], s49 offen offset:0 lds
  buffer_load_dwordx4 v37, s[16:19], s49 offen offset:1024 lds
  buffer_load_dwordx4 v38, s[16:19], s49 offen offset:2048 lds
  buffer_load_dwordx4 v39, s[16:19], s49 offen offset:3072 lds
  s_add_u32 s49, s47, 3
  s_cmp_ge_u32 s49, 7
  s_cselect_b32 s50, 7, 0
  s_sub_u32 s49, s49, s50
  s_mul_i32 s49, s49, 172032
  s_mov_b32 m0, 45056
  s_waitcnt vmcnt(20)
  buffer_load_dwordx4 v36, s[16:19], s49 offen offset:0 lds
  buffer_load_dwordx4 v37, s[16:19], s49 offen offset:1024 lds
  buffer_load_dwordx4 v38, s[16:19], s49 offen offset:2048 lds
  buffer_load_dwordx4 v39, s[16:19], s49 offen offset:3072 lds
  s_add_u32 s49, s47, 4
  s_cmp_ge_u32 s49, 7
  s_cselect_b32 s50, 7, 0
  s_sub_u32 s49, s49, s50
  s_mul_i32 s49, s49, 172032
  s_mov_b32 m0, 49152
  s_waitcnt vmcnt(20)
  buffer_load_dwordx4 v36, s[16:19], s49 offen offset:0 lds
  buffer_load_dwordx4 v37, s[16:19], s49 offen offset:1024 lds
  buffer_load_dwordx4 v38, s[16:19], s49 offen offset:2048 lds
  buffer_load_dwordx4 v39, s[16:19], s49 offen offset:3072 lds
  s_add_u32 s49, s47, 5
  s_cmp_ge_u32 s49, 7
  s_cselect_b32 s50, 7, 0
  s_sub_u32 s49, s49, s50
  s_mul_i32 s49, s49, 172032
  s_mov_b32 m0, 53248
  s_waitcnt vmcnt(20)
  buffer_load_dwordx4 v36, s[16:19], s49 offen offset:0 lds
  buffer_load_dwordx4 v37, s[16:19], s49 offen offset:1024 lds
  buffer_load_dwordx4 v38, s[16:19], s49 offen offset:2048 lds
  buffer_load_dwordx4 v39, s[16:19], s49 offen offset:3072 lds
  s_add_u32 s49, s47, 6
  s_cmp_ge_u32 s49, 7
  s_cselect_b32 s50, 7, 0
  s_sub_u32 s49, s49, s50
  s_mul_i32 s49, s49, 172032
  s_mov_b32 m0, 57344
  s_waitcnt vmcnt(20)
  v_mov_b32 v3, 15
  ds_write_b32 v7, v3
  buffer_load_dwordx4 v36, s[16:19], s49 offen offset:0 lds
  buffer_load_dwordx4 v37, s[16:19], s49 offen offset:1024 lds
  buffer_load_dwordx4 v38, s[16:19], s49 offen offset:2048 lds
  buffer_load_dwordx4 v39, s[16:19], s49 offen offset:3072 lds
  s_add_u32 s49, s100, 6
  s_cmp_ge_u32 s49, 7
  s_cselect_b32 s50, 7, 0
  s_sub_u32 s49, s49, s50
  s_mul_i32 s49, s49, 229376
  s_lshl_b32 s50, s99, 8
  s_add_u32 s49, s49, s50
  s_waitcnt vmcnt(20)
  v_mov_b32 v3, 16
  ds_write_b32 v7, v3
  buffer_load_dwordx4 v[192:195], v20, s[32:35], s49 offen offset:0
  buffer_load_dwordx4 v[196:199], v21, s[32:35], s49 offen offset:1024
  buffer_load_dwordx4 v[200:203], v22, s[32:35], s49 offen offset:2048
  buffer_load_dwordx4 v[204:207], v23, s[32:35], s49 offen offset:3072
  s_add_u32 s49, s49, 57344
  s_waitcnt vmcnt(20)
  v_mov_b32 v3, 17
  ds_write_b32 v7, v3
  buffer_load_dwordx4 v[208:211], v20, s[32:35], s49 offen offset:0
  buffer_load_dwordx4 v[212:215], v21, s[32:35], s49 offen offset:1024
  buffer_load_dwordx4 v[216:219], v22, s[32:35], s49 offen offset:2048
  buffer_load_dwordx4 v[220:223], v23, s[32:35], s49 offen offset:3072
  s_add_u32 s49, s49, 57344
  s_waitcnt vmcnt(20)
  v_mov_b32 v3, 18
  ds_write_b32 v7, v3
  buffer_load_dwordx4 v[224:227], v20, s[32:35], s49 offen offset:0
  buffer_load_dwordx4 v[228:231], v21, s[32:35], s49 offen offset:1024
  buffer_load_dwordx4 v[232:235], v22, s[32:35], s49 offen offset:2048
  buffer_load_dwordx4 v[236:239], v23, s[32:35], s49 offen offset:3072
  s_add_u32 s49, s49, 57344
  s_waitcnt vmcnt(20)
  v_mov_b32 v3, 19
  ds_write_b32 v7, v3
  buffer_load_dwordx4 v[240:243], v20, s[32:35], s49 offen offset:0
  buffer_load_dwordx4 v[244:247], v21, s[32:35], s49 offen offset:1024
  buffer_load_dwordx4 v[248:251], v22, s[32:35], s49 offen offset:2048
  buffer_load_dwordx4 v[252:255], v23, s[32:35], s49 offen offset:3072
  s_add_u32 s49, s49, 57344
  s_setprio 0
W_28:
  ds_read_b128 v[32:35], v2 offset:0
  s_waitcnt lgkmcnt(0)
  v_min3_u32 v32, v32, v33, v34
  v_min_u32 v32, v32, v35
  s_nop 0
  v_readfirstlane_b32 s49, v32
  s_sub_u32 s90, s90, 1
  s_cbranch_scc1 WD_29
  s_cmp_ge_u32 s49, 3
  s_cbranch_scc0 W_28
WD_29:
  s_setprio 2
  s_setprio 0
W_31:
  ds_read_b32 v32, v2 offset:20
  s_waitcnt lgkmcnt(0)
  v_readfirstlane_b32 s49, v32
  s_sub_u32 s90, s90, 1
  s_cbranch_scc1 WD_30
  s_cmp_ge_u32 s49, 1
  s_cbranch_scc0 W_31
  s_setprio 2
WD_30:
  s_add_u32 s52, s101, 0
  s_cmp_ge_u32 s52, 7
  s_cselect_b32 s50, 7, 0
  s_sub_u32 s52, s52, s50
  s_mul_i32 s49, s52, 57344
  s_add_u32 s49, s49, s88
  s_lshl_b32 s52, s52, 13
  s_add_u32 m0, s52, 98304
  s_waitcnt vmcnt(20)
  v_mov_b32 v3, 20
  ds_write_b32 v7, v3
  buffer_load_dwordx4 v12, s[28:31], s49 offen offset:0 lds
  buffer_load_dwordx4 v13, s[28:31], s49 offen offset:1024 lds
  buffer_load_dwordx4 v14, s[28:31], s49 offen offset:2048 lds
  buffer_load_dwordx4 v15, s[28:31], s49 offen offset:3072 lds
  s_add_u32 s49, s49, 28672
  s_add_u32 m0, s52, 102400
  s_waitcnt vmcnt(20)
  v_mov_b32 v3, 21
  ds_write_b32 v7, v3
  buffer_load_dwordx4 v12, s[28:31], s49 offen offset:0 lds
  buffer_load_dwordx4 v13, s[28:31], s49 offen offset:1024 lds
  buffer_load_dwordx4 v14, s[28:31], s49 offen offset:2048 lds
  buffer_load_dwordx4 v15, s[28:31], s49 offen offset:3072 lds
  s_add_u32 s52, s101, 1
  s_cmp_ge_u32 s52, 7
  s_cselect_b32 s50, 7, 0
  s_sub_u32 s52, s52, s50
  s_mul_i32 s49, s52, 57344
  s_add_u32 s49, s49, s88
  s_lshl_b32 s52, s52, 13
  s_add_u32 m0, s52, 98304
  s_waitcnt vmcnt(20)
  buffer_load_dwordx4 v12, s[28:31], s49 offen offset:0 lds
  buffer_load_dwordx4 v13, s[28:31], s49 offen offset:1024 lds
  buffer_load_dwordx4 v14, s[28:31], s49 offen offset:2048 lds
  buffer_load_dwordx4 v15, s[28:31], s49 offen offset:3072 lds
  s_add_u32 s49, s49, 28672
  s_add_u32 m0, s52, 102400
  s_waitcnt vmcnt(20)
  buffer_load_dwordx4 v12, s[28:31], s49 offen offset:0 lds
  buffer_load_dwordx4 v13, s[28:31], s49 offen offset:1024 lds
  buffer_load_dwordx4 v14, s[28:31], s49 offen offset:2048 lds
  buffer_load_dwordx4 v15, s[28:31], s49 offen offset:3072 lds
  s_add_u32 s52, s101, 2
  s_cmp_ge_u32 s52, 7
  s_cselect_b32 s50, 7, 0
  s_sub_u32 s52, s52, s50
  s_mul_i32 s49, s52, 57344
  s_add_u32 s49, s49, s88
  s_lshl_b32 s52, s52, 13
  s_add_u32 m0, s52, 98304
  s_waitcnt vmcnt(20)
  buffer_load_dwordx4 v12, s[28:31], s49 offen offset:0 lds
  buffer_load_dwordx4 v13, s[28:31], s49 offen offset:1024 lds
  buffer_load_dwordx4 v14, s[28:31], s49 offen offset:2048 lds
  buffer_load_dwordx4 v15, s[28:31], s49 offen offset:3072 lds
  s_add_u32 s49, s49, 28672
  s_add_u32 m0, s52, 102400
  s_waitcnt vmcnt(20)
  buffer_load_dwordx4 v12, s[28:31], s49 offen offset:0 lds
  buffer_load_dwordx4 v13, s[28:31], s49 offen offset:1024 lds
  buffer_load_dwordx4 v14, s[28:31], s49 offen offset:2048 lds
  buffer_load_dwordx4 v15, s[28:31], s49 offen offset:3072 lds
  s_add_u32 s52, s101, 3
  s_cmp_ge_u32 s52, 7
  s_cselect_b32 s50, 7, 0
  s_sub_u32 s52, s52, s50
  s_mul_i32 s49, s52, 57344
  s_add_u32 s49, s49, s88
  s_lshl_b32 s52, s52, 13
  s_add_u32 m0, s52, 98304
  s_nop 0
  buffer_load_dwordx4 v12, s[28:31], s49 offen offset:0 lds
  buffer_load_dwordx4 v13, s[28:31], s49 offen offset:1024 lds
  buffer_load_dwordx4 v14, s[28:31], s49 offen offset:2048 lds
  buffer_load_dwordx4 v15, s[28:31], s49 offen offset:3072 lds
  s_add_u32 s49, s49, 28672
  s_add_u32 m0, s52, 102400
  s_nop 0
  buffer_load_dwordx4 v12, s[28:31], s49 offen offset:0 lds
  buffer_load_dwordx4 v13, s[28:31], s49 offen offset:1024 lds
  buffer_load_dwordx4 v14, s[28:31], s49 offen offset:2048 lds
  buffer_load_dwordx4 v15, s[28:31], s49 offen offset:3072 lds
  s_add_u32 s52, s101, 4
  s_cmp_ge_u32 s52, 7
  s_cselect_b32 s50, 7, 0
  s_sub_u32 s52, s52, s50
  s_mul_i32 s49, s52, 57344
  s_add_u32 s49, s49, s88
  s_lshl_b32 s52, s52, 13
  s_add_u32 m0, s52, 98304
  s_waitcnt vmcnt(28)
  buffer_load_dwordx4 v12, s[28:31], s49 offen offset:0 lds
  buffer_load_dwordx4 v13, s[28:31], s49 offen offset:1024 lds
  buffer_load_dwordx4 v14, s[28:31], s49 offen offset:2048 lds
  buffer_load_dwordx4 v15, s[28:31], s49 offen offset:3072 lds
  s_add_u32 s49, s49, 28672
  s_add_u32 m0, s52, 102400
  s_waitcnt vmcnt(28)
  buffer_load_dwordx4 v12, s[28:31], s49 offen offset:0 lds
  buffer_load_dwordx4 v13, s[28:31], s49 offen offset:1024 lds
  buffer_load_dwordx4 v14, s[28:31], s49 offen offset:2048 lds
  buffer_load_dwordx4 v15, s[28:31], s49 offen offset:3072 lds
  s_add_u32 s52, s101, 5
  s_cmp_ge_u32 s52, 7
  s_cselect_b32 s50, 7, 0
  s_sub_u32 s52, s52, s50
  s_mul_i32 s49, s52, 57344
  s_add_u32 s49, s49, s88
  s_lshl_b32 s52, s52, 13
  s_add_u32 m0, s52, 98304
  s_waitcnt vmcnt(28)
  buffer_load_dwordx4 v12, s[28:31], s49 offen offset:0 lds
  buffer_load_dwordx4 v13, s[28:31], s49 offen offset:1024 lds
  buffer_load_dwordx4 v14, s[28:31], s49 offen offset:2048 lds
  buffer_load_dwordx4 v15, s[28:31], s49 offen offset:3072 lds
  s_add_u32 s49, s49, 28672
  s_add_u32 m0, s52, 102400
  s_waitcnt vmcnt(28)
  buffer_load_dwordx4 v12, s[28:31], s49 offen offset:0 lds
  buffer_load_dwordx4 v13, s[28:31], s49 offen offset:1024 lds
  buffer_load_dwordx4 v14, s[28:31], s49 offen offset:2048 lds
  buffer_load_dwordx4 v15, s[28:31], s49 offen offset:3072 lds
  s_add_u32 s52, s101, 6
  s_cmp_ge_u32 s52, 7
  s_cselect_b32 s50, 7, 0
  s_sub_u32 s52, s52, s50
  s_mul_i32 s49, s52, 57344
  s_add_u32 s49, s49, s88
  s_lshl_b32 s52, s52, 13
  s_add_u32 m0, s52, 98304
  s_waitcnt vmcnt(28)
  buffer_load_dwordx4 v12, s[28:31], s49 offen offset:0 lds
  buffer_load_dwordx4 v13, s[28:31], s49 offen offset:1024 lds
  buffer_load_dwordx4 v14, s[28:31], s49 offen offset:2048 lds
  buffer_load_dwordx4 v15, s[28:31], s49 offen offset:3072 lds
  s_add_u32 s49, s49, 28672
  s_add_u32 m0, s52, 102400
  s_waitcnt vmcnt(28)
  buffer_load_dwordx4 v12, s[28:31], s49 offen offset:0 lds
  buffer_load_dwordx4 v13, s[28:31], s49 offen offset:1024 lds
  buffer_load_dwordx4 v14, s[28:31], s49 offen offset:2048 lds
  buffer_load_dwordx4 v15, s[28:31], s49 offen offset:3072 lds
  s_setprio 0
W_32:
  ds_read_b128 v[32:35], v2 offset:16
  s_waitcnt lgkmcnt(0)
  v_min_u32 v33, v33, v34
  s_nop 0
  v_readfirstlane_b32 s49, v33
  s_sub_u32 s90, s90, 1
  s_cbranch_scc1 WD_33
  s_cmp_ge_u32 s49, 2
  s_cbranch_scc0 W_32
WD_33:
  s_setprio 2
  s_add_u32 s49, s100, 0
  s_cmp_ge_u32 s49, 7
  s_cselect_b32 s50, 7, 0
  s_sub_u32 s49, s49, s50
  s_mul_i32 s49, s49, 229376
  s_lshl_b32 s50, s99, 8
  s_add_u32 s49, s49, s50
  s_mov_b32 m0, 0
  s_waitcnt vmcnt(28)
  buffer_load_dwordx4 v20, s[32:35], s49 offen offset:0 lds
  buffer_load_dwordx4 v21, s[32:35], s49 offen offset:1024 lds
  buffer_load_dwordx4 v22, s[32:35], s49 offen offset:2048 lds
  buffer_load_dwordx4 v23, s[32:35], s49 offen offset:3072 lds
  s_add_u32 s49, s49, 57344
  s_mov_b32 m0, 4096
  s_waitcnt vmcnt(28)
  buffer_load_dwordx4 v20, s[32:35], s49 offen offset:0 lds
  buffer_load_dwordx4 v21, s[32:35], s49 offen offset:1024 lds
  buffer_load_dwordx4 v22, s[32:35], s49 offen offset:2048 lds
  buffer_load_dwordx4 v23, s[32:35], s49 offen offset:3072 lds
  s_add_u32 s49, s49, 57344
  s_mov_b32 m0, 8192
  s_waitcnt vmcnt(28)
  buffer_load_dwordx4 v20, s[32:35], s49 offen offset:0 lds
  buffer_load_dwordx4 v21, s[32:35], s49 offen offset:1024 lds
  buffer_load_dwordx4 v22, s[32:35], s49 offen offset:2048 lds
  buffer_load_dwordx4 v23, s[32:35], s49 offen offset:3072 lds
  s_add_u32 s49, s49, 57344
  s_mov_b32 m0, 12288
  s_waitcnt vmcnt(28)
  buffer_load_dwordx4 v20, s[32:35], s49 offen offset:0 lds
  buffer_load_dwordx4 v21, s[32:35], s49 offen offset:1024 lds
  buffer_load_dwordx4 v22, s[32:35], s49 offen offset:2048 lds
  buffer_load_dwordx4 v23, s[32:35], s49 offen offset:3072 lds
  s_add_u32 s49, s100, 1
  s_cmp_ge_u32 s49, 7
  s_cselect_b32 s50, 7, 0
  s_sub_u32 s49, s49, s50
  s_mul_i32 s49, s49, 229376
  s_lshl_b32 s50, s99, 8
  s_add_u32 s49, s49, s50
  s_mov_b32 m0, 16384
  s_waitcnt vmcnt(28)
  buffer_load_dwordx4 v20, s[32:35], s49 offen offset:0 lds
  buffer_load_dwordx4 v21, s[32:35], s49 offen offset:1024 lds
  buffer_load_dwordx4 v22, s[32:35], s49 offen offset:2048 lds
  buffer_load_dwordx4 v23, s[32:35], s49 offen offset:3072 lds
  s_add_u32 s49, s49, 57344
  s_mov_b32 m0, 20480
  s_waitcnt vmcnt(28)
  buffer_load_dwordx4 v20, s[32:35], s49 offen offset:0 lds
  buffer_load_dwordx4 v21, s[32:35], s49 offen offset:1024 lds
  buffer_load_dwordx4 v22, s[32:35], s49 offen offset:2048 lds
  buffer_load_dwordx4 v23, s[32:35], s49 offen offset:3072 lds
  s_add_u32 s49, s49, 57344
  s_mov_b32 m0, 24576
  s_waitcnt vmcnt(28)
  buffer_load_dwordx4 v20, s[32:35], s49 offen offset:0 lds
  buffer_load_dwordx4 v21, s[32:35], s49 offen offset:1024 lds
  buffer_load_dwordx4 v22, s[32:35], s49 offen offset:2048 lds
  buffer_load_dwordx4 v23, s[32:35], s49 offen offset:3072 lds
  s_add_u32 s49, s49, 57344
  s_mov_b32 m0, 28672
  s_waitcnt vmcnt(28)
  v_mov_b32 v3, 22
  ds_write_b32 v7, v3
  buffer_load_dwordx4 v20, s[32:35], s49 offen offset:0 lds
  buffer_load_dwordx4 v21, s[32:35], s49 offen offset:1024 lds
  buffer_load_dwordx4 v22, s[32:35], s49 offen offset:2048 lds
  buffer_load_dwordx4 v23, s[32:35], s49 offen offset:3072 lds
  s_add_u32 s49, s100, 2
  s_cmp_ge_u32 s49, 7
  s_cselect_b32 s50, 7, 0
  s_sub_u32 s49, s49, s50
  s_mul_i32 s49, s49, 229376
  s_lshl_b32 s50, s99, 8
  s_add_u32 s49, s49, s50
  s_mov_b32 m0, 65536
  s_waitcnt vmcnt(28)
  buffer_load_dwordx4 v20, s[32:35], s49 offen offset:0 lds
  buffer_load_dwordx4 v21, s[32:35], s49 offen offset:1024 lds
  buffer_load_dwordx4 v22, s[32:35], s49 offen offset:2048 lds
  buffer_load_dwordx4 v23, s[32:35], s49 offen offset:3072 lds
  s_add_u32 s49, s49, 57344
  s_mov_b32 m0, 69632
  s_waitcnt vmcnt(28)
  buffer_load_dwordx4 v20, s[32:35], s49 offen offset:0 lds
  buffer_load_dwordx4 v21, s[32:35], s49 offen offset:1024 lds
  buffer_load_dwordx4 v22, s[32:35], s49 offen offset:2048 lds
  buffer_load_dwordx4 v23, s[32:35], s49 offen offset:3072 lds
  s_add_u32 s49, s49, 57344
  s_mov_b32 m0, 73728
  s_waitcnt vmcnt(28)
  buffer_load_dwordx4 v20, s[32:35], s49 offen offset:0 lds
  buffer_load_dwordx4 v21, s[32:35], s49 offen offset:1024 lds
  buffer_load_dwordx4 v22, s[32:35], s49 offen offset:2048 lds
  buffer_load_dwordx4 v23, s[32:35], s49 offen offset:3072 lds
  s_add_u32 s49, s49, 57344
  s_mov_b32 m0, 77824
  s_waitcnt vmcnt(28)
  v_mov_b32 v3, 23
  ds_write_b32 v7, v3
  buffer_load_dwordx4 v20, s[32:35], s49 offen offset:0 lds
  buffer_load_dwordx4 v21, s[32:35], s49 offen offset:1024 lds
  buffer_load_dwordx4 v22, s[32:35], s49 offen offset:2048 lds
  buffer_load_dwordx4 v23, s[32:35], s49 offen offset:3072 lds
  s_add_u32 s49, s100, 3
  s_cmp_ge_u32 s49, 7
  s_cselect_b32 s50, 7, 0
  s_sub_u32 s49, s49, s50
  s_mul_i32 s49, s49, 229376
  s_lshl_b32 s50, s99, 8
  s_add_u32 s49, s49, s50
  s_mov_b32 m0, 81920
  s_waitcnt vmcnt(28)
  buffer_load_dwordx4 v20, s[32:35], s49 offen offset:0 lds
  buffer_load_dwordx4 v21, s[32:35], s49 offen offset:1024 lds
  buffer_load_dwordx4 v22, s[32:35], s49 offen offset:2048 lds
  buffer_load_dwordx4 v23, s[32:35], s49 offen offset:3072 lds
  s_add_u32 s49, s49, 57344
  s_mov_b32 m0, 86016
  s_waitcnt vmcnt(28)
  buffer_load_dwordx4 v20, s[32:35], s49 offen offset:0 lds
  buffer_load_dwordx4 v21, s[32:35], s49 offen offset:1024 lds
  buffer_load_dwordx4 v22, s[32:35], s49 offen offset:2048 lds
  buffer_load_dwordx4 v23, s[32:35], s49 offen offset:3072 lds
  s_add_u32 s49, s49, 57344
  s_mov_b32 m0, 90112
  s_waitcnt vmcnt(28)
  buffer_load_dwordx4 v20, s[32:35], s49 offen offset:0 lds
  buffer_load_dwordx4 v21, s[32:35], s49 offen offset:1024 lds
  buffer_load_dwordx4 v22, s[32:35], s49 offen offset:2048 lds
  buffer_load_dwordx4 v23, s[32:35], s49 offen offset:3072 lds
  s_add_u32 s49, s49, 57344
  s_mov_b32 m0, 94208
  s_waitcnt vmcnt(28)
  v_mov_b32 v3, 24
  ds_write_b32 v7, v3
  buffer_load_dwordx4 v20, s[32:35], s49 offen offset:0 lds
  buffer_load_dwordx4 v21, s[32:35], s49 offen offset:1024 lds
  buffer_load_dwordx4 v22, s[32:35], s49 offen offset:2048 lds
  buffer_load_dwordx4 v23, s[32:35], s49 offen offset:3072 lds
  s_waitcnt vmcnt(16)
  v_mov_b32 v3, 25
  ds_write_b32 v7, v3
  s_waitcnt vmcnt(0)
  v_mov_b32 v3, 26
  ds_write_b32 v7, v3
  s_setprio 0
W_34:
  ds_read_b128 v[32:35], v2 offset:0
  s_waitcnt lgkmcnt(0)
  v_min3_u32 v32, v32, v33, v34
  v_min_u32 v32, v32, v35
  s_nop 0
  v_readfirstlane_b32 s49, v32
  s_sub_u32 s90, s90, 1
  s_cbranch_scc1 WD_35
  s_cmp_ge_u32 s49, 7
  s_cbranch_scc0 W_34
WD_35:
  s_setprio 2
  s_setprio 0
W_37:
  ds_read_b32 v32, v2 offset:28
  s_waitcnt lgkmcnt(0)
  v_readfirstlane_b32 s49, v32
  s_sub_u32 s90, s90, 1
  s_cbranch_scc1 WD_36
  s_cmp_ge_u32 s49, 9
  s_cbranch_scc0 W_37
  s_setprio 2
WD_36:
  v_add_u32 v4, 32768, v5
  s_setprio 0
  ds_write_b128 v4, v[64:67] offset:0
  ds_write_b128 v4, v[68:71] offset:1024
  ds_write_b128 v4, v[72:75] offset:2048
  ds_write_b128 v4, v[76:79] offset:3072
  ds_write_b128 v4, v[80:83] offset:4096
  ds_write_b128 v4, v[84:87] offset:5120
  ds_write_b128 v4, v[88:91] offset:6144
  ds_write_b128 v4, v[92:95] offset:7168
  ds_write_b128 v4, v[96:99] offset:8192
  ds_write_b128 v4, v[100:103] offset:9216
  ds_write_b128 v4, v[104:107] offset:10240
  ds_write_b128 v4, v[108:111] offset:11264
  ds_write_b128 v4, v[112:115] offset:12288
  ds_write_b128 v4, v[116:119] offset:13312
  ds_write_b128 v4, v[120:123] offset:14336
  ds_write_b128 v4, v[124:127] offset:15360
  v_mov_b32 v3, 27
  ds_write_b32 v7, v3
  s_setprio 0
W_38:
  ds_read_b128 v[32:35], v2 offset:96
  s_waitcnt lgkmcnt(0)
  v_min3_u32 v32, v32, v33, v34
  v_min_u32 v32, v32, v35
  s_nop 0
  v_readfirstlane_b32 s49, v32
  s_sub_u32 s90, s90, 1
  s_cbranch_scc1 WD_39
  s_cmp_ge_u32 s49, 1
  s_cbranch_scc0 W_38
WD_39:
  s_setprio 2
  v_add_u32 v4, 0, v5
  s_setprio 0
  ds_write_b128 v4, v[128:131] offset:0
  ds_write_b128 v4, v[132:135] offset:1024
  ds_write_b128 v4, v[136:139] offset:2048
  ds_write_b128 v4, v[140:143] offset:3072
  ds_write_b128 v4, v[144:147] offset:4096
  ds_write_b128 v4, v[148:151] offset:5120
  ds_write_b128 v4, v[152:155] offset:6144
  ds_write_b128 v4, v[156:159] offset:7168
  ds_write_b128 v4, v[160:163] offset:8192
  ds_write_b128 v4, v[164:167] offset:9216
  ds_write_b128 v4, v[168:171] offset:10240
  ds_write_b128 v4, v[172:175] offset:11264
  ds_write_b128 v4, v[176:179] offset:12288
  ds_write_b128 v4, v[180:183] offset:13312
  ds_write_b128 v4, v[184:187] offset:14336
  ds_write_b128 v4, v[188:191] offset:15360
  v_mov_b32 v3, 28
  ds_write_b32 v7, v3
  v_add_u32 v4, 16384, v5
  s_setprio 0
  ds_write_b128 v4, v[192:195] offset:0
  ds_write_b128 v4, v[196:199] offset:1024
  ds_write_b128 v4, v[200:203] offset:2048
  ds_write_b128 v4, v[204:207] offset:3072
  ds_write_b128 v4, v[208:211] offset:4096
  ds_write_b128 v4, v[212:215] offset:5120
  ds_write_b128 v4, v[216:219] offset:6144
  ds_write_b128 v4, v[220:223] offset:7168
  ds_write_b128 v4, v[224:227] offset:8192
  ds_write_b128 v4, v[228:231] offset:9216
  ds_write_b128 v4, v[232:235] offset:10240
  ds_write_b128 v4, v[236:239] offset:11264
  ds_write_b128 v4, v[240:243] offset:12288
  ds_write_b128 v4, v[244:247] offset:13312
  ds_write_b128 v4, v[248:251] offset:14336
  ds_write_b128 v4, v[252:255] offset:15360
  v_mov_b32 v3, 29
  ds_write_b32 v7, v3
  s_setprio 0
W_40:
  ds_read_b128 v[32:35], v2 offset:0
  s_waitcnt lgkmcnt(0)
  v_min3_u32 v32, v32, v33, v34
  v_min_u32 v32, v32, v35
  s_nop 0
  v_readfirstlane_b32 s49, v32
  s_sub_u32 s90, s90, 1
  s_cbranch_scc1 WD_41
  s_cmp_ge_u32 s49, 12
  s_cbranch_scc0 ZZ_42
WD_41:
  s_setprio 2
  s_cmp_ge_u32 s0, 20
  s_cbranch_scc1 WD_43
  s_setprio 0
W_44:
  ds_read_b32 v32, v2 offset:28
  s_waitcnt lgkmcnt(0)
  v_readfirstlane_b32 s0, v32
  s_sub_u32 s90, s90, 1
  s_cbranch_scc1 WD_43
  s_cmp_ge_u32 s0, 20
  s_cbranch_scc0 ZZ_45
  s_setprio 2
WD_43:
  s_mov_b32 s89, 0
  s_mul_i32 s49, s8, 114688
  s_add_u32 s49, s49, s88
  s_mov_b32 m0, 32768
  s_nop 0
  buffer_load_dwordx4 v12, s[36:39], s49 offen offset:0 lds
  buffer_load_dwordx4 v13, s[36:39], s49 offen offset:1024 lds
  buffer_load_dwordx4 v14, s[36:39], s49 offen offset:2048 lds
  buffer_load_dwordx4 v15, s[36:39], s49 offen offset:3072 lds
  s_add_u32 s49, s49, 28672
  s_mov_b32 m0, 36864
  s_nop 0
  buffer_load_dwordx4 v12, s[36:39], s49 offen offset:0 lds
  buffer_load_dwordx4 v13, s[36:39], s49 offen offset:1024 lds
  buffer_load_dwordx4 v14, s[36:39], s49 offen offset:2048 lds
  buffer_load_dwordx4 v15, s[36:39], s49 offen offset:3072 lds
  s_mul_i32 s49, s9, 114688
  s_add_u32 s49, s49, s88
  s_add_u32 s49, s49, 802816
  s_mov_b32 m0, 40960
  s_nop 0
  buffer_load_dwordx4 v12, s[36:39], s49 offen offset:0 lds
  buffer_load_dwordx4 v13, s[36:39], s49 offen offset:1024 lds
  buffer_load_dwordx4 v14, s[36:39], s49 offen offset:2048 lds
  buffer_load_dwordx4 v15, s[36:39], s49 offen offset:3072 lds
  s_add_u32 s49, s49, 28672
  s_mov_b32 m0, 45056
  s_nop 0
  buffer_load_dwordx4 v12, s[36:39], s49 offen offset:0 lds
  buffer_load_dwordx4 v13, s[36:39], s49 offen offset:1024 lds
  buffer_load_dwordx4 v14, s[36:39], s49 offen offset:2048 lds
  buffer_load_dwordx4 v15, s[36:39], s49 offen offset:3072 lds
  s_cmp_ge_u32 s89, 4
  s_cbranch_scc1 WD_47
  s_setprio 0
W_46:
  ds_read_b128 v[32:35], v2 offset:256
  s_waitcnt lgkmcnt(0)
  v_min3_u32 v32, v32, v33, v34
  v_min_u32 v32, v32, v35
  s_nop 0
  v_readfirstlane_b32 s89, v32
  s_sub_u32 s90, s90, 1
  s_cbranch_scc1 WD_47
  s_cmp_ge_u32 s89, 4
  s_cbranch_scc0 W_46
WD_47:
  s_setprio 2
  s_mul_i32 s49, s8, 114688
  s_add_u32 s49, s49, s88
  s_add_u32 s49, s49, 57344
  s_add_u32 s8, s8, s10
  s_cmp_ge_u32 s8, 7
  s_cselect_b32 s50, 7, 0
  s_sub_u32 s8, s8, s50
  s_mov_b32 m0, 98304
  s_nop 0
  buffer_load_dwordx4 v12, s[36:39], s49 offen offset:0 lds
  buffer_load_dwordx4 v13, s[36:39], s49 offen offset:1024 lds
  buffer_load_dwordx4 v14, s[36:39], s49 offen offset:2048 lds
  buffer_load_dwordx4 v15, s[36:39], s49 offen offset:3072 lds
  s_add_u32 s49, s49, 28672
  s_mov_b32 m0, 102400
  s_nop 0
  buffer_load_dwordx4 v12, s[36:39], s49 offen offset:0 lds
  buffer_load_dwordx4 v13, s[36:39], s49 offen offset:1024 lds
  buffer_load_dwordx4 v14, s[36:39], s49 offen offset:2048 lds
  buffer_load_dwordx4 v15, s[36:39], s49 offen offset:3072 lds
  s_cmp_ge_u32 s89, 8
  s_cbranch_scc1 WD_49
  s_setprio 0
W_48:
  ds_read_b128 v[32:35], v2 offset:256
  s_waitcnt lgkmcnt(0)
  v_min3_u32 v32, v32, v33, v34
  v_min_u32 v32, v32, v35
  s_nop 0
  v_readfirstlane_b32 s89, v32
  s_sub_u32 s90, s90, 1
  s_cbranch_scc1 WD_49
  s_cmp_ge_u32 s89, 8
  s_cbranch_scc0 W_48
WD_49:
  s_setprio 2
  s_mul_i32 s49, s9, 114688
  s_add_u32 s49, s49, s88
  s_add_u32 s49, s49, 860160
  s_add_u32 s9, s9, s10
  s_cmp_ge_u32 s9, 7
  s_cselect_b32 s50, 7, 0
  s_sub_u32 s9, s9, s50
  s_mov_b32 m0, 106496
  s_nop 0
  buffer_load_dwordx4 v12, s[36:39], s49 offen offset:0 lds
  buffer_load_dwordx4 v13, s[36:39], s49 offen offset:1024 lds
  buffer_load_dwordx4 v14, s[36:39], s49 offen offset:2048 lds
  buffer_load_dwordx4 v15, s[36:39], s49 offen offset:3072 lds
  s_add_u32 s49, s49, 28672
  s_mov_b32 m0, 110592
  s_nop 0
  buffer_load_dwordx4 v12, s[36:39], s49 offen offset:0 lds
  buffer_load_dwordx4 v13, s[36:39], s49 offen offset:1024 lds
  buffer_load_dwordx4 v14, s[36:39], s49 offen offset:2048 lds
  buffer_load_dwordx4 v15, s[36:39], s49 offen offset:3072 lds
  s_setprio 0
W_50:
  ds_read_b128 v[32:35], v2 offset:16
  s_waitcnt lgkmcnt(0)
  v_min_u32 v33, v33, v34
  s_nop 0
  v_readfirstlane_b32 s49, v33
  s_sub_u32 s90, s90, 1
  s_cbranch_scc1 WD_51
  s_cmp_ge_u32 s49, 5
  s_cbranch_scc0 W_50
WD_51:
  s_setprio 2
  s_mul_i32 s49, s8, 114688
  s_add_u32 s49, s49, s88
  s_mov_b32 m0, 49152
  s_waitcnt vmcnt(28)
  buffer_load_dwordx4 v12, s[36:39], s49 offen offset:0 lds
  buffer_load_dwordx4 v13, s[36:39], s49 offen offset:1024 lds
  buffer_load_dwordx4 v14, s[36:39], s49 offen offset:2048 lds
  buffer_load_dwordx4 v15, s[36:39], s49 offen offset:3072 lds
  s_add_u32 s49, s49, 28672
  s_mov_b32 m0, 53248
  s_waitcnt vmcnt(28)
  v_mov_b32 v3, 30
  ds_write_b32 v7, v3
  buffer_load_dwordx4 v12, s[36:39], s49 offen offset:0 lds
  buffer_load_dwordx4 v13, s[36:39], s49 offen offset:1024 lds
  buffer_load_dwordx4 v14, s[36:39], s49 offen offset:2048 lds
  buffer_load_dwordx4 v15, s[36:39], s49 offen offset:3072 lds
  s_mul_i32 s49, s9, 114688
  s_add_u32 s49, s49, s88
  s_add_u32 s49, s49, 802816
  s_mov_b32 m0, 57344
  s_waitcnt vmcnt(28)
  buffer_load_dwordx4 v12, s[36:39], s49 offen offset:0 lds
  buffer_load_dwordx4 v13, s[36:39], s49 offen offset:1024 lds
  buffer_load_dwordx4 v14, s[36:39], s49 offen offset:2048 lds
  buffer_load_dwordx4 v15, s[36:39], s49 offen offset:3072 lds
  s_add_u32 s49, s49, 28672
  s_mov_b32 m0, 61440
  s_waitcnt vmcnt(28)
  v_mov_b32 v3, 31
  ds_write_b32 v7, v3
  buffer_load_dwordx4 v12, s[36:39], s49 offen offset:0 lds
  buffer_load_dwordx4 v13, s[36:39], s49 offen offset:1024 lds
  buffer_load_dwordx4 v14, s[36:39], s49 offen offset:2048 lds
  buffer_load_dwordx4 v15, s[36:39], s49 offen offset:3072 lds
  s_cmp_ge_u32 s89, 12
  s_cbranch_scc1 WD_53
  s_setprio 0
W_52:
  ds_read_b128 v[32:35], v2 offset:256
  s_waitcnt lgkmcnt(0)
  v_min3_u32 v32, v32, v33, v34
  v_min_u32 v32, v32, v35
  s_nop 0
  v_readfirstlane_b32 s89, v32
  s_sub_u32 s90, s90, 1
  s_cbranch_scc1 WD_53
  s_cmp_ge_u32 s89, 12
  s_cbranch_scc0 W_52
WD_53:
  s_setprio 2
  s_mul_i32 s49, s8, 114688
  s_add_u32 s49, s49, s88
  s_add_u32 s49, s49, 57344
  s_add_u32 s8, s8, s10
  s_cmp_ge_u32 s8, 7
  s_cselect_b32 s50, 7, 0
  s_sub_u32 s8, s8, s50
  s_mov_b32 m0, 114688
  s_waitcnt vmcnt(28)
  buffer_load_dwordx4 v12, s[36:39], s49 offen offset:0 lds
  buffer_load_dwordx4 v13, s[36:39], s49 offen offset:1024 lds
  buffer_load_dwordx4 v14, s[36:39], s49 offen offset:2048 lds
  buffer_load_dwordx4 v15, s[36:39], s49 offen offset:3072 lds
  s_add_u32 s49, s49, 28672
  s_mov_b32 m0, 118784
  s_waitcnt vmcnt(28)
  v_mov_b32 v3, 32
  ds_write_b32 v7, v3
  buffer_load_dwordx4 v12, s[36:39], s49 offen offset:0 lds
  buffer_load_dwordx4 v13, s[36:39], s49 offen offset:1024 lds
  buffer_load_dwordx4 v14, s[36:39], s49 offen offset:2048 lds
  buffer_load_dwordx4 v15, s[36:39], s49 offen offset:3072 lds
  s_cmp_ge_u32 s89, 16
  s_cbranch_scc1 WD_55
  s_setprio 0
W_54:
  ds_read_b128 v[32:35], v2 offset:256
  s_waitcnt lgkmcnt(0)
  v_min3_u32 v32, v32, v33, v34
  v_min_u32 v32, v32, v35
  s_nop 0
  v_readfirstlane_b32 s89, v32
  s_sub_u32 s90, s90, 1
  s_cbranch_scc1 WD_55
  s_cmp_ge_u32 s89, 16
  s_cbranch_scc0 W_54
WD_55:
  s_setprio 2
  s_mul_i32 s49, s9, 114688
  s_add_u32 s49, s49, s88
  s_add_u32 s49, s49, 860160
  s_add_u32 s9, s9, s10
  s_cmp_ge_u32 s9, 7
  s_cselect_b32 s50, 7, 0
  s_sub_u32 s9, s9, s50
  s_mov_b32 m0, 122880
  s_waitcnt vmcnt(28)
  buffer_load_dwordx4 v12, s[36:39], s49 offen offset:0 lds
  buffer_load_dwordx4 v13, s[36:39], s49 offen offset:1024 lds
  buffer_load_dwordx4 v14, s[36:39], s49 offen offset:2048 lds
  buffer_load_dwordx4 v15, s[36:39], s49 offen offset:3072 lds
  s_add_u32 s49, s49, 28672
  s_mov_b32 m0, 126976
  s_waitcnt vmcnt(28)
  v_mov_b32 v3, 33
  ds_write_b32 v7, v3
  buffer_load_dwordx4 v12, s[36:39], s49 offen offset:0 lds
  buffer_load_dwordx4 v13, s[36:39], s49 offen offset:1024 lds
  buffer_load_dwordx4 v14, s[36:39], s49 offen offset:2048 lds
  buffer_load_dwordx4 v15, s[36:39], s49 offen offset:3072 lds
  s_cmp_ge_u32 s89, 20
  s_cbranch_scc1 WD_57
  s_setprio 0
W_56:
  ds_read_b128 v[32:35], v2 offset:256
  s_waitcnt lgkmcnt(0)
  v_min3_u32 v32, v32, v33, v34
  v_min_u32 v32, v32, v35
  s_nop 0
  v_readfirstlane_b32 s89, v32
  s_sub_u32 s90, s90, 1
  s_cbranch_scc1 WD_57
  s_cmp_ge_u32 s89, 20
  s_cbranch_scc0 W_56
WD_57:
  s_setprio 2
  s_mul_i32 s49, s8, 114688
  s_add_u32 s49, s49, s88
  s_mov_b32 m0, 131072
  s_waitcnt vmcnt(28)
  buffer_load_dwordx4 v12, s[36:39], s49 offen offset:0 lds
  buffer_load_dwordx4 v13, s[36:39], s49 offen offset:1024 lds
  buffer_load_dwordx4 v14, s[36:39], s49 offen offset:2048 lds
  buffer_load_dwordx4 v15, s[36:39], s49 offen offset:3072 lds
  s_add_u32 s49, s49, 28672
  s_mov_b32 m0, 135168
  s_waitcnt vmcnt(28)
  v_mov_b32 v3, 34
  ds_write_b32 v7, v3
  buffer_load_dwordx4 v12, s[36:39], s49 offen offset:0 lds
  buffer_load_dwordx4 v13, s[36:39], s49 offen offset:1024 lds
  buffer_load_dwordx4 v14, s[36:39], s49 offen offset:2048 lds
  buffer_load_dwordx4 v15, s[36:39], s49 offen offset:3072 lds
  s_cmp_ge_u32 s89, 24
  s_cbranch_scc1 WD_59
  s_setprio 0
W_58:
  ds_read_b128 v[32:35], v2 offset:256
  s_waitcnt lgkmcnt(0)
  v_min3_u32 v32, v32, v33, v34
  v_min_u32 v32, v32, v35
  s_nop 0
  v_readfirstlane_b32 s89, v32
  s_sub_u32 s90, s90, 1
  s_cbranch_scc1 WD_59
  s_cmp_ge_u32 s89, 24
  s_cbranch_scc0 W_58
WD_59:
  s_setprio 2
  s_mul_i32 s49, s9, 114688
  s_add_u32 s49, s49, s88
  s_add_u32 s49, s49, 802816
  s_mov_b32 m0, 139264
  s_waitcnt vmcnt(28)
  buffer_load_dwordx4 v12, s[36:39], s49 offen offset:0 lds
  buffer_load_dwordx4 v13, s[36:39], s49 offen offset:1024 lds
  buffer_load_dwordx4 v14, s[36:39], s49 offen offset:2048 lds
  buffer_load_dwordx4 v15, s[36:39], s49 offen offset:3072 lds
  s_add_u32 s49, s49, 28672
  s_mov_b32 m0, 143360
  s_waitcnt vmcnt(28)
  v_mov_b32 v3, 35
  ds_write_b32 v7, v3
  buffer_load_dwordx4 v12, s[36:39], s49 offen offset:0 lds
  buffer_load_dwordx4 v13, s[36:39], s49 offen offset:1024 lds
  buffer_load_dwordx4 v14, s[36:39], s49 offen offset:2048 lds
  buffer_load_dwordx4 v15, s[36:39], s49 offen offset:3072 lds
  s_cmp_ge_u32 s89, 28
  s_cbranch_scc1 WD_61
  s_setprio 0
W_60:
  ds_read_b128 v[32:35], v2 offset:256
  s_waitcnt lgkmcnt(0)
  v_min3_u32 v32, v32, v33, v34
  v_min_u32 v32, v32, v35
  s_nop 0
  v_readfirstlane_b32 s89, v32
  s_sub_u32 s90, s90, 1
  s_cbranch_scc1 WD_61
  s_cmp_ge_u32 s89, 28
  s_cbranch_scc0 W_60
WD_61:
  s_setprio 2
  s_mul_i32 s49, s8, 114688
  s_add_u32 s49, s49, s88
  s_add_u32 s49, s49, 57344
  s_add_u32 s8, s8, s10
  s_cmp_ge_u32 s8, 7
  s_cselect_b32 s50, 7, 0
  s_sub_u32 s8, s8, s50
  s_mov_b32 m0, 147456
  s_waitcnt vmcnt(28)
  buffer_load_dwordx4 v12, s[36:39], s49 offen offset:0 lds
  buffer_load_dwordx4 v13, s[36:39], s49 offen offset:1024 lds
  buffer_load_dwordx4 v14, s[36:39], s49 offen offset:2048 lds
  buffer_load_dwordx4 v15, s[36:39], s49 offen offset:3072 lds
  s_add_u32 s49, s49, 28672
  s_mov_b32 m0, 151552
  s_waitcnt vmcnt(28)
  v_mov_b32 v3, 36
  ds_write_b32 v7, v3
  buffer_load_dwordx4 v12, s[36:39], s49 offen offset:0 lds
  buffer_load_dwordx4 v13, s[36:39], s49 offen offset:1024 lds
  buffer_load_dwordx4 v14, s[36:39], s49 offen offset:2048 lds
  buffer_load_dwordx4 v15, s[36:39], s49 offen offset:3072 lds
  s_cmp_ge_u32 s89, 32
  s_cbranch_scc1 WD_63
  s_setprio 0
W_62:
  ds_read_b128 v[32:35], v2 offset:256
  s_waitcnt lgkmcnt(0)
  v_min3_u32 v32, v32, v33, v34
  v_min_u32 v32, v32, v35
  s_nop 0
  v_readfirstlane_b32 s89, v32
  s_sub_u32 s90, s90, 1
  s_cbranch_scc1 WD_63
  s_cmp_ge_u32 s89, 32
  s_cbranch_scc0 W_62
WD_63:
  s_setprio 2
  s_mul_i32 s49, s9, 114688
  s_add_u32 s49, s49, s88
  s_add_u32 s49, s49, 860160
  s_add_u32 s9, s9, s10
  s_cmp_ge_u32 s9, 7
  s_cselect_b32 s50, 7, 0
  s_sub_u32 s9, s9, s50
  s_mov_b32 m0, 0
  s_waitcnt vmcnt(28)
  buffer_load_dwordx4 v12, s[36:39], s49 offen offset:0 lds
  buffer_load_dwordx4 v13, s[36:39], s49 offen offset:1024 lds
  buffer_load_dwordx4 v14, s[36:39], s49 offen offset:2048 lds
  buffer_load_dwordx4 v15, s[36:39], s49 offen offset:3072 lds
  s_add_u32 s49, s49, 28672
  s_mov_b32 m0, 4096
  s_waitcnt vmcnt(28)
  v_mov_b32 v3, 37
  ds_write_b32 v7, v3
  buffer_load_dwordx4 v12, s[36:39], s49 offen offset:0 lds
  buffer_load_dwordx4 v13, s[36:39], s49 offen offset:1024 lds
  buffer_load_dwordx4 v14, s[36:39], s49 offen offset:2048 lds
  buffer_load_dwordx4 v15, s[36:39], s49 offen offset:3072 lds
  s_cmp_ge_u32 s89, 36
  s_cbranch_scc1 WD_65
  s_setprio 0
W_64:
  ds_read_b128 v[32:35], v2 offset:256
  s_waitcnt lgkmcnt(0)
  v_min3_u32 v32, v32, v33, v34
  v_min_u32 v32, v32, v35
  s_nop 0
  v_readfirstlane_b32 s89, v32
  s_sub_u32 s90, s90, 1
  s_cbranch_scc1 WD_65
  s_cmp_ge_u32 s89, 36
  s_cbranch_scc0 W_64
WD_65:
  s_setprio 2
  s_mul_i32 s49, s8, 114688
  s_add_u32 s49, s49, s88
  s_mov_b32 m0, 8192
  s_waitcnt vmcnt(28)
  buffer_load_dwordx4 v12, s[36:39], s49 offen offset:0 lds
  buffer_load_dwordx4 v13, s[36:39], s49 offen offset:1024 lds
  buffer_load_dwordx4 v14, s[36:39], s49 offen offset:2048 lds
  buffer_load_dwordx4 v15, s[36:39], s49 offen offset:3072 lds
  s_add_u32 s49, s49, 28672
  s_mov_b32 m0, 12288
  s_waitcnt vmcnt(28)
  v_mov_b32 v3, 38
  ds_write_b32 v7, v3
  buffer_load_dwordx4 v12, s[36:39], s49 offen offset:0 lds
  buffer_load_dwordx4 v13, s[36:39], s49 offen offset:1024 lds
  buffer_load_dwordx4 v14, s[36:39], s49 offen offset:2048 lds
  buffer_load_dwordx4 v15, s[36:39], s49 offen offset:3072 lds
  s_cmp_ge_u32 s89, 40
  s_cbranch_scc1 WD_67
  s_setprio 0
W_66:
  ds_read_b128 v[32:35], v2 offset:256
  s_waitcnt lgkmcnt(0)
  v_min3_u32 v32, v32, v33, v34
  v_min_u32 v32, v32, v35
  s_nop 0
  v_readfirstlane_b32 s89, v32
  s_sub_u32 s90, s90, 1
  s_cbranch_scc1 WD_67
  s_cmp_ge_u32 s89, 40
  s_cbranch_scc0 W_66
WD_67:
  s_setprio 2
  s_mul_i32 s49, s9, 114688
  s_add_u32 s49, s49, s88
  s_add_u32 s49, s49, 802816
  s_mov_b32 m0, 16384
  s_waitcnt vmcnt(28)
  buffer_load_dwordx4 v12, s[36:39], s49 offen offset:0 lds
  buffer_load_dwordx4 v13, s[36:39], s49 offen offset:1024 lds
  buffer_load_dwordx4 v14, s[36:39], s49 offen offset:2048 lds
  buffer_load_dwordx4 v15, s[36:39], s49 offen offset:3072 lds
  s_add_u32 s49, s49, 28672
  s_mov_b32 m0, 20480
  s_waitcnt vmcnt(28)
  v_mov_b32 v3, 39
  ds_write_b32 v7, v3
  buffer_load_dwordx4 v12, s[36:39], s49 offen offset:0 lds
  buffer_load_dwordx4 v13, s[36:39], s49 offen offset:1024 lds
  buffer_load_dwordx4 v14, s[36:39], s49 offen offset:2048 lds
  buffer_load_dwordx4 v15, s[36:39], s49 offen offset:3072 lds
  s_cmp_ge_u32 s89, 42
  s_cbranch_scc1 WD_69
  s_setprio 0
W_68:
  ds_read_b128 v[32:35], v2 offset:256
  s_waitcnt lgkmcnt(0)
  v_min3_u32 v32, v32, v33, v34
  v_min_u32 v32, v32, v35
  s_nop 0
  v_readfirstlane_b32 s89, v32
  s_sub_u32 s90, s90, 1
  s_cbranch_scc1 WD_69
  s_cmp_ge_u32 s89, 42
  s_cbranch_scc0 W_68
WD_69:
  s_setprio 2
  s_mul_i32 s49, s8, 114688
  s_add_u32 s49, s49, s88
  s_add_u32 s49, s49, 57344
  s_add_u32 s8, s8, s10
  s_cmp_ge_u32 s8, 7
  s_cselect_b32 s50, 7, 0
  s_sub_u32 s8, s8, s50
  s_mov_b32 m0, 24576
  s_waitcnt vmcnt(28)
  buffer_load_dwordx4 v12, s[36:39], s49 offen offset:0 lds
  buffer_load_dwordx4 v13, s[36:39], s49 offen offset:1024 lds
  buffer_load_dwordx4 v14, s[36:39], s49 offen offset:2048 lds
  buffer_load_dwordx4 v15, s[36:39], s49 offen offset:3072 lds
  s_add_u32 s49, s49, 28672
  s_mov_b32 m0, 28672
  s_waitcnt vmcnt(28)
  v_mov_b32 v3, 40
  ds_write_b32 v7, v3
  buffer_load_dwordx4 v12, s[36:39], s49 offen offset:0 lds
  buffer_load_dwordx4 v13, s[36:39], s49 offen offset:1024 lds
  buffer_load_dwordx4 v14, s[36:39], s49 offen offset:2048 lds
  buffer_load_dwordx4 v15, s[36:39], s49 offen offset:3072 lds
  s_cmp_ge_u32 s89, 46
  s_cbranch_scc1 WD_71
  s_setprio 0
W_70:
  ds_read_b128 v[32:35], v2 offset:256
  s_waitcnt lgkmcnt(0)
  v_min3_u32 v32, v32, v33, v34
  v_min_u32 v32, v32, v35
  s_nop 0
  v_readfirstlane_b32 s89, v32
  s_sub_u32 s90, s90, 1
  s_cbranch_scc1 WD_71
  s_cmp_ge_u32 s89, 46
  s_cbranch_scc0 W_70
WD_71:
  s_setprio 2
  s_mul_i32 s49, s9, 114688
  s_add_u32 s49, s49, s88
  s_add_u32 s49, s49, 860160
  s_add_u32 s9, s9, s10
  s_cmp_ge_u32 s9, 7
  s_cselect_b32 s50, 7, 0
  s_sub_u32 s9, s9, s50
  s_mov_b32 m0, 65536
  s_waitcnt vmcnt(28)
  buffer_load_dwordx4 v12, s[36:39], s49 offen offset:0 lds
  buffer_load_dwordx4 v13, s[36:39], s49 offen offset:1024 lds
  buffer_load_dwordx4 v14, s[36:39], s49 offen offset:2048 lds
  buffer_load_dwordx4 v15, s[36:39], s49 offen offset:3072 lds
  s_add_u32 s49, s49, 28672
  s_mov_b32 m0, 69632
  s_waitcnt vmcnt(28)
  v_mov_b32 v3, 41
  ds_write_b32 v7, v3
  buffer_load_dwordx4 v12, s[36:39], s49 offen offset:0 lds
  buffer_load_dwordx4 v13, s[36:39], s49 offen offset:1024 lds
  buffer_load_dwordx4 v14, s[36:39], s49 offen offset:2048 lds
  buffer_load_dwordx4 v15, s[36:39], s49 offen offset:3072 lds
  s_cmp_ge_u32 s89, 50
  s_cbranch_scc1 WD_73
  s_setprio 0
W_72:
  ds_read_b128 v[32:35], v2 offset:256
  s_waitcnt lgkmcnt(0)
  v_min3_u32 v32, v32, v33, v34
  v_min_u32 v32, v32, v35
  s_nop 0
  v_readfirstlane_b32 s89, v32
  s_sub_u32 s90, s90, 1
  s_cbranch_scc1 WD_73
  s_cmp_ge_u32 s89, 50
  s_cbranch_scc0 W_72
WD_73:
  s_setprio 2
  s_mul_i32 s49, s8, 114688
  s_add_u32 s49, s49, s88
  s_mov_b32 m0, 73728
  s_waitcnt vmcnt(28)
  buffer_load_dwordx4 v12, s[36:39], s49 offen offset:0 lds
  buffer_load_dwordx4 v13, s[36:39], s49 offen offset:1024 lds
  buffer_load_dwordx4 v14, s[36:39], s49 offen offset:2048 lds
  buffer_load_dwordx4 v15, s[36:39], s49 offen offset:3072 lds
  s_add_u32 s49, s49, 28672
  s_mov_b32 m0, 77824
  s_waitcnt vmcnt(28)
  v_mov_b32 v3, 42
  ds_write_b32 v7, v3
  buffer_load_dwordx4 v12, s[36:39], s49 offen offset:0 lds
  buffer_load_dwordx4 v13, s[36:39], s49 offen offset:1024 lds
  buffer_load_dwordx4 v14, s[36:39], s49 offen offset:2048 lds
  buffer_load_dwordx4 v15, s[36:39], s49 offen offset:3072 lds
  s_cmp_ge_u32 s89, 54
  s_cbranch_scc1 WD_75
  s_setprio 0
W_74:
  ds_read_b128 v[32:35], v2 offset:256
  s_waitcnt lgkmcnt(0)
  v_min3_u32 v32, v32, v33, v34
  v_min_u32 v32, v32, v35
  s_nop 0
  v_readfirstlane_b32 s89, v32
  s_sub_u32 s90, s90, 1
  s_cbranch_scc1 WD_75
  s_cmp_ge_u32 s89, 54
  s_cbranch_scc0 W_74
WD_75:
  s_setprio 2
  s_mul_i32 s49, s9, 114688
  s_add_u32 s49, s49, s88
  s_add_u32 s49, s49, 802816
  s_mov_b32 m0, 81920
  s_waitcnt vmcnt(28)
  buffer_load_dwordx4 v12, s[36:39], s49 offen offset:0 lds
  buffer_load_dwordx4 v13, s[36:39], s49 offen offset:1024 lds
  buffer_load_dwordx4 v14, s[36:39], s49 offen offset:2048 lds
  buffer_load_dwordx4 v15, s[36:39], s49 offen offset:3072 lds
  s_add_u32 s49, s49, 28672
  s_mov_b32 m0, 86016
  s_waitcnt vmcnt(28)
  v_mov_b32 v3, 43
  ds_write_b32 v7, v3
  buffer_load_dwordx4 v12, s[36:39], s49 offen offset:0 lds
  buffer_load_dwordx4 v13, s[36:39], s49 offen offset:1024 lds
  buffer_load_dwordx4 v14, s[36:39], s49 offen offset:2048 lds
  buffer_load_dwordx4 v15, s[36:39], s49 offen offset:3072 lds
  s_cmp_ge_u32 s89, 56
  s_cbranch_scc1 WD_77
  s_setprio 0
W_76:
  ds_read_b128 v[32:35], v2 offset:256
  s_waitcnt lgkmcnt(0)
  v_min3_u32 v32, v32, v33, v34
  v_min_u32 v32, v32, v35
  s_nop 0
  v_readfirstlane_b32 s89, v32
  s_sub_u32 s90, s90, 1
  s_cbranch_scc1 WD_77
  s_cmp_ge_u32 s89, 56
  s_cbranch_scc0 W_76
WD_77:
  s_setprio 2
  s_mul_i32 s49, s8, 114688
  s_add_u32 s49, s49, s88
  s_add_u32 s49, s49, 57344
  s_add_u32 s8, s8, s10
  s_cmp_ge_u32 s8, 7
  s_cselect_b32 s50, 7, 0
  s_sub_u32 s8, s8, s50
  s_mov_b32 m0, 90112
  s_waitcnt vmcnt(28)
  buffer_load_dwordx4 v12, s[36:39], s49 offen offset:0 lds
  buffer_load_dwordx4 v13, s[36:39], s49 offen offset:1024 lds
  buffer_load_dwordx4 v14, s[36:39], s49 offen offset:2048 lds
  buffer_load_dwordx4 v15, s[36:39], s49 offen offset:3072 lds
  s_add_u32 s49, s49, 28672
  s_mov_b32 m0, 94208
  s_waitcnt vmcnt(28)
  v_mov_b32 v3, 44
  ds_write_b32 v7, v3
  buffer_load_dwordx4 v12, s[36:39], s49 offen offset:0 lds
  buffer_load_dwordx4 v13, s[36:39], s49 offen offset:1024 lds
  buffer_load_dwordx4 v14, s[36:39], s49 offen offset:2048 lds
  buffer_load_dwordx4 v15, s[36:39], s49 offen offset:3072 lds
  s_setprio 0
W_78:
  ds_read_b128 v[32:35], v2 offset:0
  s_waitcnt lgkmcnt(0)
  v_min_u32 v32, v32, v33
  s_nop 0
  v_readfirstlane_b32 s49, v32
  s_sub_u32 s90, s90, 1
  s_cbranch_scc1 WD_79
  s_cmp_ge_u32 s49, 17
  s_cbranch_scc0 W_78
WD_79:
  s_setprio 2
  s_mul_i32 s49, s9, 114688
  s_add_u32 s49, s49, s88
  s_add_u32 s49, s49, 860160
  s_add_u32 s9, s9, s10
  s_cmp_ge_u32 s9, 7
  s_cselect_b32 s50, 7, 0
  s_sub_u32 s9, s9, s50
  s_mov_b32 m0, 32768
  s_waitcnt vmcnt(28)
  buffer_load_dwordx4 v12, s[36:39], s49 offen offset:0 lds
  buffer_load_dwordx4 v13, s[36:39], s49 offen offset:1024 lds
  buffer_load_dwordx4 v14, s[36:39], s49 offen offset:2048 lds
  buffer_load_dwordx4 v15, s[36:39], s49 offen offset:3072 lds
  s_add_u32 s49, s49, 28672
  s_mov_b32 m0, 36864
  s_waitcnt vmcnt(28)
  v_mov_b32 v3, 45
  ds_write_b32 v7, v3
  buffer_load_dwordx4 v12, s[36:39], s49 offen offset:0 lds
  buffer_load_dwordx4 v13, s[36:39], s49 offen offset:1024 lds
  buffer_load_dwordx4 v14, s[36:39], s49 offen offset:2048 lds
  buffer_load_dwordx4 v15, s[36:39], s49 offen offset:3072 lds
  s_setprio 0
W_80:
  ds_read_b128 v[32:35], v2 offset:0
  s_waitcnt lgkmcnt(0)
  v_min_u32 v34, v34, v35
  s_nop 0
  v_readfirstlane_b32 s49, v34
  s_sub_u32 s90, s90, 1
  s_cbranch_scc1 WD_81
  s_cmp_ge_u32 s49, 17
  s_cbranch_scc0 W_80
WD_81:
  s_setprio 2
  s_mul_i32 s49, s8, 114688
  s_add_u32 s49, s49, s88
  s_mov_b32 m0, 40960
  s_waitcnt vmcnt(28)
  buffer_load_dwordx4 v12, s[36:39], s49 offen offset:0 lds
  buffer_load_dwordx4 v13, s[36:39], s49 offen offset:1024 lds
  buffer_load_dwordx4 v14, s[36:39], s49 offen offset:2048 lds
  buffer_load_dwordx4 v15, s[36:39], s49 offen offset:3072 lds
  s_add_u32 s49, s49, 28672
  s_mov_b32 m0, 45056
  s_waitcnt vmcnt(28)
  v_mov_b32 v3, 46
  ds_write_b32 v7, v3
  buffer_load_dwordx4 v12, s[36:39], s49 offen offset:0 lds
  buffer_load_dwordx4 v13, s[36:39], s49 offen offset:1024 lds
  buffer_load_dwordx4 v14, s[36:39], s49 offen offset:2048 lds
  buffer_load_dwordx4 v15, s[36:39], s49 offen offset:3072 lds
  s_setprio 0
W_82:
  ds_read_b128 v[32:35], v2 offset:0
  s_waitcnt lgkmcnt(0)
  v_min_u32 v32, v32, v33
  s_nop 0
  v_readfirstlane_b32 s49, v32
  s_sub_u32 s90, s90, 1
  s_cbranch_scc1 WD_83
  s_cmp_ge_u32 s49, 18
  s_cbranch_scc0 W_82
WD_83:
  s_setprio 2
  s_mul_i32 s49, s9, 114688
  s_add_u32 s49, s49, s88
  s_add_u32 s49, s49, 802816
  s_mov_b32 m0, 98304
  s_waitcnt vmcnt(28)
  buffer_load_dwordx4 v12, s[36:39], s49 offen offset:0 lds
  buffer_load_dwordx4 v13, s[36:39], s49 offen offset:1024 lds
  buffer_load_dwordx4 v14, s[36:39], s49 offen offset:2048 lds
  buffer_load_dwordx4 v15, s[36:39], s49 offen offset:3072 lds
  s_add_u32 s49, s49, 28672
  s_mov_b32 m0, 102400
  s_waitcnt vmcnt(28)
  v_mov_b32 v3, 47
  ds_write_b32 v7, v3
  buffer_load_dwordx4 v12, s[36:39], s49 offen offset:0 lds
  buffer_load_dwordx4 v13, s[36:39], s49 offen offset:1024 lds
  buffer_load_dwordx4 v14, s[36:39], s49 offen offset:2048 lds
  buffer_load_dwordx4 v15, s[36:39], s49 offen offset:3072 lds
  s_setprio 0
W_84:
  ds_read_b128 v[32:35], v2 offset:0
  s_waitcnt lgkmcnt(0)
  v_min_u32 v34, v34, v35
  s_nop 0
  v_readfirstlane_b32 s49, v34
  s_sub_u32 s90, s90, 1
  s_cbranch_scc1 WD_85
  s_cmp_ge_u32 s49, 18
  s_cbranch_scc0 W_84
WD_85:
  s_setprio 2
  s_mul_i32 s49, s8, 114688
  s_add_u32 s49, s49, s88
  s_add_u32 s49, s49, 57344
  s_add_u32 s8, s8, s10
  s_cmp_ge_u32 s8, 7
  s_cselect_b32 s50, 7, 0
  s_sub_u32 s8, s8, s50
  s_mov_b32 m0, 106496
  s_waitcnt vmcnt(28)
  buffer_load_dwordx4 v12, s[36:39], s49 offen offset:0 lds
  buffer_load_dwordx4 v13, s[36:39], s49 offen offset:1024 lds
  buffer_load_dwordx4 v14, s[36:39], s49 offen offset:2048 lds
  buffer_load_dwordx4 v15, s[36:39], s49 offen offset:3072 lds
  s_add_u32 s49, s49, 28672
  s_mov_b32 m0, 110592
  s_waitcnt vmcnt(28)
  v_mov_b32 v3, 48
  ds_write_b32 v7, v3
  buffer_load_dwordx4 v12, s[36:39], s49 offen offset:0 lds
  buffer_load_dwordx4 v13, s[36:39], s49 offen offset:1024 lds
  buffer_load_dwordx4 v14, s[36:39], s49 offen offset:2048 lds
  buffer_load_dwordx4 v15, s[36:39], s49 offen offset:3072 lds
  s_setprio 0
W_86:
  ds_read_b128 v[32:35], v2 offset:0
  s_waitcnt lgkmcnt(0)
  v_min_u32 v32, v32, v33
  s_nop 0
  v_readfirstlane_b32 s49, v32
  s_sub_u32 s90, s90, 1
  s_cbranch_scc1 WD_87
  s_cmp_ge_u32 s49, 20
  s_cbranch_scc0 W_86
WD_87:
  s_setprio 2
  s_mul_i32 s49, s9, 114688
  s_add_u32 s49, s49, s88
  s_add_u32 s49, s49, 860160
  s_add_u32 s9, s9, s10
  s_cmp_ge_u32 s9, 7
  s_cselect_b32 s50, 7, 0
  s_sub_u32 s9, s9, s50
  s_mov_b32 m0, 114688
  s_waitcnt vmcnt(28)
  buffer_load_dwordx4 v12, s[36:39], s49 offen offset:0 lds
  buffer_load_dwordx4 v13, s[36:39], s49 offen offset:1024 lds
  buffer_load_dwordx4 v14, s[36:39], s49 offen offset:2048 lds
  buffer_load_dwordx4 v15, s[36:39], s49 offen offset:3072 lds
  s_add_u32 s49, s49, 28672
  s_mov_b32 m0, 118784
  s_waitcnt vmcnt(28)
  v_mov_b32 v3, 49
  ds_write_b32 v7, v3
  buffer_load_dwordx4 v12, s[36:39], s49 offen offset:0 lds
  buffer_load_dwordx4 v13, s[36:39], s49 offen offset:1024 lds
  buffer_load_dwordx4 v14, s[36:39], s49 offen offset:2048 lds
  buffer_load_dwordx4 v15, s[36:39], s49 offen offset:3072 lds
  s_setprio 0
W_88:
  ds_read_b128 v[32:35], v2 offset:0
  s_waitcnt lgkmcnt(0)
  v_min_u32 v34, v34, v35
  s_nop 0
  v_readfirstlane_b32 s49, v34
  s_sub_u32 s90, s90, 1
  s_cbranch_scc1 WD_89
  s_cmp_ge_u32 s49, 20
  s_cbranch_scc0 W_88
WD_89:
  s_setprio 2
  s_mul_i32 s49, s8, 114688
  s_add_u32 s49, s49, s88
  s_mov_b32 m0, 122880
  s_waitcnt vmcnt(28)
  buffer_load_dwordx4 v12, s[36:39], s49 offen offset:0 lds
  buffer_load_dwordx4 v13, s[36:39], s49 offen offset:1024 lds
  buffer_load_dwordx4 v14, s[36:39], s49 offen offset:2048 lds
  buffer_load_dwordx4 v15, s[36:39], s49 offen offset:3072 lds
  s_add_u32 s49, s49, 28672
  s_mov_b32 m0, 126976
  s_waitcnt vmcnt(28)
  v_mov_b32 v3, 50
  ds_write_b32 v7, v3
  buffer_load_dwordx4 v12, s[36:39], s49 offen offset:0 lds
  buffer_load_dwordx4 v13, s[36:39], s49 offen offset:1024 lds
  buffer_load_dwordx4 v14, s[36:39], s49 offen offset:2048 lds
  buffer_load_dwordx4 v15, s[36:39], s49 offen offset:3072 lds
  s_setprio 0
W_90:
  ds_read_b128 v[32:35], v2 offset:0
  s_waitcnt lgkmcnt(0)
  v_min_u32 v32, v32, v33
  s_nop 0
  v_readfirstlane_b32 s49, v32
  s_sub_u32 s90, s90, 1
  s_cbranch_scc1 WD_91
  s_cmp_ge_u32 s49, 21
  s_cbranch_scc0 W_90
WD_91:
  s_setprio 2
  s_mul_i32 s49, s9, 114688
  s_add_u32 s49, s49, s88
  s_add_u32 s49, s49, 802816
  s_mov_b32 m0, 131072
  s_waitcnt vmcnt(28)
  buffer_load_dwordx4 v12, s[36:39], s49 offen offset:0 lds
  buffer_load_dwordx4 v13, s[36:39], s49 offen offset:1024 lds
  buffer_load_dwordx4 v14, s[36:39], s49 offen offset:2048 lds
  buffer_load_dwordx4 v15, s[36:39], s49 offen offset:3072 lds
  s_add_u32 s49, s49, 28672
  s_mov_b32 m0, 135168
  s_waitcnt vmcnt(28)
  v_mov_b32 v3, 51
  ds_write_b32 v7, v3
  buffer_load_dwordx4 v12, s[36:39], s49 offen offset:0 lds
  buffer_load_dwordx4 v13, s[36:39], s49 offen offset:1024 lds
  buffer_load_dwordx4 v14, s[36:39], s49 offen offset:2048 lds
  buffer_load_dwordx4 v15, s[36:39], s49 offen offset:3072 lds
  s_setprio 0
W_92:
  ds_read_b128 v[32:35], v2 offset:0
  s_waitcnt lgkmcnt(0)
  v_min_u32 v34, v34, v35
  s_nop 0
  v_readfirstlane_b32 s49, v34
  s_sub_u32 s90, s90, 1
  s_cbranch_scc1 WD_93
  s_cmp_ge_u32 s49, 21
  s_cbranch_scc0 W_92
WD_93:
  s_setprio 2
  s_mul_i32 s49, s8, 114688
  s_add_u32 s49, s49, s88
  s_add_u32 s49, s49, 57344
  s_add_u32 s8, s8, s10
  s_cmp_ge_u32 s8, 7
  s_cselect_b32 s50, 7, 0
  s_sub_u32 s8, s8, s50
  s_mov_b32 m0, 139264
  s_waitcnt vmcnt(28)
  buffer_load_dwordx4 v12, s[36:39], s49 offen offset:0 lds
  buffer_load_dwordx4 v13, s[36:39], s49 offen offset:1024 lds
  buffer_load_dwordx4 v14, s[36:39], s49 offen offset:2048 lds
  buffer_load_dwordx4 v15, s[36:39], s49 offen offset:3072 lds
  s_add_u32 s49, s49, 28672
  s_mov_b32 m0, 143360
  s_waitcnt vmcnt(28)
  v_mov_b32 v3, 52
  ds_write_b32 v7, v3
  buffer_load_dwordx4 v12, s[36:39], s49 offen offset:0 lds
  buffer_load_dwordx4 v13, s[36:39], s49 offen offset:1024 lds
  buffer_load_dwordx4 v14, s[36:39], s49 offen offset:2048 lds
  buffer_load_dwordx4 v15, s[36:39], s49 offen offset:3072 lds
  s_setprio 0
W_94:
  ds_read_b128 v[32:35], v2 offset:0
  s_waitcnt lgkmcnt(0)
  v_min_u32 v32, v32, v33
  s_nop 0
  v_readfirstlane_b32 s49, v32
  s_sub_u32 s90, s90, 1
  s_cbranch_scc1 WD_95
  s_cmp_ge_u32 s49, 22
  s_cbranch_scc0 W_94
WD_95:
  s_setprio 2
  s_mul_i32 s49, s9, 114688
  s_add_u32 s49, s49, s88
  s_add_u32 s49, s49, 860160
  s_add_u32 s9, s9, s10
  s_cmp_ge_u32 s9, 7
  s_cselect_b32 s50, 7, 0
  s_sub_u32 s9, s9, s50
  s_mov_b32 m0, 147456
  s_waitcnt vmcnt(28)
  buffer_load_dwordx4 v12, s[36:39], s49 offen offset:0 lds
  buffer_load_dwordx4 v13, s[36:39], s49 offen offset:1024 lds
  buffer_load_dwordx4 v14, s[36:39], s49 offen offset:2048 lds
  buffer_load_dwordx4 v15, s[36:39], s49 offen offset:3072 lds
  s_add_u32 s49, s49, 28672
  s_mov_b32 m0, 151552
  s_waitcnt vmcnt(28)
  v_mov_b32 v3, 53
  ds_write_b32 v7, v3
  buffer_load_dwordx4 v12, s[36:39], s49 offen offset:0 lds
  buffer_load_dwordx4 v13, s[36:39], s49 offen offset:1024 lds
  buffer_load_dwordx4 v14, s[36:39], s49 offen offset:2048 lds
  buffer_load_dwordx4 v15, s[36:39], s49 offen offset:3072 lds
  s_waitcnt vmcnt(24)
  v_mov_b32 v3, 54
  ds_write_b32 v7, v3
  s_waitcnt vmcnt(16)
  v_mov_b32 v3, 55
  ds_write_b32 v7, v3
  s_waitcnt vmcnt(8)
  v_mov_b32 v3, 56
  ds_write_b32 v7, v3
  s_waitcnt vmcnt(0)
  v_mov_b32 v3, 57
  ds_write_b32 v7, v3
LEND_17:
  s_waitcnt lgkmcnt(0)
  s_endpgm
H1_4:
  s_nop 4
  s_setprio 2
  s_add_u32 s82, s80, 16818176
  s_addc_u32 s83, s81, 0
  s_load_dword s53, s[82:83], 0
  s_mov_b32 s20, s68
  s_and_b32 s21, s69, 0xffff
  s_mov_b32 s22, 0x6200
  s_mov_b32 s23, 0x20000
  s_mul_i32 s96, s55, 37
  s_lshr_b32 s96, s96, 8
  s_mul_i32 s97, s96, 7
  s_sub_u32 s97, s55, s97
  s_lshr_b32 s98, s96, 1
  s_mul_i32 s99, s98, 14
  s_sub_u32 s99, s55, s99
  s_lshl2_add_u32 s96, s3, s96
  s_lshl1_add_u32 s98, s3, s98
  v_lshlrev_b32 v5, 4, v1
  s_mov_b32 s54, 0
  s_mov_b32 s51, 0x3f803f80
  s_mov_b32 s28, s70
  s_and_b32 s29, s71, 0xffff
  s_mov_b32 s30, 0x62000
  s_mov_b32 s31, 0x20000
  s_mov_b32 s32, s74
  s_and_b32 s33, s75, 0xffff
  s_mov_b32 s34, 0x188000
  s_mov_b32 s35, 0x20000
  s_mov_b32 s36, s76
  s_and_b32 s37, s77, 0xffff
  s_mov_b32 s38, 0x188000
  s_mov_b32 s39, 0x20000
  s_mov_b32 s40, s78
  s_and_b32 s41, s79, 0xffff
  s_mov_b32 s42, 0x1c0000
  s_mov_b32 s43, 0x20000
  s_mov_b32 s24, s80
  s_and_b32 s25, s81, 0xffff
  s_mov_b32 s26, 0x1200000
  s_mov_b32 s27, 0x20000
  v_lshrrev_b32 v4, 5, v1
  v_bfe_u32 v3, v1, 2, 2
  v_lshl_add_u32 v3, v4, 3, v3
  v_lshlrev_b32 v3, 6, v3
  v_bfe_u32 v8, v1, 4, 1
  v_lshl_add_u32 v3, v8, 5, v3
  v_and_b32 v8, 3, v1
  v_lshl_add_u32 v3, v8, 3, v3
  v_add_u32 v16, 114688, v3
  v_add_u32 v17, 0, v3
  v_add_u32 v18, 32768, v3
  v_lshlrev_b32 v36, 3, v1
  v_add_u32 v36, 159744, v36
  s_waitcnt lgkmcnt(0)
  s_mul_i32 s53, s53, 0x19660d
  s_add_u32 s53, s53, 0x3c6ef35f
  v_mov_b32 v6, s53
  s_mov_b32 s100, 1
  v_lshrrev_b32 v20, 4, v1
  v_mul_u32_u24 v20, 3584, v20
  v_and_b32 v4, 15, v1
  v_lshrrev_b32 v3, 2, v1
  v_and_b32 v3, 12, v3
  v_xor_b32 v4, v4, v3
  v_lshl_add_u32 v20, v4, 4, v20
  v_add_u32 v21, 13312, v20
  v_add_u32 v22, 26624, v20
  v_add_u32 v23, 39936, v20
  s_and_b32 s89, s98, 1
  s_mul_i32 s89, s89, 3
  s_add_u32 s89, s89, s3
  s_lshr_b32 s49, s99, 1
  s_add_u32 s89, s89, s49
  s_mul_i32 s49, s89, 37
  s_lshr_b32 s49, s49, 8
  s_mul_i32 s49, s49, 7
  s_sub_u32 s89, s89, s49
CSL_96:
  v_mov_b32 v40, 0
  v_mov_b32 v41, 0
  s_cmp_eq_u32 s100, 1
  s_cselect_b32 s49, 0, 32768
  s_cmp_eq_u32 s100, 0
  s_cselect_b32 s49, 114688, s49
  v_add_u32 v44, s49, v17
  s_mul_i32 s52, s100, 7
  s_add_u32 s50, s52, 7
CS_98:
  s_cmp_gt_u32 s48, s52
  s_cbranch_scc1 WD_100
  s_setprio 0
W_99:
  ds_read_b32 v32, v2 offset:16
  s_waitcnt lgkmcnt(0)
  v_readfirstlane_b32 s48, v32
  s_sub_u32 s90, s90, 1
  s_cbranch_scc1 WD_100
  s_cmp_gt_u32 s48, s52
  s_cbranch_scc0 W_99
  s_setprio 2
WD_100:
  ds_read_b64_tr_b16 v[48:49], v44 offset:0
  ds_read_b64_tr_b16 v[50:51], v44 offset:256
  ds_read_b64_tr_b16 v[52:53], v44 offset:1024
  ds_read_b64_tr_b16 v[54:55], v44 offset:1280
  ds_read_b64_tr_b16 v[56:57], v44 offset:2048
  ds_read_b64_tr_b16 v[58:59], v44 offset:2304
  ds_read_b64_tr_b16 v[60:61], v44 offset:3072
  ds_read_b64_tr_b16 v[62:63], v44 offset:3328
  ds_read_b32 v32, v2 offset:16
  v_add_u32 v44, 4096, v44
  s_add_u32 s52, s52, 1
  s_waitcnt lgkmcnt(7)
  v_dot2c_f32_bf16 v40, s51, v48
  v_dot2c_f32_bf16 v41, s51, v49
  v_dot2c_f32_bf16 v40, s51, v50
  v_dot2c_f32_bf16 v41, s51, v51
  s_waitcnt lgkmcnt(5)
  v_dot2c_f32_bf16 v40, s51, v52
  v_dot2c_f32_bf16 v41, s51, v53
  v_dot2c_f32_bf16 v40, s51, v54
  v_dot2c_f32_bf16 v41, s51, v55
  s_waitcnt lgkmcnt(3)
  v_dot2c_f32_bf16 v40, s51, v56
  v_dot2c_f32_bf16 v41, s51, v57
  v_dot2c_f32_bf16 v40, s51, v58
  v_dot2c_f32_bf16 v41, s51, v59
  s_waitcnt lgkmcnt(1)
  v_dot2c_f32_bf16 v40, s51, v60
  v_dot2c_f32_bf16 v41, s51, v61
  v_dot2c_f32_bf16 v40, s51, v62
  v_dot2c_f32_bf16 v41, s51, v63
  s_waitcnt lgkmcnt(0)
  v_readfirstlane_b32 s48, v32
  s_cmp_lt_u32 s52, s50
  s_cbranch_scc1 CS_98
  v_add_f32 v40, v40, v41
  v_cvt_pk_bf16_f32 v42, v40, v40
  v_and_b32 v3, 0xffff0000, v42
  v_sub_f32 v3, v40, v3
  v_cvt_pk_bf16_f32 v43, v3, 0
  s_lshl_b32 s49, s100, 9
  v_add_u32 v44, s49, v36
  ds_write_b64 v44, v[42:43]
  s_add_u32 s49, s100, 7
  v_mov_b32 v3, s49
  ds_write_b32 v7, v3
  s_add_u32 s100, s100, 1
  s_cmp_eq_u32 s100, 3
  s_cbranch_scc1 CSM_97
  s_cmp_ge_u32 s55, 28
  s_cbranch_scc1 CSL_96
  s_branch CSL_96
CSM_97:
  s_mul_i32 s49, s55, 1408
  v_lshlrev_b32 v3, 7, v1
  v_add_u32 v3, s49, v3
  s_mov_b64 exec, 0x7ff
  global_load_dword v63, v3, s[94:95]
  s_mov_b64 exec, -1
  s_cmp_lt_u32 s55, 28
  s_cbranch_scc1 NF_101
  v_lshlrev_b32 v4, 7, v1
  s_mov_b64 exec, 0xf
  s_lshl_b32 s49, s3, 9
  s_add_u32 s49, s49, 16781312
  buffer_load_dword v63, v4, s[24:27], s49 offen sc1
  s_mov_b64 exec, 0xf
  s_lshl_b32 s49, s3, 9
  s_add_u32 s49, s49, 16789504
  buffer_load_dword v63, v4, s[24:27], s49 offen sc1
  s_mov_b64 exec, 0xff
  s_lshl_b32 s49, s3, 10
  s_add_u32 s49, s49, 17235968
  buffer_load_dword v63, v4, s[24:27], s49 offen sc1
  s_mov_b64 exec, 0xff
  s_mov_b64 exec, -1
NF_101:
  s_lshl_b32 s49, s3, 18
  s_lshl_b32 s50, s55, 13
  s_add_u32 s49, s49, s50
  v_lshlrev_b32 v4, 7, v1
  s_add_u32 s50, s49, 2097152
  buffer_load_dword v63, v4, s[24:27], s50 offen sc1
  s_cmp_ge_u32 s55, 28
  s_cbranch_scc1 LEND_102
  s_lshl_b32 s88, s98, 17
  s_add_u32 s88, s88, 4194304
  s_and_b32 s100, s98, 1
  s_mul_i32 s100, s100, 3
  s_add_u32 s100, s100, s3
  s_lshr_b32 s49, s99, 1
  s_add_u32 s100, s100, s49
  s_mul_i32 s49, s100, 37
  s_lshr_b32 s49, s49, 8
  s_mul_i32 s49, s49, 7
  s_sub_u32 s100, s100, s49
  s_add_u32 s4, s100, 0
  s_cmp_ge_u32 s4, 7
  s_cselect_b32 s50, 7, 0
  s_sub_u32 s4, s4, s50
  s_lshl_b32 s4, s4, 12
  s_add_u32 s4, s4, s88
  s_add_u32 s4, s4, 4096
  s_add_u32 s5, s100, 1
  s_cmp_ge_u32 s5, 7
  s_cselect_b32 s50, 7, 0
  s_sub_u32 s5, s5, s50
  s_lshl_b32 s5, s5, 12
  s_add_u32 s5, s5, s88
  s_add_u32 s5, s5, 4096
  s_add_u32 s6, s100, 2
  s_cmp_ge_u32 s6, 7
  s_cselect_b32 s50, 7, 0
  s_sub_u32 s6, s6, s50
  s_lshl_b32 s6, s6, 12
  s_add_u32 s6, s6, s88
  s_add_u32 s6, s6, 4096
  s_add_u32 s7, s100, 3
  s_cmp_ge_u32 s7, 7
  s_cselect_b32 s50, 7, 0
  s_sub_u32 s7, s7, s50
  s_lshl_b32 s7, s7, 12
  s_add_u32 s7, s7, s88
  s_add_u32 s7, s7, 4096
  s_add_u32 s8, s100, 4
  s_cmp_ge_u32 s8, 7
  s_cselect_b32 s50, 7, 0
  s_sub_u32 s8, s8, s50
  s_lshl_b32 s8, s8, 12
  s_add_u32 s8, s8, s88
  s_add_u32 s8, s8, 4096
  s_add_u32 s9, s100, 5
  s_cmp_ge_u32 s9, 7
  s_cselect_b32 s50, 7, 0
  s_sub_u32 s9, s9, s50
  s_lshl_b32 s9, s9, 12
  s_add_u32 s9, s9, s88
  s_add_u32 s9, s9, 4096
  s_add_u32 s10, s100, 6
  s_cmp_ge_u32 s10, 7
  s_cselect_b32 s50, 7, 0
  s_sub_u32 s10, s10, s50
  s_lshl_b32 s10, s10, 12
  s_add_u32 s10, s10, s88
  s_add_u32 s10, s10, 4096
  s_lshl_b32 s50, s98, 8
  s_add_u32 s50, s50, 16789504
  v_lshlrev_b32 v4, 2, v1
  s_and_b32 s52, s99, 1
  s_lshl_b32 s52, s52, 16
  s_bitcmp1_b32 s99, 0
  s_cselect_b32 s92, 0, 0x3fff3fff
  s_cselect_b32 s93, 0x3fff3fff, 0
  v_mov_b32 v41, v4
  s_mov_b32 s91, s50
  s_setprio 0
W_103:
  ds_read_b128 v[32:35], v2 offset:0
  s_waitcnt lgkmcnt(0)
  v_min3_u32 v32, v32, v33, v34
  v_min_u32 v32, v32, v35
  s_nop 0
  v_readfirstlane_b32 s49, v32
  s_sub_u32 s90, s90, 1
  s_cbranch_scc1 WD_104
  s_cmp_ge_u32 s49, 11
  s_cbranch_scc0 ZZ_105
WD_104:
  s_setprio 2
P_107:
  buffer_load_dword v42, v41, s[24:27], s91 offen sc1
  s_waitcnt vmcnt(0)
  v_cmp_ne_u32 vcc, s53, v42
  s_sub_u32 s90, s90, 1
  s_cbranch_scc1 PD_106
  s_and_b64 vcc, vcc, s[92:93]
  s_cbranch_scc1 P_107
PD_106:
  s_add_u32 s49, s4, s52
  s_mov_b32 m0, 98304
  s_nop 0
  buffer_load_dwordx4 v5, s[24:27], s49 offen offset:0 sc1 lds
  buffer_load_dwordx4 v5, s[24:27], s49 offen offset:1024 sc1 lds
  buffer_load_dwordx4 v5, s[24:27], s49 offen offset:2048 sc1 lds
  buffer_load_dwordx4 v5, s[24:27], s49 offen offset:3072 sc1 lds
  s_add_u32 s49, s5, s52
  s_mov_b32 m0, 102400
  s_nop 0
  buffer_load_dwordx4 v5, s[24:27], s49 offen offset:0 sc1 lds
  buffer_load_dwordx4 v5, s[24:27], s49 offen offset:1024 sc1 lds
  buffer_load_dwordx4 v5, s[24:27], s49 offen offset:2048 sc1 lds
  buffer_load_dwordx4 v5, s[24:27], s49 offen offset:3072 sc1 lds
  s_add_u32 s49, s6, s52
  s_mov_b32 m0, 106496
  s_nop 0
  buffer_load_dwordx4 v5, s[24:27], s49 offen offset:0 sc1 lds
  buffer_load_dwordx4 v5, s[24:27], s49 offen offset:1024 sc1 lds
  buffer_load_dwordx4 v5, s[24:27], s49 offen offset:2048 sc1 lds
  buffer_load_dwordx4 v5, s[24:27], s49 offen offset:3072 sc1 lds
  s_add_u32 s49, s7, s52
  s_mov_b32 m0, 110592
  s_nop 0
  buffer_load_dwordx4 v5, s[24:27], s49 offen offset:0 sc1 lds
  buffer_load_dwordx4 v5, s[24:27], s49 offen offset:1024 sc1 lds
  buffer_load_dwordx4 v5, s[24:27], s49 offen offset:2048 sc1 lds
  buffer_load_dwordx4 v5, s[24:27], s49 offen offset:3072 sc1 lds
  s_add_u32 s49, s88, s52
  s_mov_b32 m0, 49152
  s_nop 0
  buffer_load_dwordx4 v5, s[24:27], s49 offen offset:0 sc1 lds
  buffer_load_dwordx4 v5, s[24:27], s49 offen offset:1024 sc1 lds
  buffer_load_dwordx4 v5, s[24:27], s49 offen offset:2048 sc1 lds
  buffer_load_dwordx4 v5, s[24:27], s49 offen offset:3072 sc1 lds
  s_add_u32 s49, s8, s52
  s_mov_b32 m0, 114688
  s_nop 0
  buffer_load_dwordx4 v5, s[24:27], s49 offen offset:0 sc1 lds
  buffer_load_dwordx4 v5, s[24:27], s49 offen offset:1024 sc1 lds
  buffer_load_dwordx4 v5, s[24:27], s49 offen offset:2048 sc1 lds
  buffer_load_dwordx4 v5, s[24:27], s49 offen offset:3072 sc1 lds
  s_add_u32 s49, s9, s52
  s_mov_b32 m0, 118784
  s_waitcnt vmcnt(20)
  buffer_load_dwordx4 v5, s[24:27], s49 offen offset:0 sc1 lds
  buffer_load_dwordx4 v5, s[24:27], s49 offen offset:1024 sc1 lds
  buffer_load_dwordx4 v5, s[24:27], s49 offen offset:2048 sc1 lds
  buffer_load_dwordx4 v5, s[24:27], s49 offen offset:3072 sc1 lds
  s_add_u32 s49, s10, s52
  s_mov_b32 m0, 122880
  s_waitcnt vmcnt(20)
  v_mov_b32 v3, 10
  ds_write_b32 v7, v3
  buffer_load_dwordx4 v5, s[24:27], s49 offen offset:0 sc1 lds
  buffer_load_dwordx4 v5, s[24:27], s49 offen offset:1024 sc1 lds
  buffer_load_dwordx4 v5, s[24:27], s49 offen offset:2048 sc1 lds
  buffer_load_dwordx4 v5, s[24:27], s49 offen offset:3072 sc1 lds
  s_waitcnt vmcnt(23)
  buffer_load_dword v42, v41, s[24:27], s91 offen sc1
  s_mov_b32 s92, 0x3fff3fff
  s_mov_b32 s93, 0x3fff3fff
  s_xor_b32 s52, s52, 32768
  s_add_u32 s49, s4, s52
  s_mov_b32 m0, 126976
  s_waitcnt vmcnt(20)
  buffer_load_dwordx4 v5, s[24:27], s49 offen offset:0 sc1 lds
  buffer_load_dwordx4 v5, s[24:27], s49 offen offset:1024 sc1 lds
  buffer_load_dwordx4 v5, s[24:27], s49 offen offset:2048 sc1 lds
  buffer_load_dwordx4 v5, s[24:27], s49 offen offset:3072 sc1 lds
  s_add_u32 s49, s88, s52
  s_mov_b32 m0, 53248
  s_waitcnt vmcnt(20)
  v_mov_b32 v3, 11
  ds_write_b32 v7, v3
  buffer_load_dwordx4 v5, s[24:27], s49 offen offset:0 sc1 lds
  buffer_load_dwordx4 v5, s[24:27], s49 offen offset:1024 sc1 lds
  buffer_load_dwordx4 v5, s[24:27], s49 offen offset:2048 sc1 lds
  buffer_load_dwordx4 v5, s[24:27], s49 offen offset:3072 sc1 lds
  s_add_u32 s49, s5, s52
  s_mov_b32 m0, 131072
  s_waitcnt vmcnt(20)
  v_mov_b32 v3, 12
  ds_write_b32 v7, v3
  buffer_load_dwordx4 v5, s[24:27], s49 offen offset:0 sc1 lds
  buffer_load_dwordx4 v5, s[24:27], s49 offen offset:1024 sc1 lds
  buffer_load_dwordx4 v5, s[24:27], s49 offen offset:2048 sc1 lds
  buffer_load_dwordx4 v5, s[24:27], s49 offen offset:3072 sc1 lds
  s_add_u32 s49, s6, s52
  s_mov_b32 m0, 135168
  s_waitcnt vmcnt(20)
  buffer_load_dwordx4 v5, s[24:27], s49 offen offset:0 sc1 lds
  buffer_load_dwordx4 v5, s[24:27], s49 offen offset:1024 sc1 lds
  buffer_load_dwordx4 v5, s[24:27], s49 offen offset:2048 sc1 lds
  buffer_load_dwordx4 v5, s[24:27], s49 offen offset:3072 sc1 lds
  s_add_u32 s49, s7, s52
  s_mov_b32 m0, 139264
  s_waitcnt vmcnt(20)
  v_mov_b32 v3, 13
  ds_write_b32 v7, v3
  buffer_load_dwordx4 v5, s[24:27], s49 offen offset:0 sc1 lds
  buffer_load_dwordx4 v5, s[24:27], s49 offen offset:1024 sc1 lds
  buffer_load_dwordx4 v5, s[24:27], s49 offen offset:2048 sc1 lds
  buffer_load_dwordx4 v5, s[24:27], s49 offen offset:3072 sc1 lds
  s_add_u32 s49, s8, s52
  s_mov_b32 m0, 143360
  s_waitcnt vmcnt(20)
  v_mov_b32 v3, 14
  ds_write_b32 v7, v3
  buffer_load_dwordx4 v5, s[24:27], s49 offen offset:0 sc1 lds
  buffer_load_dwordx4 v5, s[24:27], s49 offen offset:1024 sc1 lds
  buffer_load_dwordx4 v5, s[24:27], s49 offen offset:2048 sc1 lds
  buffer_load_dwordx4 v5, s[24:27], s49 offen offset:3072 sc1 lds
  s_add_u32 s49, s9, s52
  s_mov_b32 m0, 147456
  s_waitcnt vmcnt(20)
  buffer_load_dwordx4 v5, s[24:27], s49 offen offset:0 sc1 lds
  buffer_load_dwordx4 v5, s[24:27], s49 offen offset:1024 sc1 lds
  buffer_load_dwordx4 v5, s[24:27], s49 offen offset:2048 sc1 lds
  buffer_load_dwordx4 v5, s[24:27], s49 offen offset:3072 sc1 lds
  s_add_u32 s49, s10, s52
  s_mov_b32 m0, 151552
  s_waitcnt vmcnt(20)
  v_mov_b32 v3, 15
  ds_write_b32 v7, v3
  buffer_load_dwordx4 v5, s[24:27], s49 offen offset:0 sc1 lds
  buffer_load_dwordx4 v5, s[24:27], s49 offen offset:1024 sc1 lds
  buffer_load_dwordx4 v5, s[24:27], s49 offen offset:2048 sc1 lds
  buffer_load_dwordx4 v5, s[24:27], s49 offen offset:3072 sc1 lds
  s_setprio 0
W_108:
  ds_read_b128 v[32:35], v2 offset:0
  s_waitcnt lgkmcnt(0)
  v_min3_u32 v32, v32, v33, v34
  v_min_u32 v32, v32, v35
  s_nop 0
  v_readfirstlane_b32 s49, v32
  s_sub_u32 s90, s90, 1
  s_cbranch_scc1 WD_109
  s_cmp_ge_u32 s49, 12
  s_cbranch_scc0 W_108
WD_109:
  s_setprio 2
  v_cmp_ne_u32 vcc, s53, v42
  s_and_b64 vcc, vcc, s[92:93]
  s_cbranch_scc1 CE_110
CB_111:
  s_xor_b32 s52, s52, 98304
  s_add_u32 s49, s4, s52
  s_mov_b32 m0, 0
  s_waitcnt vmcnt(20)
  v_mov_b32 v3, 16
  ds_write_b32 v7, v3
  buffer_load_dwordx4 v5, s[24:27], s49 offen offset:0 sc1 lds
  buffer_load_dwordx4 v5, s[24:27], s49 offen offset:1024 sc1 lds
  buffer_load_dwordx4 v5, s[24:27], s49 offen offset:2048 sc1 lds
  buffer_load_dwordx4 v5, s[24:27], s49 offen offset:3072 sc1 lds
  s_add_u32 s49, s88, s52
  s_mov_b32 m0, 57344
  s_waitcnt vmcnt(20)
  buffer_load_dwordx4 v5, s[24:27], s49 offen offset:0 sc1 lds
  buffer_load_dwordx4 v5, s[24:27], s49 offen offset:1024 sc1 lds
  buffer_load_dwordx4 v5, s[24:27], s49 offen offset:2048 sc1 lds
  buffer_load_dwordx4 v5, s[24:27], s49 offen offset:3072 sc1 lds
  s_add_u32 s49, s5, s52
  s_mov_b32 m0, 4096
  s_waitcnt vmcnt(20)
  v_mov_b32 v3, 17
  ds_write_b32 v7, v3
  buffer_load_dwordx4 v5, s[24:27], s49 offen offset:0 sc1 lds
  buffer_load_dwordx4 v5, s[24:27], s49 offen offset:1024 sc1 lds
  buffer_load_dwordx4 v5, s[24:27], s49 offen offset:2048 sc1 lds
  buffer_load_dwordx4 v5, s[24:27], s49 offen offset:3072 sc1 lds
  s_add_u32 s49, s6, s52
  s_mov_b32 m0, 8192
  s_waitcnt vmcnt(20)
  buffer_load_dwordx4 v5, s[24:27], s49 offen offset:0 sc1 lds
  buffer_load_dwordx4 v5, s[24:27], s49 offen offset:1024 sc1 lds
  buffer_load_dwordx4 v5, s[24:27], s49 offen offset:2048 sc1 lds
  buffer_load_dwordx4 v5, s[24:27], s49 offen offset:3072 sc1 lds
  s_add_u32 s49, s7, s52
  s_mov_b32 m0, 12288
  s_waitcnt vmcnt(20)
  buffer_load_dwordx4 v5, s[24:27], s49 offen offset:0 sc1 lds
  buffer_load_dwordx4 v5, s[24:27], s49 offen offset:1024 sc1 lds
  buffer_load_dwordx4 v5, s[24:27], s49 offen offset:2048 sc1 lds
  buffer_load_dwordx4 v5, s[24:27], s49 offen offset:3072 sc1 lds
  s_add_u32 s49, s8, s52
  s_mov_b32 m0, 16384
  s_waitcnt vmcnt(20)
  v_mov_b32 v3, 18
  ds_write_b32 v7, v3
  buffer_load_dwordx4 v5, s[24:27], s49 offen offset:0 sc1 lds
  buffer_load_dwordx4 v5, s[24:27], s49 offen offset:1024 sc1 lds
  buffer_load_dwordx4 v5, s[24:27], s49 offen offset:2048 sc1 lds
  buffer_load_dwordx4 v5, s[24:27], s49 offen offset:3072 sc1 lds
  s_add_u32 s49, s9, s52
  s_mov_b32 m0, 20480
  s_waitcnt vmcnt(20)
  buffer_load_dwordx4 v5, s[24:27], s49 offen offset:0 sc1 lds
  buffer_load_dwordx4 v5, s[24:27], s49 offen offset:1024 sc1 lds
  buffer_load_dwordx4 v5, s[24:27], s49 offen offset:2048 sc1 lds
  buffer_load_dwordx4 v5, s[24:27], s49 offen offset:3072 sc1 lds
  s_add_u32 s49, s10, s52
  s_mov_b32 m0, 24576
  s_waitcnt vmcnt(20)
  v_mov_b32 v3, 19
  ds_write_b32 v7, v3
  buffer_load_dwordx4 v5, s[24:27], s49 offen offset:0 sc1 lds
  buffer_load_dwordx4 v5, s[24:27], s49 offen offset:1024 sc1 lds
  buffer_load_dwordx4 v5, s[24:27], s49 offen offset:2048 sc1 lds
  buffer_load_dwordx4 v5, s[24:27], s49 offen offset:3072 sc1 lds
  s_xor_b32 s52, s52, 32768
  s_add_u32 s49, s4, s52
  s_mov_b32 m0, 65536
  s_waitcnt vmcnt(20)
  v_mov_b32 v3, 20
  ds_write_b32 v7, v3
  buffer_load_dwordx4 v5, s[24:27], s49 offen offset:0 sc1 lds
  buffer_load_dwordx4 v5, s[24:27], s49 offen offset:1024 sc1 lds
  buffer_load_dwordx4 v5, s[24:27], s49 offen offset:2048 sc1 lds
  buffer_load_dwordx4 v5, s[24:27], s49 offen offset:3072 sc1 lds
  s_add_u32 s49, s88, s52
  s_mov_b32 m0, 61440
  s_waitcnt vmcnt(20)
  buffer_load_dwordx4 v5, s[24:27], s49 offen offset:0 sc1 lds
  buffer_load_dwordx4 v5, s[24:27], s49 offen offset:1024 sc1 lds
  buffer_load_dwordx4 v5, s[24:27], s49 offen offset:2048 sc1 lds
  buffer_load_dwordx4 v5, s[24:27], s49 offen offset:3072 sc1 lds
  s_add_u32 s49, s5, s52
  s_mov_b32 m0, 69632
  s_waitcnt vmcnt(20)
  v_mov_b32 v3, 21
  ds_write_b32 v7, v3
  buffer_load_dwordx4 v5, s[24:27], s49 offen offset:0 sc1 lds
  buffer_load_dwordx4 v5, s[24:27], s49 offen offset:1024 sc1 lds
  buffer_load_dwordx4 v5, s[24:27], s49 offen offset:2048 sc1 lds
  buffer_load_dwordx4 v5, s[24:27], s49 offen offset:3072 sc1 lds
  s_add_u32 s49, s6, s52
  s_mov_b32 m0, 73728
  s_waitcnt vmcnt(20)
  buffer_load_dwordx4 v5, s[24:27], s49 offen offset:0 sc1 lds
  buffer_load_dwordx4 v5, s[24:27], s49 offen offset:1024 sc1 lds
  buffer_load_dwordx4 v5, s[24:27], s49 offen offset:2048 sc1 lds
  buffer_load_dwordx4 v5, s[24:27], s49 offen offset:3072 sc1 lds
  s_add_u32 s49, s7, s52
  s_mov_b32 m0, 77824
  s_waitcnt vmcnt(20)
  buffer_load_dwordx4 v5, s[24:27], s49 offen offset:0 sc1 lds
  buffer_load_dwordx4 v5, s[24:27], s49 offen offset:1024 sc1 lds
  buffer_load_dwordx4 v5, s[24:27], s49 offen offset:2048 sc1 lds
  buffer_load_dwordx4 v5, s[24:27], s49 offen offset:3072 sc1 lds
  s_add_u32 s49, s8, s52
  s_mov_b32 m0, 81920
  s_waitcnt vmcnt(20)
  v_mov_b32 v3, 22
  ds_write_b32 v7, v3
  buffer_load_dwordx4 v5, s[24:27], s49 offen offset:0 sc1 lds
  buffer_load_dwordx4 v5, s[24:27], s49 offen offset:1024 sc1 lds
  buffer_load_dwordx4 v5, s[24:27], s49 offen offset:2048 sc1 lds
  buffer_load_dwordx4 v5, s[24:27], s49 offen offset:3072 sc1 lds
  s_add_u32 s49, s9, s52
  s_mov_b32 m0, 86016
  s_waitcnt vmcnt(20)
  buffer_load_dwordx4 v5, s[24:27], s49 offen offset:0 sc1 lds
  buffer_load_dwordx4 v5, s[24:27], s49 offen offset:1024 sc1 lds
  buffer_load_dwordx4 v5, s[24:27], s49 offen offset:2048 sc1 lds
  buffer_load_dwordx4 v5, s[24:27], s49 offen offset:3072 sc1 lds
  s_add_u32 s49, s10, s52
  s_mov_b32 m0, 90112
  s_waitcnt vmcnt(20)
  v_mov_b32 v3, 23
  ds_write_b32 v7, v3
  buffer_load_dwordx4 v5, s[24:27], s49 offen offset:0 sc1 lds
  buffer_load_dwordx4 v5, s[24:27], s49 offen offset:1024 sc1 lds
  buffer_load_dwordx4 v5, s[24:27], s49 offen offset:2048 sc1 lds
  buffer_load_dwordx4 v5, s[24:27], s49 offen offset:3072 sc1 lds
  s_waitcnt vmcnt(20)
  v_mov_b32 v3, 24
  ds_write_b32 v7, v3
  s_waitcnt vmcnt(12)
  v_mov_b32 v3, 25
  ds_write_b32 v7, v3
  s_waitcnt vmcnt(0)
  v_mov_b32 v3, 26
  ds_write_b32 v7, v3
LEND_102:
  s_waitcnt lgkmcnt(0)
  s_endpgm
H23_5:
  s_nop 4
  s_setprio 2
  s_add_u32 s82, s80, 16818176
  s_addc_u32 s83, s81, 0
  s_load_dword s53, s[82:83], 0
  s_mov_b32 s20, s68
  s_and_b32 s21, s69, 0xffff
  s_mov_b32 s22, 0x6200
  s_mov_b32 s23, 0x20000
  s_mul_i32 s96, s55, 37
  s_lshr_b32 s96, s96, 8
  s_mul_i32 s97, s96, 7
  s_sub_u32 s97, s55, s97
  s_lshr_b32 s98, s96, 1
  s_mul_i32 s99, s98, 14
  s_sub_u32 s99, s55, s99
  s_lshl2_add_u32 s96, s3, s96
  s_lshl1_add_u32 s98, s3, s98
  v_lshlrev_b32 v5, 4, v1
  s_mov_b32 s54, 0
  s_mov_b32 s51, 0x3f803f80
  s_mov_b32 s28, s70
  s_and_b32 s29, s71, 0xffff
  s_mov_b32 s30, 0x62000
  s_mov_b32 s31, 0x20000
  s_mov_b32 s32, s74
  s_and_b32 s33, s75, 0xffff
  s_mov_b32 s34, 0x188000
  s_mov_b32 s35, 0x20000
  s_mov_b32 s36, s76
  s_and_b32 s37, s77, 0xffff
  s_mov_b32 s38, 0x188000
  s_mov_b32 s39, 0x20000
  s_mov_b32 s40, s78
  s_and_b32 s41, s79, 0xffff
  s_mov_b32 s42, 0x1c0000
  s_mov_b32 s43, 0x20000
  s_mov_b32 s24, s80
  s_and_b32 s25, s81, 0xffff
  s_mov_b32 s26, 0x1200000
  s_mov_b32 s27, 0x20000
  s_sub_u32 s101, s46, 5
  s_cmp_eq_u32 s101, 1
  s_cbranch_scc1 NOST_113
  s_mul_i32 s49, s45, 1568
  s_mov_b32 m0, 161280
  s_nop 0
  buffer_load_dwordx4 v5, s[20:23], s49 offen lds
  buffer_load_dwordx4 v5, s[20:23], s49 offen offset:1024 lds
NOST_113:
  v_lshrrev_b32 v4, 5, v1
  v_bfe_u32 v3, v1, 2, 2
  v_lshl_add_u32 v3, v4, 3, v3
  v_lshlrev_b32 v3, 6, v3
  v_bfe_u32 v8, v1, 4, 1
  v_lshl_add_u32 v3, v8, 5, v3
  v_and_b32 v8, 3, v1
  v_lshl_add_u32 v3, v8, 3, v3
  v_add_u32 v16, 114688, v3
  v_add_u32 v17, 0, v3
  v_add_u32 v18, 32768, v3
  v_lshlrev_b32 v36, 3, v1
  v_add_u32 v36, 159744, v36
  v_lshrrev_b32 v4, 5, v1
  v_and_b32 v3, 31, v1
  v_lshlrev_b32 v8, 2, v4
  v_sub_u32 v3, v3, v8
  v_mov_b32 v8, 0x3f80
  v_mov_b32 v9, 0x3f800000
  v_cmp_eq_u32 vcc, 0, v3
  s_nop 1
  v_cndmask_b32 v64, 0, v8, vcc
  v_cmp_eq_u32 vcc, 1, v3
  s_nop 1
  v_cndmask_b32 v64, v64, v9, vcc
  v_cmp_eq_u32 vcc, 2, v3
  s_nop 1
  v_cndmask_b32 v65, 0, v8, vcc
  v_cmp_eq_u32 vcc, 3, v3
  s_nop 1
  v_cndmask_b32 v65, v65, v9, vcc
  v_cmp_eq_u32 vcc, 8, v3
  s_nop 1
  v_cndmask_b32 v66, 0, v8, vcc
  v_cmp_eq_u32 vcc, 9, v3
  s_nop 1
  v_cndmask_b32 v66, v66, v9, vcc
  v_cmp_eq_u32 vcc, 10, v3
  s_nop 1
  v_cndmask_b32 v67, 0, v8, vcc
  v_cmp_eq_u32 vcc, 11, v3
  s_nop 1
  v_cndmask_b32 v67, v67, v9, vcc
  v_cmp_eq_u32 vcc, 16, v3
  s_nop 1
  v_cndmask_b32 v68, 0, v8, vcc
  v_cmp_eq_u32 vcc, 17, v3
  s_nop 1
  v_cndmask_b32 v68, v68, v9, vcc
  v_cmp_eq_u32 vcc, 18, v3
  s_nop 1
  v_cndmask_b32 v69, 0, v8, vcc
  v_cmp_eq_u32 vcc, 19, v3
  s_nop 1
  v_cndmask_b32 v69, v69, v9, vcc
  v_cmp_eq_u32 vcc, 24, v3
  s_nop 1
  v_cndmask_b32 v70, 0, v8, vcc
  v_cmp_eq_u32 vcc, 25, v3
  s_nop 1
  v_cndmask_b32 v70, v70, v9, vcc
  v_cmp_eq_u32 vcc, 26, v3
  s_nop 1
  v_cndmask_b32 v71, 0, v8, vcc
  v_cmp_eq_u32 vcc, 27, v3
  s_nop 1
  v_cndmask_b32 v71, v71, v9, vcc
  s_waitcnt lgkmcnt(0)
  s_lshr_b32 s50, s53, 16
  s_mul_i32 s53, s53, 0x19660d
  s_add_u32 s53, s53, 0x3c6ef35f
  v_mov_b32 v6, s53
  s_and_b32 s8, s53, 0x3fff
  s_and_b32 s49, s53, 0x4000
  s_lshl_b32 s49, s49, 1
  s_or_b32 s8, s8, s49
  s_cmp_eq_u32 s8, s50
  s_cselect_b32 s49, 1, 0
  s_xor_b32 s8, s8, s49
  s_lshl_b32 s8, s8, 16
  s_cmp_eq_u32 s101, 0
  s_cbranch_scc1 NORG_114
  s_getreg_b32 s50, hwreg(HW_REG_XCC_ID)
  s_and_b32 s50, s50, 15
  s_add_u32 s50, s50, s53
  v_mov_b32 v3, s50
  s_lshl_b32 s49, s3, 7
  s_lshl_b32 s50, s55, 2
  s_add_u32 s49, s49, s50
  s_add_u32 s49, s49, 16814080
  s_mov_b64 exec, 1
  buffer_store_dword v3, v5, s[24:27], s49 offen sc1
  s_mov_b64 exec, -1
NORG_114:
  s_cmp_eq_u32 s101, 1
  s_cbranch_scc1 SIX_115
  v_mov_b32 v40, 0
  v_mov_b32 v41, 0
  s_cmp_eq_u32 s101, 1
  s_cselect_b32 s49, 0, 32768
  s_cmp_eq_u32 s101, 0
  s_cselect_b32 s49, 114688, s49
  v_add_u32 v44, s49, v17
  s_mul_i32 s52, s101, 7
  s_add_u32 s50, s52, 7
CS_117:
  s_cmp_gt_u32 s48, s52
  s_cbranch_scc1 WD_119
  s_setprio 0
W_118:
  ds_read_b32 v32, v2 offset:16
  s_waitcnt lgkmcnt(0)
  v_readfirstlane_b32 s48, v32
  s_sub_u32 s90, s90, 1
  s_cbranch_scc1 WD_119
  s_cmp_gt_u32 s48, s52
  s_cbranch_scc0 W_118
  s_setprio 2
WD_119:
  ds_read_b64_tr_b16 v[48:49], v44 offset:0
  ds_read_b64_tr_b16 v[50:51], v44 offset:256
  ds_read_b64_tr_b16 v[52:53], v44 offset:1024
  ds_read_b64_tr_b16 v[54:55], v44 offset:1280
  ds_read_b64_tr_b16 v[56:57], v44 offset:2048
  ds_read_b64_tr_b16 v[58:59], v44 offset:2304
  ds_read_b64_tr_b16 v[60:61], v44 offset:3072
  ds_read_b64_tr_b16 v[62:63], v44 offset:3328
  ds_read_b32 v32, v2 offset:16
  v_add_u32 v44, 4096, v44
  s_add_u32 s52, s52, 1
  s_waitcnt lgkmcnt(7)
  v_dot2c_f32_bf16 v40, s51, v48
  v_dot2c_f32_bf16 v41, s51, v49
  v_dot2c_f32_bf16 v40, s51, v50
  v_dot2c_f32_bf16 v41, s51, v51
  s_waitcnt lgkmcnt(5)
  v_dot2c_f32_bf16 v40, s51, v52
  v_dot2c_f32_bf16 v41, s51, v53
  v_dot2c_f32_bf16 v40, s51, v54
  v_dot2c_f32_bf16 v41, s51, v55
  s_waitcnt lgkmcnt(3)
  v_dot2c_f32_bf16 v40, s51, v56
  v_dot2c_f32_bf16 v41, s51, v57
  v_dot2c_f32_bf16 v40, s51, v58
  v_dot2c_f32_bf16 v41, s51, v59
  s_waitcnt lgkmcnt(1)
  v_dot2c_f32_bf16 v40, s51, v60
  v_dot2c_f32_bf16 v41, s51, v61
  v_dot2c_f32_bf16 v40, s51, v62
  v_dot2c_f32_bf16 v41, s51, v63
  s_waitcnt lgkmcnt(0)
  v_readfirstlane_b32 s48, v32
  s_cmp_lt_u32 s52, s50
  s_cbranch_scc1 CS_117
  v_add_f32 v40, v40, v41
  v_cvt_pk_bf16_f32 v42, v40, v40
  v_and_b32 v3, 0xffff0000, v42
  v_sub_f32 v3, v40, v3
  v_cvt_pk_bf16_f32 v43, v3, 0
  s_lshl_b32 s49, s101, 9
  v_add_u32 v44, s49, v36
  ds_write_b64 v44, v[42:43]
  s_waitcnt vmcnt(0)
  s_branch BOTH_116
SIX_115:
  s_cmp_lt_u32 s55, 28
  s_cbranch_scc1 NI_120
  s_lshl2_add_u32 s52, s3, s55
  s_sub_u32 s52, s52, 28
  v_lshlrev_b32 v4, 7, v1
  s_mul_i32 s49, s52, 40960
  buffer_load_dword v73, v4, s[16:19], s49 offen
  s_add_u32 s49, s49, 8192
  buffer_load_dword v73, v4, s[16:19], s49 offen
  s_add_u32 s49, s49, 8192
  buffer_load_dword v73, v4, s[16:19], s49 offen
  s_add_u32 s49, s49, 8192
  buffer_load_dword v73, v4, s[16:19], s49 offen
  s_add_u32 s49, s49, 8192
  buffer_load_dword v73, v4, s[16:19], s49 offen
  s_add_u32 s49, s49, 8192
  s_mul_i32 s49, s52, 16384
  buffer_load_dword v73, v4, s[28:31], s49 offen
  s_add_u32 s49, s49, 8192
  buffer_load_dword v73, v4, s[28:31], s49 offen
  s_add_u32 s49, s49, 8192
NI_120:
  s_cmp_ge_u32 s0, 7
  s_cbranch_scc1 WD_121
  s_setprio 0
W_122:
  ds_read_b32 v32, v2 offset:28
  s_waitcnt lgkmcnt(0)
  v_readfirstlane_b32 s0, v32
  s_sub_u32 s90, s90, 1
  s_cbranch_scc1 WD_121
  s_cmp_ge_u32 s0, 7
  s_cbranch_scc0 ZZ_123
  s_setprio 2
WD_121:
  s_getreg_b32 s52, hwreg(HW_REG_XCC_ID)
  s_and_b32 s52, s52, 15
  s_add_u32 s52, s52, s53
  s_lshl_b32 s49, s3, 7
  s_add_u32 s49, s49, 16814080
  v_and_b32 v4, 31, v1
  v_lshlrev_b32 v4, 2, v4
  buffer_load_dword v3, v4, s[24:27], s49 offen sc1
  s_waitcnt vmcnt(0)
  v_cmp_ne_u32 vcc, s52, v3
  s_cmp_eq_u64 vcc, 0
  s_cselect_b32 s54, 1, 0
  v_mov_b32 v3, s54
  ds_write_b32 v2, v3 offset:64
BOTH_116:
  v_mov_b32 v3, 1
  ds_write_b32 v7, v3
  s_lshl_b32 s50, s101, 11
  v_add_u32 v8, s50, v5
  v_add_u32 v9, 65536, v8
  v_add_u32 v10, 81920, v5
  s_lshl_b32 s89, s45, 16
  s_add_u32 s89, s89, s50
  s_add_u32 s89, s89, 0
  s_lshl_b32 s88, s44, 12
  s_add_u32 s88, s88, s89
  s_lshl_b32 s91, s45, 1
  s_add_u32 s91, s91, s101
  s_lshl_b32 s91, s91, 12
  s_add_u32 s91, s91, 16842752
  s_lshl_b32 s1, s44, 2
  s_add_u32 s1, s1, s91
  s_lshl_b32 s49, s44, 8
  s_add_u32 s91, s91, s49
  s_add_u32 s94, s24, s91
  s_addc_u32 s95, s25, 0
  s_load_dword s10, s[94:95], 0 glc
  v_lshlrev_b32 v12, 8, v1
  v_lshlrev_b32 v13, 2, v1
  s_setprio 0
W_124:
  ds_read_b128 v[32:35], v2 offset:0
  s_waitcnt lgkmcnt(0)
  v_min3_u32 v32, v32, v33, v34
  v_min_u32 v32, v32, v35
  s_nop 0
  v_readfirstlane_b32 s49, v32
  s_sub_u32 s90, s90, 1
  s_cbranch_scc1 WD_125
  s_cmp_ge_u32 s49, 4
  s_cbranch_scc0 W_124
WD_125:
  s_setprio 2
  ds_read_b128 v[104:107], v9 offset:0
  ds_read_b128 v[108:111], v9 offset:1024
  ds_read_b128 v[112:115], v9 offset:4096
  ds_read_b128 v[116:119], v9 offset:5120
  ds_read_b128 v[120:123], v9 offset:8192
  ds_read_b128 v[124:127], v9 offset:9216
  ds_read_b128 v[128:131], v9 offset:12288
  ds_read_b128 v[132:135], v9 offset:13312
  s_waitcnt lgkmcnt(7)
  v_mfma_f32_32x32x16_bf16 v[152:167], v[104:107], v[64:67], 0
  s_waitcnt lgkmcnt(6)
  v_mfma_f32_32x32x16_bf16 v[152:167], v[108:111], v[68:71], v[152:167]
  s_waitcnt lgkmcnt(5)
  v_mfma_f32_32x32x16_bf16 v[168:183], v[112:115], v[64:67], 0
  s_waitcnt lgkmcnt(4)
  v_mfma_f32_32x32x16_bf16 v[168:183], v[116:119], v[68:71], v[168:183]
  s_waitcnt lgkmcnt(3)
  v_mfma_f32_32x32x16_bf16 v[184:199], v[120:123], v[64:67], 0
  s_waitcnt lgkmcnt(2)
  v_mfma_f32_32x32x16_bf16 v[184:199], v[124:127], v[68:71], v[184:199]
  s_waitcnt lgkmcnt(1)
  v_mfma_f32_32x32x16_bf16 v[200:215], v[128:131], v[64:67], 0
  s_waitcnt lgkmcnt(0)
  v_mfma_f32_32x32x16_bf16 v[200:215], v[132:135], v[68:71], v[200:215]
  v_cvt_pk_bf16_f32 v72, v152, v153
  v_cvt_pk_bf16_f32 v73, v154, v155
  v_cvt_pk_bf16_f32 v74, v156, v157
  v_cvt_pk_bf16_f32 v75, v158, v159
  v_cvt_pk_bf16_f32 v76, v160, v161
  v_cvt_pk_bf16_f32 v77, v162, v163
  v_cvt_pk_bf16_f32 v78, v164, v165
  v_cvt_pk_bf16_f32 v79, v166, v167
  v_cvt_pk_bf16_f32 v80, v168, v169
  v_cvt_pk_bf16_f32 v81, v170, v171
  v_cvt_pk_bf16_f32 v82, v172, v173
  v_cvt_pk_bf16_f32 v83, v174, v175
  v_cvt_pk_bf16_f32 v84, v176, v177
  v_cvt_pk_bf16_f32 v85, v178, v179
  v_cvt_pk_bf16_f32 v86, v180, v181
  v_cvt_pk_bf16_f32 v87, v182, v183
  v_cvt_pk_bf16_f32 v88, v184, v185
  v_cvt_pk_bf16_f32 v89, v186, v187
  v_cvt_pk_bf16_f32 v90, v188, v189
  v_cvt_pk_bf16_f32 v91, v190, v191
  v_cvt_pk_bf16_f32 v92, v192, v193
  v_cvt_pk_bf16_f32 v93, v194, v195
  v_cvt_pk_bf16_f32 v94, v196, v197
  v_cvt_pk_bf16_f32 v95, v198, v199
  v_cvt_pk_bf16_f32 v96, v200, v201
  v_cvt_pk_bf16_f32 v97, v202, v203
  v_cvt_pk_bf16_f32 v98, v204, v205
  v_cvt_pk_bf16_f32 v99, v206, v207
  v_cvt_pk_bf16_f32 v100, v208, v209
  v_cvt_pk_bf16_f32 v101, v210, v211
  v_cvt_pk_bf16_f32 v102, v212, v213
  v_cvt_pk_bf16_f32 v103, v214, v215
W_127:
  ds_read_b32 v32, v2 offset:0
  ds_read_b128 v[104:107], v10 offset:0
  ds_read_b128 v[108:111], v10 offset:1024
  s_waitcnt lgkmcnt(2)
  v_readfirstlane_b32 s49, v32
  s_sub_u32 s90, s90, 1
  s_cbranch_scc1 WD_126
  s_cmp_ge_u32 s49, 5
  s_cbranch_scc0 ZZ_128
WD_126:
  s_waitcnt lgkmcnt(1)
  v_mfma_f32_32x32x16_bf16 v[136:151], v[72:75], v[104:107], 0
  s_waitcnt lgkmcnt(0)
  v_mfma_f32_32x32x16_bf16 v[136:151], v[76:79], v[108:111], v[136:151]
W_130:
  ds_read_b32 v32, v2 offset:8
  ds_read_b128 v[120:123], v10 offset:8192
  ds_read_b128 v[124:127], v10 offset:9216
  s_waitcnt lgkmcnt(2)
  v_readfirstlane_b32 s49, v32
  s_sub_u32 s90, s90, 1
  s_cbranch_scc1 WD_129
  s_cmp_ge_u32 s49, 5
  s_cbranch_scc0 W_130
WD_129:
  s_waitcnt lgkmcnt(1)
  v_mfma_f32_32x32x16_bf16 v[136:151], v[88:91], v[120:123], v[136:151]
  s_waitcnt lgkmcnt(0)
  v_mfma_f32_32x32x16_bf16 v[136:151], v[92:95], v[124:127], v[136:151]
W_132:
  ds_read_b32 v32, v2 offset:4
  ds_read_b128 v[112:115], v10 offset:4096
  ds_read_b128 v[116:119], v10 offset:5120
  s_waitcnt lgkmcnt(2)
  v_readfirstlane_b32 s49, v32
  s_sub_u32 s90, s90, 1
  s_cbranch_scc1 WD_131
  s_cmp_ge_u32 s49, 5
  s_cbranch_scc0 W_132
WD_131:
  s_waitcnt lgkmcnt(1)
  v_mfma_f32_32x32x16_bf16 v[136:151], v[80:83], v[112:115], v[136:151]
  s_waitcnt lgkmcnt(0)
  v_mfma_f32_32x32x16_bf16 v[136:151], v[84:87], v[116:119], v[136:151]
W_134:
  ds_read_b32 v32, v2 offset:12
  ds_read_b128 v[128:131], v10 offset:12288
  ds_read_b128 v[132:135], v10 offset:13312
  s_waitcnt lgkmcnt(2)
  v_readfirstlane_b32 s49, v32
  s_sub_u32 s90, s90, 1
  s_cbranch_scc1 WD_133
  s_cmp_ge_u32 s49, 5
  s_cbranch_scc0 W_134
WD_133:
  s_waitcnt lgkmcnt(1)
  v_mfma_f32_32x32x16_bf16 v[136:151], v[96:99], v[128:131], v[136:151]
  s_waitcnt lgkmcnt(0)
  v_mfma_f32_32x32x16_bf16 v[136:151], v[100:103], v[132:135], v[136:151]
  v_mov_b32 v3, 2
  ds_write_b32 v7, v3
  s_nop 9
  v_cvt_pk_bf16_f32 v72, v136, v137
  v_cvt_pk_bf16_f32 v73, v138, v139
  v_cvt_pk_bf16_f32 v74, v140, v141
  v_cvt_pk_bf16_f32 v75, v142, v143
  v_cvt_pk_bf16_f32 v76, v144, v145
  v_cvt_pk_bf16_f32 v77, v146, v147
  v_cvt_pk_bf16_f32 v78, v148, v149
  v_cvt_pk_bf16_f32 v79, v150, v151
  v_and_b32 v75, 0xffff, v75
  v_or_b32 v75, s8, v75
  v_and_b32 v79, 0xffff, v79
  v_or_b32 v79, s8, v79
  buffer_store_dwordx4 v[72:75], v5, s[24:27], s88 offen offset:0 sc1
  buffer_store_dwordx4 v[76:79], v5, s[24:27], s88 offen offset:1024 sc1
  s_mov_b64 exec, 0xffff
  buffer_store_dword v6, v12, s[24:27], s1 offen sc1
  s_mov_b64 exec, -1
  s_not_b32 s72, s53
  s_mov_b32 s73, s72
  s_mov_b64 s[74:75], s[72:73]
  s_mov_b64 s[76:77], s[72:73]
  s_mov_b64 s[78:79], s[72:73]
  s_mov_b64 s[80:81], s[72:73]
  s_mov_b64 s[82:83], s[72:73]
  s_mov_b64 s[84:85], s[72:73]
  s_mov_b64 s[86:87], s[72:73]
  s_branch OV_138
POLL_135:
P_136:
  s_load_dwordx16 s[72:87], s[94:95], 0 glc
  s_mov_b32 s4, 0
  s_waitcnt lgkmcnt(8)
  s_cmp_eq_u32 s87, s53
  s_addc_u32 s4, s4, s4
  s_cmp_eq_u32 s86, s53
  s_addc_u32 s4, s4, s4
  s_cmp_eq_u32 s85, s53
  s_addc_u32 s4, s4, s4
  s_cmp_eq_u32 s84, s53
  s_addc_u32 s4, s4, s4
  s_cmp_eq_u32 s83, s53
  s_addc_u32 s4, s4, s4
  s_cmp_eq_u32 s82, s53
  s_addc_u32 s4, s4, s4
  s_cmp_eq_u32 s81, s53
  s_addc_u32 s4, s4, s4
  s_cmp_eq_u32 s80, s53
  s_addc_u32 s4, s4, s4
  s_cmp_eq_u32 s79, s53
  s_addc_u32 s4, s4, s4
  s_cmp_eq_u32 s78, s53
  s_addc_u32 s4, s4, s4
  s_cmp_eq_u32 s77, s53
  s_addc_u32 s4, s4, s4
  s_cmp_eq_u32 s76, s53
  s_addc_u32 s4, s4, s4
  s_cmp_eq_u32 s75, s53
  s_addc_u32 s4, s4, s4
  s_cmp_eq_u32 s74, s53
  s_addc_u32 s4, s4, s4
  s_cmp_eq_u32 s73, s53
  s_addc_u32 s4, s4, s4
  s_cmp_eq_u32 s72, s53
  s_addc_u32 s4, s4, s4
  s_sub_u32 s90, s90, 1
  s_cselect_b32 s4, -1, s4
  s_and_b32 s4, s4, s5
  s_cbranch_scc0 P_136
  s_setpc_b64 s[6:7]
OV_138:
  s_mov_b32 s4, 0
  s_mov_b32 s5, 0xffff
  v_mov_b32 v14, 0
  s_nop 1
  s_getpc_b64 s[6:7]
  s_cmp_eq_u32 s4, 0
  s_cbranch_scc1 POLL_135
  s_ff1_i32_b32 s49, s4
  s_bitset0_b32 s4, s49
  s_bitset0_b32 s5, s49
  s_lshl_b32 s49, s49, 12
  s_add_u32 s49, s49, s89
  buffer_load_dwordx4 v[72:75], v5, s[24:27], s49 offen offset:0 sc1
  buffer_load_dwordx4 v[76:79], v5, s[24:27], s49 offen offset:1024 sc1
  s_getpc_b64 s[6:7]
  s_cmp_eq_u32 s4, 0
  s_cbranch_scc1 POLL_135
  s_ff1_i32_b32 s49, s4
  s_bitset0_b32 s4, s49
  s_bitset0_b32 s5, s49
  s_lshl_b32 s49, s49, 12
  s_add_u32 s49, s49, s89
  buffer_load_dwordx4 v[80:83], v5, s[24:27], s49 offen offset:0 sc1
  buffer_load_dwordx4 v[84:87], v5, s[24:27], s49 offen offset:1024 sc1
  s_getpc_b64 s[6:7]
  s_cmp_eq_u32 s4, 0
  s_cbranch_scc1 POLL_135
  s_ff1_i32_b32 s49, s4
  s_bitset0_b32 s4, s49
  s_bitset0_b32 s5, s49
  s_lshl_b32 s49, s49, 12
  s_add_u32 s49, s49, s89
  buffer_load_dwordx4 v[88:91], v5, s[24:27], s49 offen offset:0 sc1
  buffer_load_dwordx4 v[92:95], v5, s[24:27], s49 offen offset:1024 sc1
  s_getpc_b64 s[6:7]
  s_cmp_eq_u32 s4, 0
  s_cbranch_scc1 POLL_135
  s_ff1_i32_b32 s49, s4
  s_bitset0_b32 s4, s49
  s_bitset0_b32 s5, s49
  s_lshl_b32 s49, s49, 12
  s_add_u32 s49, s49, s89
  buffer_load_dwordx4 v[96:99], v5, s[24:27], s49 offen offset:0 sc1
  buffer_load_dwordx4 v[100:103], v5, s[24:27], s49 offen offset:1024 sc1
  s_getpc_b64 s[6:7]
  s_cmp_eq_u32 s4, 0
  s_cbranch_scc1 POLL_135
  s_ff1_i32_b32 s49, s4
  s_bitset0_b32 s4, s49
  s_bitset0_b32 s5, s49
  s_lshl_b32 s49, s49, 12
  s_add_u32 s49, s49, s89
  buffer_load_dwordx4 v[104:107], v5, s[24:27], s49 offen offset:0 sc1
  buffer_load_dwordx4 v[108:111], v5, s[24:27], s49 offen offset:1024 sc1
  s_getpc_b64 s[6:7]
  s_cmp_eq_u32 s4, 0
  s_cbranch_scc1 POLL_135
  s_ff1_i32_b32 s49, s4
  s_bitset0_b32 s4, s49
  s_bitset0_b32 s5, s49
  s_lshl_b32 s49, s49, 12
  s_add_u32 s49, s49, s89
  buffer_load_dwordx4 v[112:115], v5, s[24:27], s49 offen offset:0 sc1
  buffer_load_dwordx4 v[116:119], v5, s[24:27], s49 offen offset:1024 sc1
  s_getpc_b64 s[6:7]
  s_cmp_eq_u32 s4, 0
  s_cbranch_scc1 POLL_135
  s_ff1_i32_b32 s49, s4
  s_bitset0_b32 s4, s49
  s_bitset0_b32 s5, s49
  s_lshl_b32 s49, s49, 12
  s_add_u32 s49, s49, s89
  buffer_load_dwordx4 v[120:123], v5, s[24:27], s49 offen offset:0 sc1
  buffer_load_dwordx4 v[124:127], v5, s[24:27], s49 offen offset:1024 sc1
  s_getpc_b64 s[6:7]
  s_cmp_eq_u32 s4, 0
  s_cbranch_scc1 POLL_135
  s_ff1_i32_b32 s49, s4
  s_bitset0_b32 s4, s49
  s_bitset0_b32 s5, s49
  s_lshl_b32 s49, s49, 12
  s_add_u32 s49, s49, s89
  buffer_load_dwordx4 v[128:131], v5, s[24:27], s49 offen offset:0 sc1
  buffer_load_dwordx4 v[132:135], v5, s[24:27], s49 offen offset:1024 sc1
  s_getpc_b64 s[6:7]
  s_cmp_eq_u32 s4, 0
  s_cbranch_scc1 POLL_135
  s_ff1_i32_b32 s49, s4
  s_bitset0_b32 s4, s49
  s_bitset0_b32 s5, s49
  s_lshl_b32 s49, s49, 12
  s_add_u32 s49, s49, s89
  buffer_load_dwordx4 v[152:155], v5, s[24:27], s49 offen offset:0 sc1
  buffer_load_dwordx4 v[156:159], v5, s[24:27], s49 offen offset:1024 sc1
  s_getpc_b64 s[6:7]
  s_cmp_eq_u32 s4, 0
  s_cbranch_scc1 POLL_135
  s_ff1_i32_b32 s49, s4
  s_bitset0_b32 s4, s49
  s_bitset0_b32 s5, s49
  s_lshl_b32 s49, s49, 12
  s_add_u32 s49, s49, s89
  buffer_load_dwordx4 v[160:163], v5, s[24:27], s49 offen offset:0 sc1
  buffer_load_dwordx4 v[164:167], v5, s[24:27], s49 offen offset:1024 sc1
  s_getpc_b64 s[6:7]
  s_cmp_eq_u32 s4, 0
  s_cbranch_scc1 POLL_135
  s_ff1_i32_b32 s49, s4
  s_bitset0_b32 s4, s49
  s_bitset0_b32 s5, s49
  s_lshl_b32 s49, s49, 12
  s_add_u32 s49, s49, s89
  buffer_load_dwordx4 v[168:171], v5, s[24:27], s49 offen offset:0 sc1
  buffer_load_dwordx4 v[172:175], v5, s[24:27], s49 offen offset:1024 sc1
  s_getpc_b64 s[6:7]
  s_cmp_eq_u32 s4, 0
  s_cbranch_scc1 POLL_135
  s_ff1_i32_b32 s49, s4
  s_bitset0_b32 s4, s49
  s_bitset0_b32 s5, s49
  s_lshl_b32 s49, s49, 12
  s_add_u32 s49, s49, s89
  buffer_load_dwordx4 v[176:179], v5, s[24:27], s49 offen offset:0 sc1
  buffer_load_dwordx4 v[180:183], v5, s[24:27], s49 offen offset:1024 sc1
  s_getpc_b64 s[6:7]
  s_cmp_eq_u32 s4, 0
  s_cbranch_scc1 POLL_135
  s_ff1_i32_b32 s49, s4
  s_bitset0_b32 s4, s49
  s_bitset0_b32 s5, s49
  s_lshl_b32 s49, s49, 12
  s_add_u32 s49, s49, s89
  buffer_load_dwordx4 v[184:187], v5, s[24:27], s49 offen offset:0 sc1
  buffer_load_dwordx4 v[188:191], v5, s[24:27], s49 offen offset:1024 sc1
  s_waitcnt vmcnt(25)
  v_mfma_f32_32x32x16_bf16 v[136:151], v[64:67], v[72:75], 0
  v_xor_b32 v15, s8, v75
  v_or_b32 v14, v14, v15
  s_waitcnt vmcnt(24)
  v_mfma_f32_32x32x16_bf16 v[136:151], v[68:71], v[76:79], v[136:151]
  v_xor_b32 v15, s8, v79
  v_or_b32 v14, v14, v15
  s_getpc_b64 s[6:7]
  s_cmp_eq_u32 s4, 0
  s_cbranch_scc1 POLL_135
  s_ff1_i32_b32 s49, s4
  s_bitset0_b32 s4, s49
  s_bitset0_b32 s5, s49
  s_lshl_b32 s49, s49, 12
  s_add_u32 s49, s49, s89
  buffer_load_dwordx4 v[192:195], v5, s[24:27], s49 offen offset:0 sc1
  buffer_load_dwordx4 v[196:199], v5, s[24:27], s49 offen offset:1024 sc1
  s_waitcnt vmcnt(25)
  v_mfma_f32_32x32x16_bf16 v[136:151], v[64:67], v[80:83], v[136:151]
  v_xor_b32 v15, s8, v83
  v_or_b32 v14, v14, v15
  s_waitcnt vmcnt(24)
  v_mfma_f32_32x32x16_bf16 v[136:151], v[68:71], v[84:87], v[136:151]
  v_xor_b32 v15, s8, v87
  v_or_b32 v14, v14, v15
  s_getpc_b64 s[6:7]
  s_cmp_eq_u32 s4, 0
  s_cbranch_scc1 POLL_135
  s_ff1_i32_b32 s49, s4
  s_bitset0_b32 s4, s49
  s_bitset0_b32 s5, s49
  s_lshl_b32 s49, s49, 12
  s_add_u32 s49, s49, s89
  buffer_load_dwordx4 v[200:203], v5, s[24:27], s49 offen offset:0 sc1
  buffer_load_dwordx4 v[204:207], v5, s[24:27], s49 offen offset:1024 sc1
  s_waitcnt vmcnt(25)
  v_mfma_f32_32x32x16_bf16 v[136:151], v[64:67], v[88:91], v[136:151]
  v_xor_b32 v15, s8, v91
  v_or_b32 v14, v14, v15
  s_waitcnt vmcnt(24)
  v_mfma_f32_32x32x16_bf16 v[136:151], v[68:71], v[92:95], v[136:151]
  v_xor_b32 v15, s8, v95
  v_or_b32 v14, v14, v15
  s_getpc_b64 s[6:7]
  s_cmp_eq_u32 s4, 0
  s_cbranch_scc1 POLL_135
  s_ff1_i32_b32 s49, s4
  s_bitset0_b32 s4, s49
  s_bitset0_b32 s5, s49
  s_lshl_b32 s49, s49, 12
  s_add_u32 s49, s49, s89
  buffer_load_dwordx4 v[208:211], v5, s[24:27], s49 offen offset:0 sc1
  buffer_load_dwordx4 v[212:215], v5, s[24:27], s49 offen offset:1024 sc1
  s_waitcnt vmcnt(25)
  v_mfma_f32_32x32x16_bf16 v[136:151], v[64:67], v[96:99], v[136:151]
  v_xor_b32 v15, s8, v99
  v_or_b32 v14, v14, v15
  s_waitcnt vmcnt(24)
  v_mfma_f32_32x32x16_bf16 v[136:151], v[68:71], v[100:103], v[136:151]
  v_xor_b32 v15, s8, v103
  v_or_b32 v14, v14, v15
  s_waitcnt vmcnt(23)
  v_mfma_f32_32x32x16_bf16 v[136:151], v[64:67], v[104:107], v[136:151]
  v_xor_b32 v15, s8, v107
  v_or_b32 v14, v14, v15
  s_waitcnt vmcnt(22)
  v_mfma_f32_32x32x16_bf16 v[136:151], v[68:71], v[108:111], v[136:151]
  v_xor_b32 v15, s8, v111
  v_or_b32 v14, v14, v15
  s_waitcnt vmcnt(21)
  v_mfma_f32_32x32x16_bf16 v[136:151], v[64:67], v[112:115], v[136:151]
  v_xor_b32 v15, s8, v115
  v_or_b32 v14, v14, v15
  s_waitcnt vmcnt(20)
  v_mfma_f32_32x32x16_bf16 v[136:151], v[68:71], v[116:119], v[136:151]
  v_xor_b32 v15, s8, v119
  v_or_b32 v14, v14, v15
  s_waitcnt vmcnt(19)
  v_mfma_f32_32x32x16_bf16 v[136:151], v[64:67], v[120:123], v[136:151]
  v_xor_b32 v15, s8, v123
  v_or_b32 v14, v14, v15
  s_waitcnt vmcnt(18)
  v_mfma_f32_32x32x16_bf16 v[136:151], v[68:71], v[124:127], v[136:151]
  v_xor_b32 v15, s8, v127
  v_or_b32 v14, v14, v15
  s_waitcnt vmcnt(17)
  v_mfma_f32_32x32x16_bf16 v[136:151], v[64:67], v[128:131], v[136:151]
  v_xor_b32 v15, s8, v131
  v_or_b32 v14, v14, v15
  s_waitcnt vmcnt(16)
  v_mfma_f32_32x32x16_bf16 v[136:151], v[68:71], v[132:135], v[136:151]
  v_xor_b32 v15, s8, v135
  v_or_b32 v14, v14, v15
  s_waitcnt vmcnt(15)
  v_mfma_f32_32x32x16_bf16 v[136:151], v[64:67], v[152:155], v[136:151]
  v_xor_b32 v15, s8, v155
  v_or_b32 v14, v14, v15
  s_waitcnt vmcnt(14)
  v_mfma_f32_32x32x16_bf16 v[136:151], v[68:71], v[156:159], v[136:151]
  v_xor_b32 v15, s8, v159
  v_or_b32 v14, v14, v15
  s_waitcnt vmcnt(13)
  v_mfma_f32_32x32x16_bf16 v[136:151], v[64:67], v[160:163], v[136:151]
  v_xor_b32 v15, s8, v163
  v_or_b32 v14, v14, v15
  s_waitcnt vmcnt(12)
  v_mfma_f32_32x32x16_bf16 v[136:151], v[68:71], v[164:167], v[136:151]
  v_xor_b32 v15, s8, v167
  v_or_b32 v14, v14, v15
  s_waitcnt vmcnt(11)
  v_mfma_f32_32x32x16_bf16 v[136:151], v[64:67], v[168:171], v[136:151]
  v_xor_b32 v15, s8, v171
  v_or_b32 v14, v14, v15
  s_waitcnt vmcnt(10)
  v_mfma_f32_32x32x16_bf16 v[136:151], v[68:71], v[172:175], v[136:151]
  v_xor_b32 v15, s8, v175
  v_or_b32 v14, v14, v15
  s_waitcnt vmcnt(9)
  v_mfma_f32_32x32x16_bf16 v[136:151], v[64:67], v[176:179], v[136:151]
  v_xor_b32 v15, s8, v179
  v_or_b32 v14, v14, v15
  s_waitcnt vmcnt(8)
  v_mfma_f32_32x32x16_bf16 v[136:151], v[68:71], v[180:183], v[136:151]
  v_xor_b32 v15, s8, v183
  v_or_b32 v14, v14, v15
  s_waitcnt vmcnt(7)
  v_mfma_f32_32x32x16_bf16 v[136:151], v[64:67], v[184:187], v[136:151]
  v_xor_b32 v15, s8, v187
  v_or_b32 v14, v14, v15
  s_waitcnt vmcnt(6)
  v_mfma_f32_32x32x16_bf16 v[136:151], v[68:71], v[188:191], v[136:151]
  v_xor_b32 v15, s8, v191
  v_or_b32 v14, v14, v15
  s_waitcnt vmcnt(5)
  v_mfma_f32_32x32x16_bf16 v[136:151], v[64:67], v[192:195], v[136:151]
  v_xor_b32 v15, s8, v195
  v_or_b32 v14, v14, v15
  s_waitcnt vmcnt(4)
  v_mfma_f32_32x32x16_bf16 v[136:151], v[68:71], v[196:199], v[136:151]
  v_xor_b32 v15, s8, v199
  v_or_b32 v14, v14, v15
  s_waitcnt vmcnt(3)
  v_mfma_f32_32x32x16_bf16 v[136:151], v[64:67], v[200:203], v[136:151]
  v_xor_b32 v15, s8, v203
  v_or_b32 v14, v14, v15
  s_waitcnt vmcnt(2)
  v_mfma_f32_32x32x16_bf16 v[136:151], v[68:71], v[204:207], v[136:151]
  v_xor_b32 v15, s8, v207
  v_or_b32 v14, v14, v15
  s_waitcnt vmcnt(1)
  v_mfma_f32_32x32x16_bf16 v[136:151], v[64:67], v[208:211], v[136:151]
  v_xor_b32 v15, s8, v211
  v_or_b32 v14, v14, v15
  s_waitcnt vmcnt(0)
  v_mfma_f32_32x32x16_bf16 v[136:151], v[68:71], v[212:215], v[136:151]
  v_xor_b32 v15, s8, v215
  v_or_b32 v14, v14, v15
  v_cmp_lt_u32 vcc, 0xffff, v14
  s_sub_u32 s90, s90, 1
  s_cbranch_scc1 TOK_139
  s_nop 15
  s_cbranch_vccnz OV_138
TOK_139:
  v_add_u32 v8, 155648, v8
  s_nop 5
  v_cvt_pk_bf16_f32 v72, v136, v137
  v_cvt_pk_bf16_f32 v73, v138, v139
  v_cvt_pk_bf16_f32 v74, v140, v141
  v_cvt_pk_bf16_f32 v75, v142, v143
  v_cvt_pk_bf16_f32 v76, v144, v145
  v_cvt_pk_bf16_f32 v77, v146, v147
  v_cvt_pk_bf16_f32 v78, v148, v149
  v_cvt_pk_bf16_f32 v79, v150, v151
  ds_write_b128 v8, v[72:75] offset:0
  ds_write_b128 v8, v[76:79] offset:1024
  v_mov_b32 v3, 3
  ds_write_b32 v7, v3
  s_cmp_ge_u32 s55, 28
  s_cbranch_scc1 LEND_140
  v_lshlrev_b32 v36, 2, v1
  v_add_u32 v10, 155648, v5
  s_setprio 0
W_141:
  ds_read_b128 v[32:35], v2 offset:0
  s_waitcnt lgkmcnt(0)
  v_min3_u32 v32, v32, v33, v34
  v_min_u32 v32, v32, v35
  s_nop 0
  v_readfirstlane_b32 s49, v32
  s_sub_u32 s90, s90, 1
  s_cbranch_scc1 WD_142
  s_cmp_ge_u32 s49, 11
  s_cbranch_scc0 ZZ_143
WD_142:
  s_setprio 2
  s_cmp_eq_u32 s101, 0
  s_cbranch_scc1 S5_144
  s_cmp_ge_u32 s0, 12
  s_cbranch_scc1 WD_145
  s_setprio 0
W_146:
  ds_read_b32 v32, v2 offset:28
  s_waitcnt lgkmcnt(0)
  v_readfirstlane_b32 s0, v32
  s_sub_u32 s90, s90, 1
  s_cbranch_scc1 WD_145
  s_cmp_ge_u32 s0, 12
  s_cbranch_scc0 ZZ_147
  s_setprio 2
WD_145:
  ds_read2st64_b32 v[72:73], v36 offset0:192 offset1:193
  ds_read2st64_b32 v[74:75], v36 offset0:194 offset1:195
  ds_read2st64_b32 v[76:77], v36 offset0:196 offset1:197
  ds_read2st64_b32 v[78:79], v36 offset0:198 offset1:199
  ds_read2st64_b32 v[80:81], v36 offset0:200 offset1:201
  ds_read2st64_b32 v[82:83], v36 offset0:202 offset1:203
  ds_read2st64_b32 v[84:85], v36 offset0:204 offset1:205
  s_waitcnt lgkmcnt(0)
  v_add_f32 v72, v72, v74
  v_add_f32 v73, v73, v75
  v_add_f32 v72, v72, v76
  v_add_f32 v73, v73, v77
  v_add_f32 v72, v72, v78
  v_add_f32 v73, v73, v79
  v_add_f32 v72, v72, v80
  v_add_f32 v73, v73, v81
  v_add_f32 v72, v72, v82
  v_add_f32 v73, v73, v83
  v_add_f32 v72, v72, v84
  v_add_f32 v73, v73, v85
  v_add_f32 v8, v72, v73
  v_mul_f32 v8, 0x3b124925, v8
  v_mov_b32 v9, v8
  s_nop 1
  v_permlane32_swap_b32 v8, v9
  v_fma_f32 v9, -v8, v8, v9
  v_max_f32 v9, 0, v9
  v_add_f32 v9, 0x3727c5ac, v9
  v_rsq_f32 v25, v9
  v_sub_f32 v24, 0, v8
  v_cvt_pk_bf16_f32 v89, v24, 0
  v_lshlrev_b32 v3, 16, v89
  v_sub_f32 v3, v24, v3
  v_cvt_pk_bf16_f32 v88, v24, v3
  v_mul_f32 v90, v9, v25
  v_mul_f32 v91, 0xbfb8aa3b, v25
  ds_write_b128 v10, v[88:91] offset:0
  v_mov_b32 v3, 4
  ds_write_b32 v7, v3
  s_cmp_ge_u32 s0, 19
  s_cbranch_scc1 WD_148
  s_setprio 0
W_149:
  ds_read_b32 v32, v2 offset:28
  s_waitcnt lgkmcnt(0)
  v_readfirstlane_b32 s0, v32
  s_sub_u32 s90, s90, 1
  s_cbranch_scc1 WD_148
  s_cmp_ge_u32 s0, 19
  s_cbranch_scc0 ZZ_150
  s_setprio 2
WD_148:
  ds_read2st64_b32 v[72:73], v36 offset0:224 offset1:225
  ds_read2st64_b32 v[74:75], v36 offset0:226 offset1:227
  ds_read2st64_b32 v[76:77], v36 offset0:228 offset1:229
  ds_read2st64_b32 v[78:79], v36 offset0:230 offset1:231
  ds_read2st64_b32 v[80:81], v36 offset0:232 offset1:233
  ds_read2st64_b32 v[82:83], v36 offset0:234 offset1:235
  ds_read2st64_b32 v[84:85], v36 offset0:236 offset1:237
  s_waitcnt lgkmcnt(0)
  v_add_f32 v72, v72, v74
  v_add_f32 v73, v73, v75
  v_add_f32 v72, v72, v76
  v_add_f32 v73, v73, v77
  v_add_f32 v72, v72, v78
  v_add_f32 v73, v73, v79
  v_add_f32 v72, v72, v80
  v_add_f32 v73, v73, v81
  v_add_f32 v72, v72, v82
  v_add_f32 v73, v73, v83
  v_add_f32 v72, v72, v84
  v_add_f32 v73, v73, v85
  v_add_f32 v8, v72, v73
  v_mul_f32 v8, 0x3b124925, v8
  v_mov_b32 v9, v8
  s_nop 1
  v_permlane32_swap_b32 v8, v9
  v_fma_f32 v9, -v8, v8, v9
  v_max_f32 v9, 0, v9
  v_add_f32 v9, 0x3727c5ac, v9
  v_rsq_f32 v25, v9
  v_sub_f32 v24, 0, v8
  v_cvt_pk_bf16_f32 v89, v24, 0
  v_lshlrev_b32 v3, 16, v89
  v_sub_f32 v3, v24, v3
  v_cvt_pk_bf16_f32 v88, v24, v3
  v_mul_f32 v90, v9, v25
  v_mul_f32 v91, 0xbfb8aa3b, v25
  ds_write_b128 v10, v[88:91] offset:2048
  v_mov_b32 v3, 5
  ds_write_b32 v7, v3
  s_branch LEND_140
S5_144:
  s_cmp_ge_u32 s0, 15
  s_cbranch_scc1 WD_151
  s_setprio 0
W_152:
  ds_read_b32 v32, v2 offset:28
  s_waitcnt lgkmcnt(0)
  v_readfirstlane_b32 s0, v32
  s_sub_u32 s90, s90, 1
  s_cbranch_scc1 WD_151
  s_cmp_ge_u32 s0, 15
  s_cbranch_scc0 ZZ_153
  s_setprio 2
WD_151:
  ds_read2st64_b32 v[72:73], v36 offset0:208 offset1:209
  ds_read2st64_b32 v[74:75], v36 offset0:210 offset1:211
  ds_read2st64_b32 v[76:77], v36 offset0:212 offset1:213
  ds_read2st64_b32 v[78:79], v36 offset0:214 offset1:215
  ds_read2st64_b32 v[80:81], v36 offset0:216 offset1:217
  ds_read2st64_b32 v[82:83], v36 offset0:218 offset1:219
  ds_read2st64_b32 v[84:85], v36 offset0:220 offset1:221
  s_waitcnt lgkmcnt(0)
  v_add_f32 v72, v72, v74
  v_add_f32 v73, v73, v75
  v_add_f32 v72, v72, v76
  v_add_f32 v73, v73, v77
  v_add_f32 v72, v72, v78
  v_add_f32 v73, v73, v79
  v_add_f32 v72, v72, v80
  v_add_f32 v73, v73, v81
  v_add_f32 v72, v72, v82
  v_add_f32 v73, v73, v83
  v_add_f32 v72, v72, v84
  v_add_f32 v73, v73, v85
  v_add_f32 v8, v72, v73
  v_mul_f32 v8, 0x3b124925, v8
  v_mov_b32 v9, v8
  s_nop 1
  v_permlane32_swap_b32 v8, v9
  v_fma_f32 v9, -v8, v8, v9
  v_max_f32 v9, 0, v9
  v_add_f32 v9, 0x3727c5ac, v9
  v_rsq_f32 v25, v9
  v_sub_f32 v24, 0, v8
  v_cvt_pk_bf16_f32 v89, v24, 0
  v_lshlrev_b32 v3, 16, v89
  v_sub_f32 v3, v24, v3
  v_cvt_pk_bf16_f32 v88, v24, v3
  v_mul_f32 v90, v9, v25
  v_mul_f32 v91, 0xbfb8aa3b, v25
  ds_write_b128 v10, v[88:91] offset:1024
  v_mov_b32 v3, 4
  ds_write_b32 v7, v3
  s_cmp_ge_u32 s0, 23
  s_cbranch_scc1 WD_154
  s_setprio 0
W_155:
  ds_read_b32 v32, v2 offset:28
  s_waitcnt lgkmcnt(0)
  v_readfirstlane_b32 s0, v32
  s_sub_u32 s90, s90, 1
  s_cbranch_scc1 WD_154
  s_cmp_ge_u32 s0, 23
  s_cbranch_scc0 ZZ_156
  s_setprio 2
WD_154:
  ds_read2st64_b32 v[72:73], v36 offset0:240 offset1:241
  ds_read2st64_b32 v[74:75], v36 offset0:242 offset1:243
  ds_read2st64_b32 v[76:77], v36 offset0:244 offset1:245
  ds_read2st64_b32 v[78:79], v36 offset0:246 offset1:247
  ds_read2st64_b32 v[80:81], v36 offset0:248 offset1:249
  ds_read2st64_b32 v[82:83], v36 offset0:250 offset1:251
  ds_read2st64_b32 v[84:85], v36 offset0:252 offset1:253
  s_waitcnt lgkmcnt(0)
  v_add_f32 v72, v72, v74
  v_add_f32 v73, v73, v75
  v_add_f32 v72, v72, v76
  v_add_f32 v73, v73, v77
  v_add_f32 v72, v72, v78
  v_add_f32 v73, v73, v79
  v_add_f32 v72, v72, v80
  v_add_f32 v73, v73, v81
  v_add_f32 v72, v72, v82
  v_add_f32 v73, v73, v83
  v_add_f32 v72, v72, v84
  v_add_f32 v73, v73, v85
  v_add_f32 v8, v72, v73
  v_mul_f32 v8, 0x3b124925, v8
  v_mov_b32 v9, v8
  s_nop 1
  v_permlane32_swap_b32 v8, v9
  v_fma_f32 v9, -v8, v8, v9
  v_max_f32 v9, 0, v9
  v_add_f32 v9, 0x3727c5ac, v9
  v_rsq_f32 v25, v9
  v_sub_f32 v24, 0, v8
  v_cvt_pk_bf16_f32 v89, v24, 0
  v_lshlrev_b32 v3, 16, v89
  v_sub_f32 v3, v24, v3
  v_cvt_pk_bf16_f32 v88, v24, v3
  v_mul_f32 v90, v9, v25
  v_mul_f32 v91, 0xbfb8aa3b, v25
  ds_write_b128 v10, v[88:91] offset:3072
  v_mov_b32 v3, 5
  ds_write_b32 v7, v3
LEND_140:
  s_waitcnt lgkmcnt(0)
  s_endpgm
ZZ_23:
  s_sleep 2
  s_branch W_21
ZZ_42:
  s_sleep 2
  s_branch W_40
ZZ_45:
  s_sleep 1
  s_branch W_44
ZZ_105:
  s_sleep 1
  s_branch W_103
CE_110:
  s_nop 15
P_112:
  buffer_load_dword v42, v41, s[24:27], s91 offen sc1
  s_waitcnt vmcnt(0)
  v_cmp_ne_u32 vcc, s53, v42
  s_sub_u32 s90, s90, 1
  s_cbranch_scc1 CB_111
  s_and_b64 vcc, vcc, s[92:93]
  s_cbranch_scc1 P_112
  s_nop 7
  s_branch CB_111
ZZ_123:
  s_sleep 2
  s_branch W_122
ZZ_128:
  s_sleep 1
  s_branch W_127
ZZ_143:
  s_sleep 2
  s_branch W_141
ZZ_147:
  s_sleep 1
  s_branch W_146
ZZ_150:
  s_sleep 1
  s_branch W_149
ZZ_153:
  s_sleep 1
  s_branch W_152
ZZ_156:
  s_sleep 1
  s_branch W_155
CE_169:
  s_nop 15
  buffer_store_dwordx4 v[120:123], v5, s[24:27], s88 offen offset:0 sc1
  buffer_store_dwordx4 v[124:127], v5, s[24:27], s88 offen offset:1024 sc1
  s_nop 7
  s_branch CB_170
CE_171:
  s_nop 15
  buffer_store_dword v6, v5, s[24:27], s1 offen sc1
  s_nop 7
  s_branch CB_172
CE_180:
  s_nop 15
  buffer_store_dwordx4 v[120:123], v5, s[24:27], s88 offen offset:0 sc1
  buffer_store_dwordx4 v[124:127], v5, s[24:27], s88 offen offset:1024 sc1
  s_nop 7
  s_branch CB_181
CE_182:
  s_nop 15
  buffer_store_dword v8, v10, s[24:27], s52 offen sc1
  s_nop 7
  s_branch CB_183
CE_185:
  s_nop 15
  buffer_store_dword v6, v5, s[24:27], s1 offen sc1
  s_nop 7
  s_branch CB_186
CE_187:
  s_nop 15
W_190:
  ds_read_b32 v32, v2 offset:24
  ds_read_b128 v[128:131], v29 offset:0
  s_waitcnt lgkmcnt(0)
  v_readfirstlane_b32 s49, v32
  s_sub_u32 s90, s90, 1
  s_cbranch_scc1 WD_189
  s_cmp_ge_u32 s49, 4
  s_cbranch_scc0 W_190
WD_189:
  s_nop 7
  s_branch CB_188
CE_191:
  s_nop 15
W_194:
  ds_read_b32 v32, v2 offset:20
  ds_read_b128 v[128:131], v29 offset:1024
  s_waitcnt lgkmcnt(0)
  v_readfirstlane_b32 s49, v32
  s_sub_u32 s90, s90, 1
  s_cbranch_scc1 WD_193
  s_cmp_ge_u32 s49, 4
  s_cbranch_scc0 W_194
WD_193:
  s_nop 7
  s_branch CB_192
CE_195:
  s_nop 15
W_198:
  ds_read_b32 v32, v2 offset:24
  ds_read_b128 v[128:131], v29 offset:2048
  s_waitcnt lgkmcnt(0)
  v_readfirstlane_b32 s49, v32
  s_sub_u32 s90, s90, 1
  s_cbranch_scc1 WD_197
  s_cmp_ge_u32 s49, 5
  s_cbranch_scc0 W_198
WD_197:
  s_nop 7
  s_branch CB_196
CE_199:
  s_nop 15
  buffer_store_dword v6, v5, s[24:27], s1 offen sc1
  s_nop 7
  s_branch CB_200
CE_201:
  s_nop 15
W_204:
  ds_read_b32 v32, v2 offset:20
  ds_read_b128 v[128:131], v29 offset:3072
  s_waitcnt lgkmcnt(0)
  v_readfirstlane_b32 s49, v32
  s_sub_u32 s90, s90, 1
  s_cbranch_scc1 WD_203
  s_cmp_ge_u32 s49, 5
  s_cbranch_scc0 W_204
WD_203:
  s_nop 7
  s_branch CB_202
CE_205:
  s_nop 15
P_207:
  s_mov_b64 exec, 0xfffffff
  buffer_load_dword v25, v24, s[24:27], s6 offen sc1
  s_mov_b64 exec, -1
  s_waitcnt vmcnt(0)
  v_cmp_ne_u32 vcc, s53, v25
  s_sub_u32 s90, s90, 1
  s_cbranch_scc1 CB_206
  s_and_b32 s49, vcc_lo, s10
  s_cbranch_scc1 P_207
  s_nop 7
  s_branch CB_206
CE_208:
  s_nop 15
  buffer_store_dword v6, v5, s[24:27], s5 offen sc1
  s_nop 7
  s_branch CB_209
CE_210:
  s_nop 15
P_212:
  s_mov_b64 exec, 0xfffffff
  buffer_load_dword v25, v24, s[24:27], s6 offen sc1
  s_mov_b64 exec, -1
  s_waitcnt vmcnt(0)
  v_cmp_ne_u32 vcc, s53, v25
  s_sub_u32 s90, s90, 1
  s_cbranch_scc1 CB_211
  s_and_b32 s49, vcc_lo, 0xfffffff
  s_cbranch_scc1 P_212
  s_nop 7
  s_branch CB_211
.p2align 8
.fill 2048, 4, 0xbf800000
.section .rodata,"a"
.p2align 6
.amdhsa_kernel sequential_preLN__linear_kernel_hedgehog__dense_activation_silu__prompt_kernel
  .amdhsa_next_free_vgpr 256
  .amdhsa_next_free_sgpr 102
  .amdhsa_accum_offset 256
  .amdhsa_group_segment_fixed_size 0
  .amdhsa_kernarg_size 80
  .amdhsa_user_sgpr_count 2
  .amdhsa_user_sgpr_kernarg_segment_ptr 1
  .amdhsa_system_sgpr_workgroup_id_x 1
  .amdhsa_float_denorm_mode_32 3
  .amdhsa_float_denorm_mode_16_64 3
.end_amdhsa_kernel
```
